```python
import torch

def _softmax(x, axis=-1):
    return torch.softmax(x, dim=axis)
def _gelu(x):
    return torch.nn.functional.gelu(x, approximate="tanh")
def _silu(x):
    return torch.nn.functional.silu(x)
def _sigmoid(x):
    return torch.sigmoid(x)
def _layernorm(x, axis=-1, eps=1e-5):
    m = x.mean(dim=axis, keepdim=True)
    v = x.var(dim=axis, keepdim=True, unbiased=False)
    return (x - m) / torch.sqrt(v + eps)
def _scatter_add(tgt, idx, src, axis=0):
    return tgt.clone().index_add_(axis, idx, src)
def _segment_sum(src, seg, n):
    out = torch.zeros((n,) + src.shape[1:], dtype=src.dtype)
    return out.index_add_(0, seg, src)
def _pad(x, pw):
    flat = tuple(v for pair in reversed(pw) for v in pair)
    return torch.nn.functional.pad(x, flat)

kernel_name = 'interleave_layers__ssm_conv_h3__swiglu_ffn__prompt'

def setup_inputs():

    _w = (lambda a: (lambda t: t.to(torch.bfloat16) if t.is_floating_point() else t)(torch.as_tensor(a)))
    def _A_setup():
        B, S, D = 1, 2048, 640
        ks = 4
        return {
            "q": _w((lambda *s: torch.randn(*s, dtype=torch.bfloat16) * 0.05)(B, S, D)),
            "k": _w((lambda *s: torch.randn(*s, dtype=torch.bfloat16) * 0.8)(B, S, D)),
            "v": _w((lambda *s: torch.randn(*s, dtype=torch.bfloat16) * 0.8)(B, S, D)),
            "shift_k": _w((lambda *s: torch.randn(*s, dtype=torch.bfloat16) * 0.8)(D, ks) * 0.5),
            "ssm_k": _w((lambda *s: torch.randn(*s, dtype=torch.bfloat16) * 0.8)(D, S) * (1.0 / S ** 0.5)),
            "ssm_D": _w((lambda *s: torch.randn(*s, dtype=torch.bfloat16) * 0.8)(D)),
        }
    _A_in = _A_setup()

    def _B_setup():
        B, S, D, F = 1, 2048, 640, 1536
        return {
            "x": _w((lambda *s: torch.randn(*s, dtype=torch.bfloat16) * 0.05)(B, S, D)),
            "w_gate": _w((lambda *s: torch.randn(*s, dtype=torch.bfloat16) * 0.1)(D, F)),
            "w_up": _w((lambda *s: torch.randn(*s, dtype=torch.bfloat16) * 0.1)(D, F)),
            "w_down": _w((lambda *s: torch.randn(*s, dtype=torch.bfloat16) * 0.1)(F, D)),
        }
    _B_in = _B_setup()

    return {
        "A_q": _A_in["q"],
        "A_k": _A_in["k"],
        "A_v": _A_in["v"],
        "A_shift_k": _A_in["shift_k"],
        "A_ssm_k": _A_in["ssm_k"],
        "A_ssm_D": _A_in["ssm_D"],
        "B_x": _B_in["x"],
        "B_w_gate": _B_in["w_gate"],
        "B_w_up": _B_in["w_up"],
        "B_w_down": _B_in["w_down"],
    }

def reference(A_q, A_k, A_v, A_shift_k, A_ssm_k, A_ssm_D, B_x, B_w_gate, B_w_up, B_w_down):
    def _A_ref(q, k, v, shift_k, ssm_k, ssm_D):
        B, S, D = q.shape
        ks = shift_k.shape[-1]
        k_pad = _pad(k, ((0, 0), (ks - 1, 0), (0, 0)))
        k_shift = torch.zeros_like(k)
        for t in range(ks):
            k_shift = k_shift + k_pad[:, t:t + S, :] * shift_k[:, ks - 1 - t][None, None, :]
        kv = k_shift * v
        L = 2 * S
        kv_pad = _pad(kv, ((0, 0), (0, S), (0, 0)))
        kf_pad = _pad(ssm_k, ((0, 0), (0, S)))
        kv_f = (lambda x, axes=(-2,-1): torch.fft.rfft2(x.float(), dim=axes))(kv_pad[:, None, :, :], axes=(1, 2))
        kf_f = (lambda x, axes=(-2,-1): torch.fft.rfft2(x.float(), dim=axes))(kf_pad[:, None, :], axes=(1, 2))
        kf_f = (lambda x, *d: x.permute(*d))(kf_f, 1, 2, 0)
        y_f = kv_f * kf_f[None, :, :, :]
        y = (lambda x, s, axes=(-2,-1): torch.fft.irfft2(x, s=s, dim=axes).to(torch.bfloat16))(y_f, (1, L), axes=(1, 2))[:, 0, :S, :]
        y = y + kv * ssm_D[None, None, :]
        return q * y

    def _B_ref(x, w_gate, w_up, w_down):
        g = _silu(x @ w_gate)
        u = x @ w_up
        return (g * u) @ w_down

    x = A_q
    x = x + _A_ref(_layernorm(x, axis=-1), A_k, A_v, A_shift_k, A_ssm_k, A_ssm_D)
    x = x + _B_ref(_layernorm(x, axis=-1), B_w_gate, B_w_up, B_w_down)
    x = x + _A_ref(_layernorm(x, axis=-1), A_k, A_v, A_shift_k, A_ssm_k, A_ssm_D)
    x = x + _B_ref(_layernorm(x, axis=-1), B_w_gate, B_w_up, B_w_down)
    return x
```

```asm
; @launch grid=(256,1,1) block=(256,1,1) lds=163840
.amdgcn_target "amdgcn-amd-amdhsa--gfx950"
.text
.globl interleave_layers__ssm_conv_h3__swiglu_ffn__prompt_kernel
.p2align 8
.type interleave_layers__ssm_conv_h3__swiglu_ffn__prompt_kernel,@function
interleave_layers__ssm_conv_h3__swiglu_ffn__prompt_kernel:
    s_cmp_ge_u32 s2, 256
    s_cbranch_scc1 Lk2_end
    s_load_dwordx16 s[64:79], s[0:1], 0
    s_load_dwordx4 s[80:83], s[0:1], 64
    s_load_dwordx2 s[20:21], s[0:1], 88
    s_load_dwordx2 s[24:25], s[0:1], 96
    v_lshlrev_b32 v3, 4, v0
    s_and_b32 s41, s2, 7
    s_lshr_b32 s42, s2, 3
    v_lshrrev_b32 v4, 4, v0
    v_min_u32 v4, 9, v4
    v_and_b32 v5, 15, v0
    s_lshl_b32 s3, s42, 4
    v_add_u32 v6, s3, v5
    v_mul_u32_u24 v7, 5120, v6
    s_mul_i32 s3, s41, 160
    v_lshl_add_u32 v7, v4, 4, v7
    v_add_u32 v7, s3, v7
    s_mov_b32 s5, 0x7fffff00
    v_subrev_u32 v56, 3840, v7
    v_subrev_u32 v57, 2560, v7
    v_subrev_u32 v58, 1280, v7
    v_min_u32 v56, s5, v56
    v_min_u32 v57, s5, v57
    v_min_u32 v58, s5, v58
    s_mul_i32 s3, s41, 640
    v_lshlrev_b32 v59, 6, v4
    v_add_u32 v59, s3, v59
    v_lshrrev_b32 v1, 6, v0
    v_and_b32 v2, 63, v0
    v_readfirstlane_b32 s40, v1
    s_mov_b32 s50, 0x05040100
    s_mov_b32 s51, 0x07060302
    s_mov_b32 s58, 4000000
    s_mov_b32 s22, 256
    s_mov_b32 s23, 0x20000
    s_mov_b32 s26, 268435456
    s_mov_b32 s27, 0x20000
    s_waitcnt lgkmcnt(0)
    s_mov_b32 s8, s66
    s_mov_b32 s9, s67
    s_mov_b32 s10, 2621440
    s_mov_b32 s11, 0x20000
    s_mov_b32 s12, s68
    s_mov_b32 s13, s69
    s_mov_b32 s14, 2621440
    s_mov_b32 s15, 0x20000
    s_mov_b32 s16, s70
    s_mov_b32 s17, s71
    s_mov_b32 s18, 5120
    s_mov_b32 s19, 0x20000
    s_or_b32 s59, s2, s40
    s_cmp_lg_u32 s59, 0
    s_cbranch_scc1 Lnp_interleave_layers__ssm_conv_h3__swiglu_ffn__prompt_kernel_2
    s_memrealtime s[56:57]
    s_waitcnt lgkmcnt(0)
    s_or_b32 s56, s56, 1
    v_mov_b32 v8, s56
    v_mov_b32 v9, s57
    s_mov_b64 exec, 1
    buffer_store_dwordx2 v[8:9], off, s[20:23], 0 sc1
    s_mov_b64 exec, -1
Lnp_interleave_layers__ssm_conv_h3__swiglu_ffn__prompt_kernel_2:
    s_cmp_lg_u32 s40, 3
    s_cbranch_scc1 Ltw_interleave_layers__ssm_conv_h3__swiglu_ffn__prompt_kernel_3
    s_getpc_b64 s[28:29]
Lpc_interleave_layers__ssm_conv_h3__swiglu_ffn__prompt_kernel:
    s_add_u32 s28, s28, interleave_layers__ssm_conv_h3__swiglu_ffn__prompt_kernel-Lpc_interleave_layers__ssm_conv_h3__swiglu_ffn__prompt_kernel
    s_addc_u32 s29, s29, -1
    s_mov_b32 s30, Lk2_end-interleave_layers__ssm_conv_h3__swiglu_ffn__prompt_kernel
    s_mov_b32 s31, 0x20000
    s_lshr_b32 s3, s2, 3
    s_and_b32 s3, s3, 15
    s_lshl_b32 s3, s3, 10
    v_lshlrev_b32 v8, 4, v2
    buffer_load_dwordx4 v[240:243], v8, s[28:31], s3 offen
    s_add_u32 s3, s3, 16384
    buffer_load_dwordx4 v[240:243], v8, s[28:31], s3 offen
    s_add_u32 s3, s3, 16384
    buffer_load_dwordx4 v[240:243], v8, s[28:31], s3 offen
    s_add_u32 s3, s3, 16384
    buffer_load_dwordx4 v[240:243], v8, s[28:31], s3 offen
    s_add_u32 s3, s3, 16384
    s_branch Lp1_interleave_layers__ssm_conv_h3__swiglu_ffn__prompt_kernel_1
Ltw_interleave_layers__ssm_conv_h3__swiglu_ffn__prompt_kernel_3:
    buffer_load_dwordx4 v[108:111], v59, s[16:19], 0 offen
    buffer_load_dwordx4 v[112:115], v59, s[16:19], 0 offen offset:16
    buffer_load_dwordx4 v[116:119], v59, s[16:19], 0 offen offset:32
    buffer_load_dwordx4 v[120:123], v59, s[16:19], 0 offen offset:48
    buffer_load_dwordx4 v[76:79], v7, s[8:11], 0 offen
    buffer_load_dwordx4 v[80:83], v7, s[8:11], 0 offen offset:1280
    buffer_load_dwordx4 v[84:87], v7, s[8:11], 0 offen offset:2560
    buffer_load_dwordx4 v[88:91], v7, s[8:11], 0 offen offset:3840
    buffer_load_dwordx4 v[92:95], v7, s[12:15], 0 offen
    buffer_load_dwordx4 v[96:99], v7, s[12:15], 0 offen offset:1280
    buffer_load_dwordx4 v[100:103], v7, s[12:15], 0 offen offset:2560
    buffer_load_dwordx4 v[104:107], v7, s[12:15], 0 offen offset:3840
    buffer_load_dwordx4 v[64:67], v56, s[8:11], 0 offen
    buffer_load_dwordx4 v[68:71], v57, s[8:11], 0 offen
    buffer_load_dwordx4 v[72:75], v58, s[8:11], 0 offen
    v_lshlrev_b32 v63, 15, v4
    v_lshl_add_u32 v63, v6, 4, v63
    s_mul_i32 s3, s41, 327680
    s_add_u32 s36, s3, 0
    s_add_u32 s37, s3, 8192
    s_add_u32 s38, s3, 16384
    s_add_u32 s39, s3, 24576
    s_waitcnt vmcnt(11)
    v_lshlrev_b32 v124, 16, v108
    v_lshlrev_b32 v125, 16, v110
    v_and_b32 v126, 0xffff0000, v108
    v_and_b32 v127, 0xffff0000, v110
    v_lshlrev_b32 v128, 16, v109
    v_lshlrev_b32 v129, 16, v111
    v_and_b32 v130, 0xffff0000, v109
    v_and_b32 v131, 0xffff0000, v111
    v_lshlrev_b32 v132, 16, v112
    v_lshlrev_b32 v133, 16, v114
    v_and_b32 v134, 0xffff0000, v112
    v_and_b32 v135, 0xffff0000, v114
    v_lshlrev_b32 v136, 16, v113
    v_lshlrev_b32 v137, 16, v115
    v_and_b32 v138, 0xffff0000, v113
    v_and_b32 v139, 0xffff0000, v115
    v_lshlrev_b32 v140, 16, v116
    v_lshlrev_b32 v141, 16, v118
    v_and_b32 v142, 0xffff0000, v116
    v_and_b32 v143, 0xffff0000, v118
    v_lshlrev_b32 v144, 16, v117
    v_lshlrev_b32 v145, 16, v119
    v_and_b32 v146, 0xffff0000, v117
    v_and_b32 v147, 0xffff0000, v119
    v_lshlrev_b32 v148, 16, v120
    v_lshlrev_b32 v149, 16, v122
    v_and_b32 v150, 0xffff0000, v120
    v_and_b32 v151, 0xffff0000, v122
    v_lshlrev_b32 v152, 16, v121
    v_lshlrev_b32 v153, 16, v123
    v_and_b32 v154, 0xffff0000, v121
    v_and_b32 v155, 0xffff0000, v123
    s_waitcnt vmcnt(0)
    v_lshlrev_b32 v8, 16, v64
    v_and_b32 v9, 0xffff0000, v64
    v_lshlrev_b32 v10, 16, v68
    v_and_b32 v11, 0xffff0000, v68
    v_lshlrev_b32 v12, 16, v72
    v_and_b32 v13, 0xffff0000, v72
    v_lshlrev_b32 v14, 16, v76
    v_and_b32 v15, 0xffff0000, v76
    v_lshlrev_b32 v16, 16, v80
    v_and_b32 v17, 0xffff0000, v80
    v_lshlrev_b32 v18, 16, v84
    v_and_b32 v19, 0xffff0000, v84
    v_lshlrev_b32 v20, 16, v88
    v_and_b32 v21, 0xffff0000, v88
    v_lshlrev_b32 v30, 16, v92
    v_and_b32 v31, 0xffff0000, v92
    v_pk_mul_f32 v[32:33], v[8:9], v[130:131]
    v_pk_fma_f32 v[32:33], v[10:11], v[128:129], v[32:33]
    v_pk_fma_f32 v[32:33], v[12:13], v[126:127], v[32:33]
    v_pk_fma_f32 v[32:33], v[14:15], v[124:125], v[32:33]
    v_pk_mul_f32 v[32:33], v[32:33], v[30:31]
    v_lshlrev_b32 v30, 16, v96
    v_and_b32 v31, 0xffff0000, v96
    v_pk_mul_f32 v[34:35], v[10:11], v[130:131]
    v_pk_fma_f32 v[34:35], v[12:13], v[128:129], v[34:35]
    v_pk_fma_f32 v[34:35], v[14:15], v[126:127], v[34:35]
    v_pk_fma_f32 v[34:35], v[16:17], v[124:125], v[34:35]
    v_pk_mul_f32 v[34:35], v[34:35], v[30:31]
    v_lshlrev_b32 v30, 16, v100
    v_and_b32 v31, 0xffff0000, v100
    v_pk_mul_f32 v[36:37], v[12:13], v[130:131]
    v_pk_fma_f32 v[36:37], v[14:15], v[128:129], v[36:37]
    v_pk_fma_f32 v[36:37], v[16:17], v[126:127], v[36:37]
    v_pk_fma_f32 v[36:37], v[18:19], v[124:125], v[36:37]
    v_pk_mul_f32 v[36:37], v[36:37], v[30:31]
    v_lshlrev_b32 v30, 16, v104
    v_and_b32 v31, 0xffff0000, v104
    v_pk_mul_f32 v[38:39], v[14:15], v[130:131]
    v_pk_fma_f32 v[38:39], v[16:17], v[128:129], v[38:39]
    v_pk_fma_f32 v[38:39], v[18:19], v[126:127], v[38:39]
    v_pk_fma_f32 v[38:39], v[20:21], v[124:125], v[38:39]
    v_pk_mul_f32 v[38:39], v[38:39], v[30:31]
    v_cvt_pk_bf16_f32 v40, v38, v36
    v_cvt_pk_bf16_f32 v41, v34, v32
    v_cvt_pk_bf16_f32 v42, v39, v37
    v_cvt_pk_bf16_f32 v43, v35, v33
    buffer_store_dwordx4 v[40:43], v63, s[24:27], s36 offen sc1
    v_lshlrev_b32 v8, 16, v65
    v_and_b32 v9, 0xffff0000, v65
    v_lshlrev_b32 v10, 16, v69
    v_and_b32 v11, 0xffff0000, v69
    v_lshlrev_b32 v12, 16, v73
    v_and_b32 v13, 0xffff0000, v73
    v_lshlrev_b32 v14, 16, v77
    v_and_b32 v15, 0xffff0000, v77
    v_lshlrev_b32 v16, 16, v81
    v_and_b32 v17, 0xffff0000, v81
    v_lshlrev_b32 v18, 16, v85
    v_and_b32 v19, 0xffff0000, v85
    v_lshlrev_b32 v20, 16, v89
    v_and_b32 v21, 0xffff0000, v89
    v_lshlrev_b32 v30, 16, v93
    v_and_b32 v31, 0xffff0000, v93
    v_pk_mul_f32 v[32:33], v[8:9], v[138:139]
    v_pk_fma_f32 v[32:33], v[10:11], v[136:137], v[32:33]
    v_pk_fma_f32 v[32:33], v[12:13], v[134:135], v[32:33]
    v_pk_fma_f32 v[32:33], v[14:15], v[132:133], v[32:33]
    v_pk_mul_f32 v[32:33], v[32:33], v[30:31]
    v_lshlrev_b32 v30, 16, v97
    v_and_b32 v31, 0xffff0000, v97
    v_pk_mul_f32 v[34:35], v[10:11], v[138:139]
    v_pk_fma_f32 v[34:35], v[12:13], v[136:137], v[34:35]
    v_pk_fma_f32 v[34:35], v[14:15], v[134:135], v[34:35]
    v_pk_fma_f32 v[34:35], v[16:17], v[132:133], v[34:35]
    v_pk_mul_f32 v[34:35], v[34:35], v[30:31]
    v_lshlrev_b32 v30, 16, v101
    v_and_b32 v31, 0xffff0000, v101
    v_pk_mul_f32 v[36:37], v[12:13], v[138:139]
    v_pk_fma_f32 v[36:37], v[14:15], v[136:137], v[36:37]
    v_pk_fma_f32 v[36:37], v[16:17], v[134:135], v[36:37]
    v_pk_fma_f32 v[36:37], v[18:19], v[132:133], v[36:37]
    v_pk_mul_f32 v[36:37], v[36:37], v[30:31]
    v_lshlrev_b32 v30, 16, v105
    v_and_b32 v31, 0xffff0000, v105
    v_pk_mul_f32 v[38:39], v[14:15], v[138:139]
    v_pk_fma_f32 v[38:39], v[16:17], v[136:137], v[38:39]
    v_pk_fma_f32 v[38:39], v[18:19], v[134:135], v[38:39]
    v_pk_fma_f32 v[38:39], v[20:21], v[132:133], v[38:39]
    v_pk_mul_f32 v[38:39], v[38:39], v[30:31]
    v_cvt_pk_bf16_f32 v44, v38, v36
    v_cvt_pk_bf16_f32 v45, v34, v32
    v_cvt_pk_bf16_f32 v46, v39, v37
    v_cvt_pk_bf16_f32 v47, v35, v33
    buffer_store_dwordx4 v[44:47], v63, s[24:27], s37 offen sc1
    v_lshlrev_b32 v8, 16, v66
    v_and_b32 v9, 0xffff0000, v66
    v_lshlrev_b32 v10, 16, v70
    v_and_b32 v11, 0xffff0000, v70
    v_lshlrev_b32 v12, 16, v74
    v_and_b32 v13, 0xffff0000, v74
    v_lshlrev_b32 v14, 16, v78
    v_and_b32 v15, 0xffff0000, v78
    v_lshlrev_b32 v16, 16, v82
    v_and_b32 v17, 0xffff0000, v82
    v_lshlrev_b32 v18, 16, v86
    v_and_b32 v19, 0xffff0000, v86
    v_lshlrev_b32 v20, 16, v90
    v_and_b32 v21, 0xffff0000, v90
    v_lshlrev_b32 v30, 16, v94
    v_and_b32 v31, 0xffff0000, v94
    v_pk_mul_f32 v[32:33], v[8:9], v[146:147]
    v_pk_fma_f32 v[32:33], v[10:11], v[144:145], v[32:33]
    v_pk_fma_f32 v[32:33], v[12:13], v[142:143], v[32:33]
    v_pk_fma_f32 v[32:33], v[14:15], v[140:141], v[32:33]
    v_pk_mul_f32 v[32:33], v[32:33], v[30:31]
    v_lshlrev_b32 v30, 16, v98
    v_and_b32 v31, 0xffff0000, v98
    v_pk_mul_f32 v[34:35], v[10:11], v[146:147]
    v_pk_fma_f32 v[34:35], v[12:13], v[144:145], v[34:35]
    v_pk_fma_f32 v[34:35], v[14:15], v[142:143], v[34:35]
    v_pk_fma_f32 v[34:35], v[16:17], v[140:141], v[34:35]
    v_pk_mul_f32 v[34:35], v[34:35], v[30:31]
    v_lshlrev_b32 v30, 16, v102
    v_and_b32 v31, 0xffff0000, v102
    v_pk_mul_f32 v[36:37], v[12:13], v[146:147]
    v_pk_fma_f32 v[36:37], v[14:15], v[144:145], v[36:37]
    v_pk_fma_f32 v[36:37], v[16:17], v[142:143], v[36:37]
    v_pk_fma_f32 v[36:37], v[18:19], v[140:141], v[36:37]
    v_pk_mul_f32 v[36:37], v[36:37], v[30:31]
    v_lshlrev_b32 v30, 16, v106
    v_and_b32 v31, 0xffff0000, v106
    v_pk_mul_f32 v[38:39], v[14:15], v[146:147]
    v_pk_fma_f32 v[38:39], v[16:17], v[144:145], v[38:39]
    v_pk_fma_f32 v[38:39], v[18:19], v[142:143], v[38:39]
    v_pk_fma_f32 v[38:39], v[20:21], v[140:141], v[38:39]
    v_pk_mul_f32 v[38:39], v[38:39], v[30:31]
    v_cvt_pk_bf16_f32 v48, v38, v36
    v_cvt_pk_bf16_f32 v49, v34, v32
    v_cvt_pk_bf16_f32 v50, v39, v37
    v_cvt_pk_bf16_f32 v51, v35, v33
    buffer_store_dwordx4 v[48:51], v63, s[24:27], s38 offen sc1
    v_lshlrev_b32 v8, 16, v67
    v_and_b32 v9, 0xffff0000, v67
    v_lshlrev_b32 v10, 16, v71
    v_and_b32 v11, 0xffff0000, v71
    v_lshlrev_b32 v12, 16, v75
    v_and_b32 v13, 0xffff0000, v75
    v_lshlrev_b32 v14, 16, v79
    v_and_b32 v15, 0xffff0000, v79
    v_lshlrev_b32 v16, 16, v83
    v_and_b32 v17, 0xffff0000, v83
    v_lshlrev_b32 v18, 16, v87
    v_and_b32 v19, 0xffff0000, v87
    v_lshlrev_b32 v20, 16, v91
    v_and_b32 v21, 0xffff0000, v91
    v_lshlrev_b32 v30, 16, v95
    v_and_b32 v31, 0xffff0000, v95
    v_pk_mul_f32 v[32:33], v[8:9], v[154:155]
    v_pk_fma_f32 v[32:33], v[10:11], v[152:153], v[32:33]
    v_pk_fma_f32 v[32:33], v[12:13], v[150:151], v[32:33]
    v_pk_fma_f32 v[32:33], v[14:15], v[148:149], v[32:33]
    v_pk_mul_f32 v[32:33], v[32:33], v[30:31]
    v_lshlrev_b32 v30, 16, v99
    v_and_b32 v31, 0xffff0000, v99
    v_pk_mul_f32 v[34:35], v[10:11], v[154:155]
    v_pk_fma_f32 v[34:35], v[12:13], v[152:153], v[34:35]
    v_pk_fma_f32 v[34:35], v[14:15], v[150:151], v[34:35]
    v_pk_fma_f32 v[34:35], v[16:17], v[148:149], v[34:35]
    v_pk_mul_f32 v[34:35], v[34:35], v[30:31]
    v_lshlrev_b32 v30, 16, v103
    v_and_b32 v31, 0xffff0000, v103
    v_pk_mul_f32 v[36:37], v[12:13], v[154:155]
    v_pk_fma_f32 v[36:37], v[14:15], v[152:153], v[36:37]
    v_pk_fma_f32 v[36:37], v[16:17], v[150:151], v[36:37]
    v_pk_fma_f32 v[36:37], v[18:19], v[148:149], v[36:37]
    v_pk_mul_f32 v[36:37], v[36:37], v[30:31]
    v_lshlrev_b32 v30, 16, v107
    v_and_b32 v31, 0xffff0000, v107
    v_pk_mul_f32 v[38:39], v[14:15], v[154:155]
    v_pk_fma_f32 v[38:39], v[16:17], v[152:153], v[38:39]
    v_pk_fma_f32 v[38:39], v[18:19], v[150:151], v[38:39]
    v_pk_fma_f32 v[38:39], v[20:21], v[148:149], v[38:39]
    v_pk_mul_f32 v[38:39], v[38:39], v[30:31]
    v_cvt_pk_bf16_f32 v52, v38, v36
    v_cvt_pk_bf16_f32 v53, v34, v32
    v_cvt_pk_bf16_f32 v54, v39, v37
    v_cvt_pk_bf16_f32 v55, v35, v33
    buffer_store_dwordx4 v[52:55], v63, s[24:27], s39 offen sc1
Lp1_interleave_layers__ssm_conv_h3__swiglu_ffn__prompt_kernel_1:
    s_cmp_ge_u32 s2, 160
    s_cbranch_scc1 Lk01_help
    s_mul_i32 s46, s41, 20
    s_add_u32 s46, s46, s42
    s_lshl_b32 s43, s46, 2
    s_add_u32 s43, s43, s40
    s_lshl_b32 s4, s43, 12
    s_add_u32 s32, s72, s4
    s_addc_u32 s33, s73, 0
    s_mov_b32 s34, 4096
    s_mov_b32 s35, 0x20000
    v_lshlrev_b32 v60, 4, v2
    v_subrev_u32 v61, 32, v60
    v_subrev_u32 v62, 16, v60
    v_min_u32 v61, s5, v61
    v_min_u32 v62, s5, v62
    buffer_load_dwordx4 v[160:163], v60, s[32:35], 0 offen offset:0
    buffer_load_dwordx2 v[164:165], v60, s[32:35], 0 offen offset:16
    buffer_load_dwordx4 v[168:171], v60, s[32:35], 0 offen offset:1024
    buffer_load_dwordx2 v[172:173], v60, s[32:35], 0 offen offset:1040
    buffer_load_dwordx4 v[176:179], v60, s[32:35], 0 offen offset:2048
    buffer_load_dwordx2 v[180:181], v60, s[32:35], 0 offen offset:2064
    buffer_load_dwordx4 v[184:187], v60, s[32:35], 0 offen offset:3072
    buffer_load_dwordx2 v[188:189], v60, s[32:35], 0 offen offset:3088
    buffer_load_dwordx4 v[192:195], v61, s[32:35], 0 offen
    buffer_load_dwordx2 v[196:197], v62, s[32:35], 0 offen
    s_lshl_b32 s4, s43, 1
    s_and_b32 s4, s4, -4
    s_load_dword s44, s[74:75], s4
    s_mul_i32 s45, s40, 21248
    v_and_b32 v8, 15, v2
    v_lshrrev_b32 v9, 4, v2
    s_cmp_lg_u32 s40, 3
    s_cbranch_scc1 Lc3_interleave_layers__ssm_conv_h3__swiglu_ffn__prompt_kernel_6
Lng_interleave_layers__ssm_conv_h3__swiglu_ffn__prompt_kernel_7:
    buffer_load_dwordx2 v[16:17], off, s[20:23], 0 sc1
    s_waitcnt vmcnt(0)
    v_readfirstlane_b32 s56, v16
    v_readfirstlane_b32 s57, v17
    s_sub_u32 s58, s58, 1
    s_cbranch_scc1 Lk2_end
    s_cmp_eq_u32 s56, 0
    s_cbranch_scc1 Lng_interleave_layers__ssm_conv_h3__swiglu_ffn__prompt_kernel_7
Lc3_interleave_layers__ssm_conv_h3__swiglu_ffn__prompt_kernel_6:
    s_waitcnt vmcnt(10)
    s_barrier
    s_cmp_lg_u32 s40, 3
    s_cbranch_scc1 Lcw_interleave_layers__ssm_conv_h3__swiglu_ffn__prompt_kernel_5
    s_lshl_b32 s6, s41, 5
    s_add_u32 s6, s6, s42
    s_lshl_b32 s6, s6, 8
    s_add_u32 s6, s6, 13631488
    v_mov_b32 v16, s56
    v_mov_b32 v17, s57
    s_mov_b64 exec, 1
    buffer_store_dwordx2 v[16:17], off, s[24:27], s6 sc1
    s_mov_b64 exec, -1
Lcw_interleave_layers__ssm_conv_h3__swiglu_ffn__prompt_kernel_5:
    v_mov_b32 v12, 0
    v_mov_b32 v13, 0
    v_mov_b32 v14, 0
    v_mov_b32 v15, 0
    v_and_b32 v10, 31, v2
    v_lshlrev_b32 v10, 4, v10
    v_add_u32 v10, s45, v10
    ds_write_b128 v10, v[12:15] offset:20736
    v_add_u32 v18, 1, v8
    v_and_b32 v19, 3, v18
    v_sub_u32 v18, v18, v19
    v_lshl_add_u32 v18, v9, 3, v18
    v_lshlrev_b32 v18, 1, v18
    v_mul_u32_u24 v19, 4160, v19
    v_add3_u32 v228, v18, v19, s45
    v_lshlrev_b32 v18, 5, v8
    v_sub_u32 v18, 17120, v18
    v_lshl_add_u32 v18, v9, 4, v18
    v_add_u32 v229, s45, v18
    v_lshlrev_b32 v19, 3, v0
    v_sub_u32 v230, 18680, v19
    v_add_u32 v231, 42496, v230
    v_lshlrev_b32 v232, 5, v8
    v_lshl_add_u32 v232, v9, 3, v232
    v_add_u32 v232, s45, v232
    v_lshlrev_b32 v233, 2, v0
    v_add_u32 v234, 42496, v233
    v_lshlrev_b32 v235, 8, v2
    v_add_u32 v236, s45, v60
    s_waitcnt lgkmcnt(0)
    s_and_b32 s4, s43, 1
    s_lshl_b32 s4, s4, 4
    s_lshr_b32 s44, s44, s4
    s_and_b32 s44, s44, 0xffff
    v_lshl_add_u32 v18, v9, 3, v8
    v_sub_u32 v18, 15, v18
    v_and_b32 v19, 1, v18
    v_lshlrev_b32 v19, 4, v19
    v_lshlrev_b32 v19, v19, s44
    v_lshrrev_b32 v18, 1, v18
    v_cmp_eq_u32 vcc, 0, v18
    s_nop 1
    v_cndmask_b32 v224, 0, v19, vcc
    v_cmp_eq_u32 vcc, 1, v18
    s_nop 1
    v_cndmask_b32 v225, 0, v19, vcc
    v_cmp_eq_u32 vcc, 2, v18
    s_nop 1
    v_cndmask_b32 v226, 0, v19, vcc
    v_cmp_eq_u32 vcc, 3, v18
    s_nop 1
    v_cndmask_b32 v227, 0, v19, vcc
    s_waitcnt vmcnt(0)
    ds_write_b128 v236, v[160:163] offset:32
    v_alignbyte_b32 v64, v161, v160, 2
    v_alignbyte_b32 v65, v162, v161, 2
    v_alignbyte_b32 v66, v163, v162, 2
    v_alignbyte_b32 v67, v164, v163, 2
    ds_write_b128 v236, v[64:67] offset:4192
    v_mov_b32 v68, v161
    v_mov_b32 v69, v162
    v_mov_b32 v70, v163
    v_mov_b32 v71, v164
    ds_write_b128 v236, v[68:71] offset:8352
    v_alignbyte_b32 v72, v162, v161, 2
    v_alignbyte_b32 v73, v163, v162, 2
    v_alignbyte_b32 v74, v164, v163, 2
    v_alignbyte_b32 v75, v165, v164, 2
    ds_write_b128 v236, v[72:75] offset:12512
    ds_write_b128 v236, v[168:171] offset:1056
    v_alignbyte_b32 v76, v169, v168, 2
    v_alignbyte_b32 v77, v170, v169, 2
    v_alignbyte_b32 v78, v171, v170, 2
    v_alignbyte_b32 v79, v172, v171, 2
    ds_write_b128 v236, v[76:79] offset:5216
    v_mov_b32 v80, v169
    v_mov_b32 v81, v170
    v_mov_b32 v82, v171
    v_mov_b32 v83, v172
    ds_write_b128 v236, v[80:83] offset:9376
    v_alignbyte_b32 v84, v170, v169, 2
    v_alignbyte_b32 v85, v171, v170, 2
    v_alignbyte_b32 v86, v172, v171, 2
    v_alignbyte_b32 v87, v173, v172, 2
    ds_write_b128 v236, v[84:87] offset:13536
    ds_write_b128 v236, v[176:179] offset:2080
    v_alignbyte_b32 v88, v177, v176, 2
    v_alignbyte_b32 v89, v178, v177, 2
    v_alignbyte_b32 v90, v179, v178, 2
    v_alignbyte_b32 v91, v180, v179, 2
    ds_write_b128 v236, v[88:91] offset:6240
    v_mov_b32 v92, v177
    v_mov_b32 v93, v178
    v_mov_b32 v94, v179
    v_mov_b32 v95, v180
    ds_write_b128 v236, v[92:95] offset:10400
    v_alignbyte_b32 v96, v178, v177, 2
    v_alignbyte_b32 v97, v179, v178, 2
    v_alignbyte_b32 v98, v180, v179, 2
    v_alignbyte_b32 v99, v181, v180, 2
    ds_write_b128 v236, v[96:99] offset:14560
    ds_write_b128 v236, v[184:187] offset:3104
    v_alignbyte_b32 v100, v185, v184, 2
    v_alignbyte_b32 v101, v186, v185, 2
    v_alignbyte_b32 v102, v187, v186, 2
    v_alignbyte_b32 v103, v188, v187, 2
    ds_write_b128 v236, v[100:103] offset:7264
    v_mov_b32 v104, v185
    v_mov_b32 v105, v186
    v_mov_b32 v106, v187
    v_mov_b32 v107, v188
    ds_write_b128 v236, v[104:107] offset:11424
    v_alignbyte_b32 v108, v186, v185, 2
    v_alignbyte_b32 v109, v187, v186, 2
    v_alignbyte_b32 v110, v188, v187, 2
    v_alignbyte_b32 v111, v189, v188, 2
    ds_write_b128 v236, v[108:111] offset:15584
    ds_write_b128 v236, v[192:195] offset:0
    v_alignbyte_b32 v112, v193, v192, 2
    v_alignbyte_b32 v113, v194, v193, 2
    v_alignbyte_b32 v114, v195, v194, 2
    v_alignbyte_b32 v115, v196, v195, 2
    ds_write_b128 v236, v[112:115] offset:4160
    v_mov_b32 v116, v193
    v_mov_b32 v117, v194
    v_mov_b32 v118, v195
    v_mov_b32 v119, v196
    ds_write_b128 v236, v[116:119] offset:8320
    v_alignbyte_b32 v120, v194, v193, 2
    v_alignbyte_b32 v121, v195, v194, 2
    v_alignbyte_b32 v122, v196, v195, 2
    v_alignbyte_b32 v123, v197, v196, 2
    ds_write_b128 v236, v[120:123] offset:12480
    s_lshl_b32 s47, s46, 14
    s_add_u32 s36, s47, 0
    s_lshl_b32 s7, s41, 13
    s_add_u32 s7, s7, 13631488
    s_cmp_lg_u32 s40, 3
    s_cbranch_scc1 Lcw_interleave_layers__ssm_conv_h3__swiglu_ffn__prompt_kernel_8
    s_mov_b64 exec, 0xffffffff
Lfw_interleave_layers__ssm_conv_h3__swiglu_ffn__prompt_kernel_9:
    buffer_load_dwordx2 v[16:17], v235, s[24:27], s7 offen sc1
    s_waitcnt vmcnt(0)
    s_sub_u32 s58, s58, 1
    s_cbranch_scc1 Lk2_end
    v_cmp_ne_u64 vcc, s[56:57], v[16:17]
    s_cbranch_vccnz Lfw_interleave_layers__ssm_conv_h3__swiglu_ffn__prompt_kernel_9
    s_mov_b64 exec, -1
Lcw_interleave_layers__ssm_conv_h3__swiglu_ffn__prompt_kernel_8:
    s_barrier
    buffer_load_dwordx4 v[208:211], v3, s[24:27], s36 offen sc1
    s_add_u32 s36, s36, 4096
    buffer_load_dwordx4 v[212:215], v3, s[24:27], s36 offen sc1
    s_add_u32 s36, s36, 4096
    buffer_load_dwordx4 v[216:219], v3, s[24:27], s36 offen sc1
    s_add_u32 s36, s36, 4096
    buffer_load_dwordx4 v[220:223], v3, s[24:27], s36 offen sc1
    s_waitcnt lgkmcnt(0)
    ds_read_b64 v[64:65], v228 offset:0
    ds_read_b64 v[66:67], v228 offset:8
    ds_read_b64 v[68:69], v228 offset:512
    ds_read_b64 v[70:71], v228 offset:520
    ds_read_b64 v[72:73], v228 offset:1024
    ds_read_b64 v[74:75], v228 offset:1032
    ds_read_b64 v[76:77], v228 offset:1536
    ds_read_b64 v[78:79], v228 offset:1544
    ds_read_b64 v[80:81], v228 offset:2048
    ds_read_b64 v[82:83], v228 offset:2056
    ds_read_b64 v[84:85], v228 offset:2560
    ds_read_b64 v[86:87], v228 offset:2568
    ds_read_b64 v[88:89], v228 offset:3072
    ds_read_b64 v[90:91], v228 offset:3080
    ds_read_b64 v[92:93], v228 offset:3584
    ds_read_b64 v[94:95], v228 offset:3592
    s_waitcnt vmcnt(3)
    ds_write_b64 v230, v[208:209] offset:2048
    ds_write_b64 v230, v[210:211] offset:23296
    s_waitcnt vmcnt(2)
    ds_write_b64 v230, v[212:213] offset:0
    ds_write_b64 v230, v[214:215] offset:21248
    s_waitcnt vmcnt(1)
    ds_write_b64 v231, v[216:217] offset:2048
    ds_write_b64 v231, v[218:219] offset:23296
    s_waitcnt vmcnt(0)
    ds_write_b64 v231, v[220:221] offset:0
    ds_write_b64 v231, v[222:223] offset:21248
    s_waitcnt lgkmcnt(0)
    s_barrier
    s_waitcnt lgkmcnt(0)
    ds_read_b128 v[96:99], v229 offset:3584
    ds_read_b128 v[100:103], v229 offset:3072
    ds_read_b128 v[104:107], v229 offset:2560
    ds_read_b128 v[108:111], v229 offset:2048
    ds_read_b128 v[112:115], v229 offset:1536
    ds_read_b128 v[116:119], v229 offset:1024
    ds_read_b128 v[120:123], v229 offset:512
    ds_read_b128 v[124:127], v229 offset:0
    buffer_load_dwordx2 v[238:239], off, s[20:23], 0 sc1
    s_waitcnt lgkmcnt(7)
    v_mfma_f32_16x16x32_bf16 v[32:35], v[64:67], v[96:99], 0
    v_mfma_f32_16x16x32_bf16 v[36:39], v[68:71], v[96:99], 0
    v_mfma_f32_16x16x32_bf16 v[40:43], v[72:75], v[96:99], 0
    v_mfma_f32_16x16x32_bf16 v[44:47], v[76:79], v[96:99], 0
    v_mfma_f32_16x16x32_bf16 v[48:51], v[80:83], v[96:99], 0
    v_mfma_f32_16x16x32_bf16 v[52:55], v[84:87], v[96:99], 0
    v_mfma_f32_16x16x32_bf16 v[56:59], v[88:91], v[96:99], 0
    v_mfma_f32_16x16x32_bf16 v[60:63], v[92:95], v[96:99], 0
    v_mfma_f32_16x16x32_bf16 v[32:35], v[224:227], v[96:99], v[32:35]
    s_waitcnt lgkmcnt(0)
    ds_read_b64 v[128:129], v228 offset:64
    v_mfma_f32_16x16x32_bf16 v[36:39], v[64:67], v[100:103], v[36:39]
    ds_read_b64 v[130:131], v228 offset:72
    v_mfma_f32_16x16x32_bf16 v[40:43], v[68:71], v[100:103], v[40:43]
    ds_read_b128 v[160:163], v229 offset:3648
    v_mfma_f32_16x16x32_bf16 v[44:47], v[72:75], v[100:103], v[44:47]
    ds_read_b64 v[132:133], v228 offset:576
    v_mfma_f32_16x16x32_bf16 v[48:51], v[76:79], v[100:103], v[48:51]
    ds_read_b64 v[134:135], v228 offset:584
    v_mfma_f32_16x16x32_bf16 v[52:55], v[80:83], v[100:103], v[52:55]
    ds_read_b128 v[164:167], v229 offset:3136
    v_mfma_f32_16x16x32_bf16 v[56:59], v[84:87], v[100:103], v[56:59]
    ds_read_b64 v[136:137], v228 offset:1088
    v_mfma_f32_16x16x32_bf16 v[60:63], v[88:91], v[100:103], v[60:63]
    ds_read_b64 v[138:139], v228 offset:1096
    v_mfma_f32_16x16x32_bf16 v[36:39], v[224:227], v[100:103], v[36:39]
    ds_read_b128 v[168:171], v229 offset:2624
    v_mfma_f32_16x16x32_bf16 v[40:43], v[64:67], v[104:107], v[40:43]
    ds_read_b64 v[140:141], v228 offset:1600
    v_mfma_f32_16x16x32_bf16 v[44:47], v[68:71], v[104:107], v[44:47]
    ds_read_b64 v[142:143], v228 offset:1608
    v_mfma_f32_16x16x32_bf16 v[48:51], v[72:75], v[104:107], v[48:51]
    ds_read_b128 v[172:175], v229 offset:2112
    v_mfma_f32_16x16x32_bf16 v[52:55], v[76:79], v[104:107], v[52:55]
    ds_read_b64 v[144:145], v228 offset:2112
    v_mfma_f32_16x16x32_bf16 v[56:59], v[80:83], v[104:107], v[56:59]
    ds_read_b64 v[146:147], v228 offset:2120
    v_mfma_f32_16x16x32_bf16 v[60:63], v[84:87], v[104:107], v[60:63]
    ds_read_b128 v[176:179], v229 offset:1600
    v_mfma_f32_16x16x32_bf16 v[40:43], v[224:227], v[104:107], v[40:43]
    ds_read_b64 v[148:149], v228 offset:2624
    v_mfma_f32_16x16x32_bf16 v[44:47], v[64:67], v[108:111], v[44:47]
    ds_read_b64 v[150:151], v228 offset:2632
    v_mfma_f32_16x16x32_bf16 v[48:51], v[68:71], v[108:111], v[48:51]
    ds_read_b128 v[180:183], v229 offset:1088
    v_mfma_f32_16x16x32_bf16 v[52:55], v[72:75], v[108:111], v[52:55]
    ds_read_b64 v[152:153], v228 offset:3136
    v_mfma_f32_16x16x32_bf16 v[56:59], v[76:79], v[108:111], v[56:59]
    ds_read_b64 v[154:155], v228 offset:3144
    v_mfma_f32_16x16x32_bf16 v[60:63], v[80:83], v[108:111], v[60:63]
    ds_read_b128 v[184:187], v229 offset:576
    v_mfma_f32_16x16x32_bf16 v[44:47], v[224:227], v[108:111], v[44:47]
    ds_read_b64 v[156:157], v228 offset:3648
    v_mfma_f32_16x16x32_bf16 v[48:51], v[64:67], v[112:115], v[48:51]
    ds_read_b64 v[158:159], v228 offset:3656
    v_mfma_f32_16x16x32_bf16 v[52:55], v[68:71], v[112:115], v[52:55]
    ds_read_b128 v[188:191], v229 offset:64
    v_mfma_f32_16x16x32_bf16 v[56:59], v[72:75], v[112:115], v[56:59]
    v_mfma_f32_16x16x32_bf16 v[60:63], v[76:79], v[112:115], v[60:63]
    v_mfma_f32_16x16x32_bf16 v[48:51], v[224:227], v[112:115], v[48:51]
    v_mfma_f32_16x16x32_bf16 v[52:55], v[64:67], v[116:119], v[52:55]
    v_mfma_f32_16x16x32_bf16 v[56:59], v[68:71], v[116:119], v[56:59]
    v_mfma_f32_16x16x32_bf16 v[60:63], v[72:75], v[116:119], v[60:63]
    v_mfma_f32_16x16x32_bf16 v[52:55], v[224:227], v[116:119], v[52:55]
    v_mfma_f32_16x16x32_bf16 v[56:59], v[64:67], v[120:123], v[56:59]
    v_mfma_f32_16x16x32_bf16 v[60:63], v[68:71], v[120:123], v[60:63]
    v_mfma_f32_16x16x32_bf16 v[56:59], v[224:227], v[120:123], v[56:59]
    v_mfma_f32_16x16x32_bf16 v[60:63], v[64:67], v[124:127], v[60:63]
    v_mfma_f32_16x16x32_bf16 v[60:63], v[224:227], v[124:127], v[60:63]
    s_waitcnt lgkmcnt(0)
    v_mfma_f32_16x16x32_bf16 v[32:35], v[128:131], v[160:163], v[32:35]
    ds_read_b64 v[64:65], v228 offset:128
    v_mfma_f32_16x16x32_bf16 v[36:39], v[128:131], v[164:167], v[36:39]
    ds_read_b64 v[66:67], v228 offset:136
    v_mfma_f32_16x16x32_bf16 v[36:39], v[132:135], v[160:163], v[36:39]
    ds_read_b128 v[96:99], v229 offset:3712
    v_mfma_f32_16x16x32_bf16 v[40:43], v[132:135], v[164:167], v[40:43]
    ds_read_b64 v[68:69], v228 offset:640
    v_mfma_f32_16x16x32_bf16 v[40:43], v[128:131], v[168:171], v[40:43]
    ds_read_b64 v[70:71], v228 offset:648
    v_mfma_f32_16x16x32_bf16 v[44:47], v[132:135], v[168:171], v[44:47]
    ds_read_b128 v[100:103], v229 offset:3200
    v_mfma_f32_16x16x32_bf16 v[40:43], v[136:139], v[160:163], v[40:43]
    ds_read_b64 v[72:73], v228 offset:1152
    v_mfma_f32_16x16x32_bf16 v[44:47], v[136:139], v[164:167], v[44:47]
    ds_read_b64 v[74:75], v228 offset:1160
    v_mfma_f32_16x16x32_bf16 v[48:51], v[136:139], v[168:171], v[48:51]
    ds_read_b128 v[104:107], v229 offset:2688
    v_mfma_f32_16x16x32_bf16 v[44:47], v[128:131], v[172:175], v[44:47]
    ds_read_b64 v[76:77], v228 offset:1664
    v_mfma_f32_16x16x32_bf16 v[48:51], v[132:135], v[172:175], v[48:51]
    ds_read_b64 v[78:79], v228 offset:1672
    v_mfma_f32_16x16x32_bf16 v[52:55], v[136:139], v[172:175], v[52:55]
    ds_read_b128 v[108:111], v229 offset:2176
    v_mfma_f32_16x16x32_bf16 v[44:47], v[140:143], v[160:163], v[44:47]
    ds_read_b64 v[80:81], v228 offset:2176
    v_mfma_f32_16x16x32_bf16 v[48:51], v[140:143], v[164:167], v[48:51]
    ds_read_b64 v[82:83], v228 offset:2184
    v_mfma_f32_16x16x32_bf16 v[52:55], v[140:143], v[168:171], v[52:55]
    ds_read_b128 v[112:115], v229 offset:1664
    v_mfma_f32_16x16x32_bf16 v[56:59], v[140:143], v[172:175], v[56:59]
    ds_read_b64 v[84:85], v228 offset:2688
    v_mfma_f32_16x16x32_bf16 v[48:51], v[128:131], v[176:179], v[48:51]
    ds_read_b64 v[86:87], v228 offset:2696
    v_mfma_f32_16x16x32_bf16 v[52:55], v[132:135], v[176:179], v[52:55]
    ds_read_b128 v[116:119], v229 offset:1152
    v_mfma_f32_16x16x32_bf16 v[56:59], v[136:139], v[176:179], v[56:59]
    ds_read_b64 v[88:89], v228 offset:3200
    v_mfma_f32_16x16x32_bf16 v[60:63], v[140:143], v[176:179], v[60:63]
    ds_read_b64 v[90:91], v228 offset:3208
    v_mfma_f32_16x16x32_bf16 v[48:51], v[144:147], v[160:163], v[48:51]
    ds_read_b128 v[120:123], v229 offset:640
    v_mfma_f32_16x16x32_bf16 v[52:55], v[144:147], v[164:167], v[52:55]
    ds_read_b64 v[92:93], v228 offset:3712
    v_mfma_f32_16x16x32_bf16 v[56:59], v[144:147], v[168:171], v[56:59]
    ds_read_b64 v[94:95], v228 offset:3720
    v_mfma_f32_16x16x32_bf16 v[60:63], v[144:147], v[172:175], v[60:63]
    ds_read_b128 v[124:127], v229 offset:128
    v_mfma_f32_16x16x32_bf16 v[52:55], v[128:131], v[180:183], v[52:55]
    v_mfma_f32_16x16x32_bf16 v[56:59], v[132:135], v[180:183], v[56:59]
    v_mfma_f32_16x16x32_bf16 v[60:63], v[136:139], v[180:183], v[60:63]
    v_mfma_f32_16x16x32_bf16 v[52:55], v[148:151], v[160:163], v[52:55]
    v_mfma_f32_16x16x32_bf16 v[56:59], v[148:151], v[164:167], v[56:59]
    v_mfma_f32_16x16x32_bf16 v[60:63], v[148:151], v[168:171], v[60:63]
    v_mfma_f32_16x16x32_bf16 v[56:59], v[128:131], v[184:187], v[56:59]
    v_mfma_f32_16x16x32_bf16 v[60:63], v[132:135], v[184:187], v[60:63]
    v_mfma_f32_16x16x32_bf16 v[56:59], v[152:155], v[160:163], v[56:59]
    v_mfma_f32_16x16x32_bf16 v[60:63], v[152:155], v[164:167], v[60:63]
    v_mfma_f32_16x16x32_bf16 v[60:63], v[128:131], v[188:191], v[60:63]
    v_mfma_f32_16x16x32_bf16 v[60:63], v[156:159], v[160:163], v[60:63]
    s_waitcnt lgkmcnt(0)
    v_mfma_f32_16x16x32_bf16 v[32:35], v[64:67], v[96:99], v[32:35]
    ds_read_b64 v[128:129], v228 offset:192
    v_mfma_f32_16x16x32_bf16 v[36:39], v[64:67], v[100:103], v[36:39]
    ds_read_b64 v[130:131], v228 offset:200
    v_mfma_f32_16x16x32_bf16 v[36:39], v[68:71], v[96:99], v[36:39]
    ds_read_b128 v[160:163], v229 offset:3776
    v_mfma_f32_16x16x32_bf16 v[40:43], v[68:71], v[100:103], v[40:43]
    ds_read_b64 v[132:133], v228 offset:704
    v_mfma_f32_16x16x32_bf16 v[40:43], v[64:67], v[104:107], v[40:43]
    ds_read_b64 v[134:135], v228 offset:712
    v_mfma_f32_16x16x32_bf16 v[44:47], v[68:71], v[104:107], v[44:47]
    ds_read_b128 v[164:167], v229 offset:3264
    v_mfma_f32_16x16x32_bf16 v[40:43], v[72:75], v[96:99], v[40:43]
    ds_read_b64 v[136:137], v228 offset:1216
    v_mfma_f32_16x16x32_bf16 v[44:47], v[72:75], v[100:103], v[44:47]
    ds_read_b64 v[138:139], v228 offset:1224
    v_mfma_f32_16x16x32_bf16 v[48:51], v[72:75], v[104:107], v[48:51]
    ds_read_b128 v[168:171], v229 offset:2752
    v_mfma_f32_16x16x32_bf16 v[44:47], v[64:67], v[108:111], v[44:47]
    ds_read_b64 v[140:141], v228 offset:1728
    v_mfma_f32_16x16x32_bf16 v[48:51], v[68:71], v[108:111], v[48:51]
    ds_read_b64 v[142:143], v228 offset:1736
    v_mfma_f32_16x16x32_bf16 v[52:55], v[72:75], v[108:111], v[52:55]
    ds_read_b128 v[172:175], v229 offset:2240
    v_mfma_f32_16x16x32_bf16 v[44:47], v[76:79], v[96:99], v[44:47]
    ds_read_b64 v[144:145], v228 offset:2240
    v_mfma_f32_16x16x32_bf16 v[48:51], v[76:79], v[100:103], v[48:51]
    ds_read_b64 v[146:147], v228 offset:2248
    v_mfma_f32_16x16x32_bf16 v[52:55], v[76:79], v[104:107], v[52:55]
    ds_read_b128 v[176:179], v229 offset:1728
    v_mfma_f32_16x16x32_bf16 v[56:59], v[76:79], v[108:111], v[56:59]
    ds_read_b64 v[148:149], v228 offset:2752
    v_mfma_f32_16x16x32_bf16 v[48:51], v[64:67], v[112:115], v[48:51]
    ds_read_b64 v[150:151], v228 offset:2760
    v_mfma_f32_16x16x32_bf16 v[52:55], v[68:71], v[112:115], v[52:55]
    ds_read_b128 v[180:183], v229 offset:1216
    v_mfma_f32_16x16x32_bf16 v[56:59], v[72:75], v[112:115], v[56:59]
    ds_read_b64 v[152:153], v228 offset:3264
    v_mfma_f32_16x16x32_bf16 v[60:63], v[76:79], v[112:115], v[60:63]
    ds_read_b64 v[154:155], v228 offset:3272
    v_mfma_f32_16x16x32_bf16 v[48:51], v[80:83], v[96:99], v[48:51]
    ds_read_b128 v[184:187], v229 offset:704
    v_mfma_f32_16x16x32_bf16 v[52:55], v[80:83], v[100:103], v[52:55]
    ds_read_b64 v[156:157], v228 offset:3776
    v_mfma_f32_16x16x32_bf16 v[56:59], v[80:83], v[104:107], v[56:59]
    ds_read_b64 v[158:159], v228 offset:3784
    v_mfma_f32_16x16x32_bf16 v[60:63], v[80:83], v[108:111], v[60:63]
    ds_read_b128 v[188:191], v229 offset:192
    v_mfma_f32_16x16x32_bf16 v[52:55], v[64:67], v[116:119], v[52:55]
    v_mfma_f32_16x16x32_bf16 v[56:59], v[68:71], v[116:119], v[56:59]
    v_mfma_f32_16x16x32_bf16 v[60:63], v[72:75], v[116:119], v[60:63]
    v_mfma_f32_16x16x32_bf16 v[52:55], v[84:87], v[96:99], v[52:55]
    v_mfma_f32_16x16x32_bf16 v[56:59], v[84:87], v[100:103], v[56:59]
    v_mfma_f32_16x16x32_bf16 v[60:63], v[84:87], v[104:107], v[60:63]
    v_mfma_f32_16x16x32_bf16 v[56:59], v[64:67], v[120:123], v[56:59]
    v_mfma_f32_16x16x32_bf16 v[60:63], v[68:71], v[120:123], v[60:63]
    v_mfma_f32_16x16x32_bf16 v[56:59], v[88:91], v[96:99], v[56:59]
    v_mfma_f32_16x16x32_bf16 v[60:63], v[88:91], v[100:103], v[60:63]
    v_mfma_f32_16x16x32_bf16 v[60:63], v[64:67], v[124:127], v[60:63]
    v_mfma_f32_16x16x32_bf16 v[60:63], v[92:95], v[96:99], v[60:63]
    s_waitcnt lgkmcnt(0)
    v_mfma_f32_16x16x32_bf16 v[32:35], v[128:131], v[160:163], v[32:35]
    ds_read_b64 v[64:65], v228 offset:256
    v_mfma_f32_16x16x32_bf16 v[36:39], v[128:131], v[164:167], v[36:39]
    ds_read_b64 v[66:67], v228 offset:264
    v_mfma_f32_16x16x32_bf16 v[36:39], v[132:135], v[160:163], v[36:39]
    ds_read_b128 v[96:99], v229 offset:3840
    v_mfma_f32_16x16x32_bf16 v[40:43], v[132:135], v[164:167], v[40:43]
    ds_read_b64 v[68:69], v228 offset:768
    v_mfma_f32_16x16x32_bf16 v[40:43], v[128:131], v[168:171], v[40:43]
    ds_read_b64 v[70:71], v228 offset:776
    v_mfma_f32_16x16x32_bf16 v[44:47], v[132:135], v[168:171], v[44:47]
    ds_read_b128 v[100:103], v229 offset:3328
    v_mfma_f32_16x16x32_bf16 v[40:43], v[136:139], v[160:163], v[40:43]
    ds_read_b64 v[72:73], v228 offset:1280
    v_mfma_f32_16x16x32_bf16 v[44:47], v[136:139], v[164:167], v[44:47]
    ds_read_b64 v[74:75], v228 offset:1288
    v_mfma_f32_16x16x32_bf16 v[48:51], v[136:139], v[168:171], v[48:51]
    ds_read_b128 v[104:107], v229 offset:2816
    v_mfma_f32_16x16x32_bf16 v[44:47], v[128:131], v[172:175], v[44:47]
    ds_read_b64 v[76:77], v228 offset:1792
    v_mfma_f32_16x16x32_bf16 v[48:51], v[132:135], v[172:175], v[48:51]
    ds_read_b64 v[78:79], v228 offset:1800
    v_mfma_f32_16x16x32_bf16 v[52:55], v[136:139], v[172:175], v[52:55]
    ds_read_b128 v[108:111], v229 offset:2304
    v_mfma_f32_16x16x32_bf16 v[44:47], v[140:143], v[160:163], v[44:47]
    ds_read_b64 v[80:81], v228 offset:2304
    v_mfma_f32_16x16x32_bf16 v[48:51], v[140:143], v[164:167], v[48:51]
    ds_read_b64 v[82:83], v228 offset:2312
    v_mfma_f32_16x16x32_bf16 v[52:55], v[140:143], v[168:171], v[52:55]
    ds_read_b128 v[112:115], v229 offset:1792
    v_mfma_f32_16x16x32_bf16 v[56:59], v[140:143], v[172:175], v[56:59]
    ds_read_b64 v[84:85], v228 offset:2816
    v_mfma_f32_16x16x32_bf16 v[48:51], v[128:131], v[176:179], v[48:51]
    ds_read_b64 v[86:87], v228 offset:2824
    v_mfma_f32_16x16x32_bf16 v[52:55], v[132:135], v[176:179], v[52:55]
    ds_read_b128 v[116:119], v229 offset:1280
    v_mfma_f32_16x16x32_bf16 v[56:59], v[136:139], v[176:179], v[56:59]
    ds_read_b64 v[88:89], v228 offset:3328
    v_mfma_f32_16x16x32_bf16 v[60:63], v[140:143], v[176:179], v[60:63]
    ds_read_b64 v[90:91], v228 offset:3336
    v_mfma_f32_16x16x32_bf16 v[48:51], v[144:147], v[160:163], v[48:51]
    ds_read_b128 v[120:123], v229 offset:768
    v_mfma_f32_16x16x32_bf16 v[52:55], v[144:147], v[164:167], v[52:55]
    ds_read_b64 v[92:93], v228 offset:3840
    v_mfma_f32_16x16x32_bf16 v[56:59], v[144:147], v[168:171], v[56:59]
    ds_read_b64 v[94:95], v228 offset:3848
    v_mfma_f32_16x16x32_bf16 v[60:63], v[144:147], v[172:175], v[60:63]
    ds_read_b128 v[124:127], v229 offset:256
    v_mfma_f32_16x16x32_bf16 v[52:55], v[128:131], v[180:183], v[52:55]
    v_mfma_f32_16x16x32_bf16 v[56:59], v[132:135], v[180:183], v[56:59]
    v_mfma_f32_16x16x32_bf16 v[60:63], v[136:139], v[180:183], v[60:63]
    v_mfma_f32_16x16x32_bf16 v[52:55], v[148:151], v[160:163], v[52:55]
    v_mfma_f32_16x16x32_bf16 v[56:59], v[148:151], v[164:167], v[56:59]
    v_mfma_f32_16x16x32_bf16 v[60:63], v[148:151], v[168:171], v[60:63]
    v_mfma_f32_16x16x32_bf16 v[56:59], v[128:131], v[184:187], v[56:59]
    v_mfma_f32_16x16x32_bf16 v[60:63], v[132:135], v[184:187], v[60:63]
    v_mfma_f32_16x16x32_bf16 v[56:59], v[152:155], v[160:163], v[56:59]
    v_mfma_f32_16x16x32_bf16 v[60:63], v[152:155], v[164:167], v[60:63]
    v_mfma_f32_16x16x32_bf16 v[60:63], v[128:131], v[188:191], v[60:63]
    v_mfma_f32_16x16x32_bf16 v[60:63], v[156:159], v[160:163], v[60:63]
    s_waitcnt lgkmcnt(0)
    v_mfma_f32_16x16x32_bf16 v[32:35], v[64:67], v[96:99], v[32:35]
    ds_read_b64 v[128:129], v228 offset:320
    v_mfma_f32_16x16x32_bf16 v[36:39], v[64:67], v[100:103], v[36:39]
    ds_read_b64 v[130:131], v228 offset:328
    v_mfma_f32_16x16x32_bf16 v[36:39], v[68:71], v[96:99], v[36:39]
    ds_read_b128 v[160:163], v229 offset:3904
    v_mfma_f32_16x16x32_bf16 v[40:43], v[68:71], v[100:103], v[40:43]
    ds_read_b64 v[132:133], v228 offset:832
    v_mfma_f32_16x16x32_bf16 v[40:43], v[64:67], v[104:107], v[40:43]
    ds_read_b64 v[134:135], v228 offset:840
    v_mfma_f32_16x16x32_bf16 v[44:47], v[68:71], v[104:107], v[44:47]
    ds_read_b128 v[164:167], v229 offset:3392
    v_mfma_f32_16x16x32_bf16 v[40:43], v[72:75], v[96:99], v[40:43]
    ds_read_b64 v[136:137], v228 offset:1344
    v_mfma_f32_16x16x32_bf16 v[44:47], v[72:75], v[100:103], v[44:47]
    ds_read_b64 v[138:139], v228 offset:1352
    v_mfma_f32_16x16x32_bf16 v[48:51], v[72:75], v[104:107], v[48:51]
    ds_read_b128 v[168:171], v229 offset:2880
    v_mfma_f32_16x16x32_bf16 v[44:47], v[64:67], v[108:111], v[44:47]
    ds_read_b64 v[140:141], v228 offset:1856
    v_mfma_f32_16x16x32_bf16 v[48:51], v[68:71], v[108:111], v[48:51]
    ds_read_b64 v[142:143], v228 offset:1864
    v_mfma_f32_16x16x32_bf16 v[52:55], v[72:75], v[108:111], v[52:55]
    ds_read_b128 v[172:175], v229 offset:2368
    v_mfma_f32_16x16x32_bf16 v[44:47], v[76:79], v[96:99], v[44:47]
    ds_read_b64 v[144:145], v228 offset:2368
    v_mfma_f32_16x16x32_bf16 v[48:51], v[76:79], v[100:103], v[48:51]
    ds_read_b64 v[146:147], v228 offset:2376
    v_mfma_f32_16x16x32_bf16 v[52:55], v[76:79], v[104:107], v[52:55]
    ds_read_b128 v[176:179], v229 offset:1856
    v_mfma_f32_16x16x32_bf16 v[56:59], v[76:79], v[108:111], v[56:59]
    ds_read_b64 v[148:149], v228 offset:2880
    v_mfma_f32_16x16x32_bf16 v[48:51], v[64:67], v[112:115], v[48:51]
    ds_read_b64 v[150:151], v228 offset:2888
    v_mfma_f32_16x16x32_bf16 v[52:55], v[68:71], v[112:115], v[52:55]
    ds_read_b128 v[180:183], v229 offset:1344
    v_mfma_f32_16x16x32_bf16 v[56:59], v[72:75], v[112:115], v[56:59]
    ds_read_b64 v[152:153], v228 offset:3392
    v_mfma_f32_16x16x32_bf16 v[60:63], v[76:79], v[112:115], v[60:63]
    ds_read_b64 v[154:155], v228 offset:3400
    v_mfma_f32_16x16x32_bf16 v[48:51], v[80:83], v[96:99], v[48:51]
    ds_read_b128 v[184:187], v229 offset:832
    v_mfma_f32_16x16x32_bf16 v[52:55], v[80:83], v[100:103], v[52:55]
    ds_read_b64 v[156:157], v228 offset:3904
    v_mfma_f32_16x16x32_bf16 v[56:59], v[80:83], v[104:107], v[56:59]
    ds_read_b64 v[158:159], v228 offset:3912
    v_mfma_f32_16x16x32_bf16 v[60:63], v[80:83], v[108:111], v[60:63]
    ds_read_b128 v[188:191], v229 offset:320
    v_mfma_f32_16x16x32_bf16 v[52:55], v[64:67], v[116:119], v[52:55]
    v_mfma_f32_16x16x32_bf16 v[56:59], v[68:71], v[116:119], v[56:59]
    v_mfma_f32_16x16x32_bf16 v[60:63], v[72:75], v[116:119], v[60:63]
    v_mfma_f32_16x16x32_bf16 v[52:55], v[84:87], v[96:99], v[52:55]
    v_mfma_f32_16x16x32_bf16 v[56:59], v[84:87], v[100:103], v[56:59]
    v_mfma_f32_16x16x32_bf16 v[60:63], v[84:87], v[104:107], v[60:63]
    v_mfma_f32_16x16x32_bf16 v[56:59], v[64:67], v[120:123], v[56:59]
    v_mfma_f32_16x16x32_bf16 v[60:63], v[68:71], v[120:123], v[60:63]
    v_mfma_f32_16x16x32_bf16 v[56:59], v[88:91], v[96:99], v[56:59]
    v_mfma_f32_16x16x32_bf16 v[60:63], v[88:91], v[100:103], v[60:63]
    v_mfma_f32_16x16x32_bf16 v[60:63], v[64:67], v[124:127], v[60:63]
    v_mfma_f32_16x16x32_bf16 v[60:63], v[92:95], v[96:99], v[60:63]
    s_waitcnt lgkmcnt(0)
    v_mfma_f32_16x16x32_bf16 v[32:35], v[128:131], v[160:163], v[32:35]
    ds_read_b64 v[64:65], v228 offset:384
    v_mfma_f32_16x16x32_bf16 v[36:39], v[128:131], v[164:167], v[36:39]
    ds_read_b64 v[66:67], v228 offset:392
    v_mfma_f32_16x16x32_bf16 v[36:39], v[132:135], v[160:163], v[36:39]
    ds_read_b128 v[96:99], v229 offset:3968
    v_mfma_f32_16x16x32_bf16 v[40:43], v[132:135], v[164:167], v[40:43]
    ds_read_b64 v[68:69], v228 offset:896
    v_mfma_f32_16x16x32_bf16 v[40:43], v[128:131], v[168:171], v[40:43]
    ds_read_b64 v[70:71], v228 offset:904
    v_mfma_f32_16x16x32_bf16 v[44:47], v[132:135], v[168:171], v[44:47]
    ds_read_b128 v[100:103], v229 offset:3456
    v_mfma_f32_16x16x32_bf16 v[40:43], v[136:139], v[160:163], v[40:43]
    ds_read_b64 v[72:73], v228 offset:1408
    v_mfma_f32_16x16x32_bf16 v[44:47], v[136:139], v[164:167], v[44:47]
    ds_read_b64 v[74:75], v228 offset:1416
    v_mfma_f32_16x16x32_bf16 v[48:51], v[136:139], v[168:171], v[48:51]
    ds_read_b128 v[104:107], v229 offset:2944
    v_mfma_f32_16x16x32_bf16 v[44:47], v[128:131], v[172:175], v[44:47]
    ds_read_b64 v[76:77], v228 offset:1920
    v_mfma_f32_16x16x32_bf16 v[48:51], v[132:135], v[172:175], v[48:51]
    ds_read_b64 v[78:79], v228 offset:1928
    v_mfma_f32_16x16x32_bf16 v[52:55], v[136:139], v[172:175], v[52:55]
    ds_read_b128 v[108:111], v229 offset:2432
    v_mfma_f32_16x16x32_bf16 v[44:47], v[140:143], v[160:163], v[44:47]
    ds_read_b64 v[80:81], v228 offset:2432
    v_mfma_f32_16x16x32_bf16 v[48:51], v[140:143], v[164:167], v[48:51]
    ds_read_b64 v[82:83], v228 offset:2440
    v_mfma_f32_16x16x32_bf16 v[52:55], v[140:143], v[168:171], v[52:55]
    ds_read_b128 v[112:115], v229 offset:1920
    v_mfma_f32_16x16x32_bf16 v[56:59], v[140:143], v[172:175], v[56:59]
    ds_read_b64 v[84:85], v228 offset:2944
    v_mfma_f32_16x16x32_bf16 v[48:51], v[128:131], v[176:179], v[48:51]
    ds_read_b64 v[86:87], v228 offset:2952
    v_mfma_f32_16x16x32_bf16 v[52:55], v[132:135], v[176:179], v[52:55]
    ds_read_b128 v[116:119], v229 offset:1408
    v_mfma_f32_16x16x32_bf16 v[56:59], v[136:139], v[176:179], v[56:59]
    ds_read_b64 v[88:89], v228 offset:3456
    v_mfma_f32_16x16x32_bf16 v[60:63], v[140:143], v[176:179], v[60:63]
    ds_read_b64 v[90:91], v228 offset:3464
    v_mfma_f32_16x16x32_bf16 v[48:51], v[144:147], v[160:163], v[48:51]
    ds_read_b128 v[120:123], v229 offset:896
    v_mfma_f32_16x16x32_bf16 v[52:55], v[144:147], v[164:167], v[52:55]
    ds_read_b64 v[92:93], v228 offset:3968
    v_mfma_f32_16x16x32_bf16 v[56:59], v[144:147], v[168:171], v[56:59]
    ds_read_b64 v[94:95], v228 offset:3976
    v_mfma_f32_16x16x32_bf16 v[60:63], v[144:147], v[172:175], v[60:63]
    ds_read_b128 v[124:127], v229 offset:384
    v_mfma_f32_16x16x32_bf16 v[52:55], v[128:131], v[180:183], v[52:55]
    v_mfma_f32_16x16x32_bf16 v[56:59], v[132:135], v[180:183], v[56:59]
    v_mfma_f32_16x16x32_bf16 v[60:63], v[136:139], v[180:183], v[60:63]
    v_mfma_f32_16x16x32_bf16 v[52:55], v[148:151], v[160:163], v[52:55]
    v_mfma_f32_16x16x32_bf16 v[56:59], v[148:151], v[164:167], v[56:59]
    v_mfma_f32_16x16x32_bf16 v[60:63], v[148:151], v[168:171], v[60:63]
    v_mfma_f32_16x16x32_bf16 v[56:59], v[128:131], v[184:187], v[56:59]
    v_mfma_f32_16x16x32_bf16 v[60:63], v[132:135], v[184:187], v[60:63]
    v_mfma_f32_16x16x32_bf16 v[56:59], v[152:155], v[160:163], v[56:59]
    v_mfma_f32_16x16x32_bf16 v[60:63], v[152:155], v[164:167], v[60:63]
    v_mfma_f32_16x16x32_bf16 v[60:63], v[128:131], v[188:191], v[60:63]
    v_mfma_f32_16x16x32_bf16 v[60:63], v[156:159], v[160:163], v[60:63]
    s_waitcnt lgkmcnt(0)
    v_mfma_f32_16x16x32_bf16 v[32:35], v[64:67], v[96:99], v[32:35]
    ds_read_b64 v[128:129], v228 offset:448
    v_mfma_f32_16x16x32_bf16 v[36:39], v[64:67], v[100:103], v[36:39]
    ds_read_b64 v[130:131], v228 offset:456
    v_mfma_f32_16x16x32_bf16 v[36:39], v[68:71], v[96:99], v[36:39]
    ds_read_b128 v[160:163], v229 offset:4032
    v_mfma_f32_16x16x32_bf16 v[40:43], v[68:71], v[100:103], v[40:43]
    ds_read_b64 v[132:133], v228 offset:960
    v_mfma_f32_16x16x32_bf16 v[40:43], v[64:67], v[104:107], v[40:43]
    ds_read_b64 v[134:135], v228 offset:968
    v_mfma_f32_16x16x32_bf16 v[44:47], v[68:71], v[104:107], v[44:47]
    ds_read_b128 v[164:167], v229 offset:3520
    v_mfma_f32_16x16x32_bf16 v[40:43], v[72:75], v[96:99], v[40:43]
    ds_read_b64 v[136:137], v228 offset:1472
    v_mfma_f32_16x16x32_bf16 v[44:47], v[72:75], v[100:103], v[44:47]
    ds_read_b64 v[138:139], v228 offset:1480
    v_mfma_f32_16x16x32_bf16 v[48:51], v[72:75], v[104:107], v[48:51]
    ds_read_b128 v[168:171], v229 offset:3008
    v_mfma_f32_16x16x32_bf16 v[44:47], v[64:67], v[108:111], v[44:47]
    ds_read_b64 v[140:141], v228 offset:1984
    v_mfma_f32_16x16x32_bf16 v[48:51], v[68:71], v[108:111], v[48:51]
    ds_read_b64 v[142:143], v228 offset:1992
    v_mfma_f32_16x16x32_bf16 v[52:55], v[72:75], v[108:111], v[52:55]
    ds_read_b128 v[172:175], v229 offset:2496
    v_mfma_f32_16x16x32_bf16 v[44:47], v[76:79], v[96:99], v[44:47]
    ds_read_b64 v[144:145], v228 offset:2496
    v_mfma_f32_16x16x32_bf16 v[48:51], v[76:79], v[100:103], v[48:51]
    ds_read_b64 v[146:147], v228 offset:2504
    v_mfma_f32_16x16x32_bf16 v[52:55], v[76:79], v[104:107], v[52:55]
    ds_read_b128 v[176:179], v229 offset:1984
    v_mfma_f32_16x16x32_bf16 v[56:59], v[76:79], v[108:111], v[56:59]
    ds_read_b64 v[148:149], v228 offset:3008
    v_mfma_f32_16x16x32_bf16 v[48:51], v[64:67], v[112:115], v[48:51]
    ds_read_b64 v[150:151], v228 offset:3016
    v_mfma_f32_16x16x32_bf16 v[52:55], v[68:71], v[112:115], v[52:55]
    ds_read_b128 v[180:183], v229 offset:1472
    v_mfma_f32_16x16x32_bf16 v[56:59], v[72:75], v[112:115], v[56:59]
    ds_read_b64 v[152:153], v228 offset:3520
    v_mfma_f32_16x16x32_bf16 v[60:63], v[76:79], v[112:115], v[60:63]
    ds_read_b64 v[154:155], v228 offset:3528
    v_mfma_f32_16x16x32_bf16 v[48:51], v[80:83], v[96:99], v[48:51]
    ds_read_b128 v[184:187], v229 offset:960
    v_mfma_f32_16x16x32_bf16 v[52:55], v[80:83], v[100:103], v[52:55]
    ds_read_b64 v[156:157], v228 offset:4032
    v_mfma_f32_16x16x32_bf16 v[56:59], v[80:83], v[104:107], v[56:59]
    ds_read_b64 v[158:159], v228 offset:4040
    v_mfma_f32_16x16x32_bf16 v[60:63], v[80:83], v[108:111], v[60:63]
    ds_read_b128 v[188:191], v229 offset:448
    v_mfma_f32_16x16x32_bf16 v[52:55], v[64:67], v[116:119], v[52:55]
    v_mfma_f32_16x16x32_bf16 v[56:59], v[68:71], v[116:119], v[56:59]
    v_mfma_f32_16x16x32_bf16 v[60:63], v[72:75], v[116:119], v[60:63]
    v_mfma_f32_16x16x32_bf16 v[52:55], v[84:87], v[96:99], v[52:55]
    v_mfma_f32_16x16x32_bf16 v[56:59], v[84:87], v[100:103], v[56:59]
    v_mfma_f32_16x16x32_bf16 v[60:63], v[84:87], v[104:107], v[60:63]
    v_mfma_f32_16x16x32_bf16 v[56:59], v[64:67], v[120:123], v[56:59]
    v_mfma_f32_16x16x32_bf16 v[60:63], v[68:71], v[120:123], v[60:63]
    v_mfma_f32_16x16x32_bf16 v[56:59], v[88:91], v[96:99], v[56:59]
    v_mfma_f32_16x16x32_bf16 v[60:63], v[88:91], v[100:103], v[60:63]
    v_mfma_f32_16x16x32_bf16 v[60:63], v[64:67], v[124:127], v[60:63]
    v_mfma_f32_16x16x32_bf16 v[60:63], v[92:95], v[96:99], v[60:63]
    s_waitcnt lgkmcnt(0)
    v_mfma_f32_16x16x32_bf16 v[32:35], v[128:131], v[160:163], v[32:35]
    v_mfma_f32_16x16x32_bf16 v[36:39], v[128:131], v[164:167], v[36:39]
    v_mfma_f32_16x16x32_bf16 v[36:39], v[132:135], v[160:163], v[36:39]
    v_mfma_f32_16x16x32_bf16 v[40:43], v[132:135], v[164:167], v[40:43]
    v_mfma_f32_16x16x32_bf16 v[40:43], v[128:131], v[168:171], v[40:43]
    v_mfma_f32_16x16x32_bf16 v[44:47], v[132:135], v[168:171], v[44:47]
    v_mfma_f32_16x16x32_bf16 v[40:43], v[136:139], v[160:163], v[40:43]
    v_mfma_f32_16x16x32_bf16 v[44:47], v[136:139], v[164:167], v[44:47]
    v_mfma_f32_16x16x32_bf16 v[48:51], v[136:139], v[168:171], v[48:51]
    v_mfma_f32_16x16x32_bf16 v[44:47], v[128:131], v[172:175], v[44:47]
    v_mfma_f32_16x16x32_bf16 v[48:51], v[132:135], v[172:175], v[48:51]
    v_mfma_f32_16x16x32_bf16 v[52:55], v[136:139], v[172:175], v[52:55]
    v_mfma_f32_16x16x32_bf16 v[44:47], v[140:143], v[160:163], v[44:47]
    v_mfma_f32_16x16x32_bf16 v[48:51], v[140:143], v[164:167], v[48:51]
    v_mfma_f32_16x16x32_bf16 v[52:55], v[140:143], v[168:171], v[52:55]
    v_mfma_f32_16x16x32_bf16 v[56:59], v[140:143], v[172:175], v[56:59]
    v_mfma_f32_16x16x32_bf16 v[48:51], v[128:131], v[176:179], v[48:51]
    v_mfma_f32_16x16x32_bf16 v[52:55], v[132:135], v[176:179], v[52:55]
    v_mfma_f32_16x16x32_bf16 v[56:59], v[136:139], v[176:179], v[56:59]
    v_mfma_f32_16x16x32_bf16 v[60:63], v[140:143], v[176:179], v[60:63]
    v_mfma_f32_16x16x32_bf16 v[48:51], v[144:147], v[160:163], v[48:51]
    v_mfma_f32_16x16x32_bf16 v[52:55], v[144:147], v[164:167], v[52:55]
    v_mfma_f32_16x16x32_bf16 v[56:59], v[144:147], v[168:171], v[56:59]
    v_mfma_f32_16x16x32_bf16 v[60:63], v[144:147], v[172:175], v[60:63]
    v_mfma_f32_16x16x32_bf16 v[52:55], v[128:131], v[180:183], v[52:55]
    v_mfma_f32_16x16x32_bf16 v[56:59], v[132:135], v[180:183], v[56:59]
    v_mfma_f32_16x16x32_bf16 v[60:63], v[136:139], v[180:183], v[60:63]
    v_mfma_f32_16x16x32_bf16 v[52:55], v[148:151], v[160:163], v[52:55]
    v_mfma_f32_16x16x32_bf16 v[56:59], v[148:151], v[164:167], v[56:59]
    v_mfma_f32_16x16x32_bf16 v[60:63], v[148:151], v[168:171], v[60:63]
    v_mfma_f32_16x16x32_bf16 v[56:59], v[128:131], v[184:187], v[56:59]
    v_mfma_f32_16x16x32_bf16 v[60:63], v[132:135], v[184:187], v[60:63]
    v_mfma_f32_16x16x32_bf16 v[56:59], v[152:155], v[160:163], v[56:59]
    v_mfma_f32_16x16x32_bf16 v[60:63], v[152:155], v[164:167], v[60:63]
    v_mfma_f32_16x16x32_bf16 v[60:63], v[128:131], v[188:191], v[60:63]
    v_mfma_f32_16x16x32_bf16 v[60:63], v[156:159], v[160:163], v[60:63]
    s_lshl_b32 s37, s47, 1
    s_add_u32 s37, s37, 44040192
    v_and_b32 v10, 1, v0
    v_cmp_eq_u32 vcc, 1, v10
    v_mov_b32 v11, s50
    v_mov_b32 v12, s51
    v_cndmask_b32 v11, v11, v12, vcc
    v_lshrrev_b32 v233, 1, v0
    v_lshlrev_b32 v233, 2, v233
    v_add_u32 v234, 42496, v233
    v_cvt_pk_bf16_f32 v64, v32, v33
    v_cvt_pk_bf16_f32 v65, v34, v35
    ds_write_b64 v232, v[64:65] offset:0
    v_cvt_pk_bf16_f32 v66, v36, v37
    v_cvt_pk_bf16_f32 v67, v38, v39
    ds_write_b64 v232, v[66:67] offset:512
    v_cvt_pk_bf16_f32 v68, v40, v41
    v_cvt_pk_bf16_f32 v69, v42, v43
    ds_write_b64 v232, v[68:69] offset:1024
    v_cvt_pk_bf16_f32 v70, v44, v45
    v_cvt_pk_bf16_f32 v71, v46, v47
    ds_write_b64 v232, v[70:71] offset:1536
    v_cvt_pk_bf16_f32 v72, v48, v49
    v_cvt_pk_bf16_f32 v73, v50, v51
    ds_write_b64 v232, v[72:73] offset:2048
    v_cvt_pk_bf16_f32 v74, v52, v53
    v_cvt_pk_bf16_f32 v75, v54, v55
    ds_write_b64 v232, v[74:75] offset:2560
    v_cvt_pk_bf16_f32 v76, v56, v57
    v_cvt_pk_bf16_f32 v77, v58, v59
    ds_write_b64 v232, v[76:77] offset:3072
    v_cvt_pk_bf16_f32 v78, v60, v61
    v_cvt_pk_bf16_f32 v79, v62, v63
    ds_write_b64 v232, v[78:79] offset:3584
    s_waitcnt vmcnt(0)
    v_mov_b32 v130, v238
    v_mov_b32 v131, v239
    v_mov_b32 v134, v238
    v_mov_b32 v135, v239
    v_mov_b32 v138, v238
    v_mov_b32 v139, v239
    v_mov_b32 v142, v238
    v_mov_b32 v143, v239
    v_mov_b32 v146, v238
    v_mov_b32 v147, v239
    v_mov_b32 v150, v238
    v_mov_b32 v151, v239
    v_mov_b32 v154, v238
    v_mov_b32 v155, v239
    v_mov_b32 v158, v238
    v_mov_b32 v159, v239
    s_waitcnt lgkmcnt(0)
    s_barrier
    ds_read_b32 v96, v233 offset:0
    ds_read_b32 v97, v233 offset:21248
    ds_read_b32 v98, v234 offset:0
    ds_read_b32 v99, v234 offset:21248
    ds_read_b32 v100, v233 offset:512
    ds_read_b32 v101, v233 offset:21760
    ds_read_b32 v102, v234 offset:512
    ds_read_b32 v103, v234 offset:21760
    ds_read_b32 v104, v233 offset:1024
    ds_read_b32 v105, v233 offset:22272
    ds_read_b32 v106, v234 offset:1024
    ds_read_b32 v107, v234 offset:22272
    ds_read_b32 v108, v233 offset:1536
    ds_read_b32 v109, v233 offset:22784
    ds_read_b32 v110, v234 offset:1536
    ds_read_b32 v111, v234 offset:22784
    ds_read_b32 v112, v233 offset:2048
    ds_read_b32 v113, v233 offset:23296
    ds_read_b32 v114, v234 offset:2048
    ds_read_b32 v115, v234 offset:23296
    ds_read_b32 v116, v233 offset:2560
    ds_read_b32 v117, v233 offset:23808
    ds_read_b32 v118, v234 offset:2560
    ds_read_b32 v119, v234 offset:23808
    ds_read_b32 v120, v233 offset:3072
    ds_read_b32 v121, v233 offset:24320
    ds_read_b32 v122, v234 offset:3072
    ds_read_b32 v123, v234 offset:24320
    ds_read_b32 v124, v233 offset:3584
    ds_read_b32 v125, v233 offset:24832
    ds_read_b32 v126, v234 offset:3584
    ds_read_b32 v127, v234 offset:24832
    s_waitcnt lgkmcnt(15)
    v_perm_b32 v128, v97, v96, v11
    v_perm_b32 v129, v99, v98, v11
    buffer_store_dwordx4 v[128:131], v3, s[24:27], s37 offen sc1
    s_add_u32 s37, s37, 4096
    v_perm_b32 v132, v101, v100, v11
    v_perm_b32 v133, v103, v102, v11
    buffer_store_dwordx4 v[132:135], v3, s[24:27], s37 offen sc1
    s_add_u32 s37, s37, 4096
    v_perm_b32 v136, v105, v104, v11
    v_perm_b32 v137, v107, v106, v11
    buffer_store_dwordx4 v[136:139], v3, s[24:27], s37 offen sc1
    s_add_u32 s37, s37, 4096
    v_perm_b32 v140, v109, v108, v11
    v_perm_b32 v141, v111, v110, v11
    buffer_store_dwordx4 v[140:143], v3, s[24:27], s37 offen sc1
    s_add_u32 s37, s37, 4096
    s_waitcnt lgkmcnt(12)
    v_perm_b32 v144, v113, v112, v11
    v_perm_b32 v145, v115, v114, v11
    buffer_store_dwordx4 v[144:147], v3, s[24:27], s37 offen sc1
    s_add_u32 s37, s37, 4096
    s_waitcnt lgkmcnt(8)
    v_perm_b32 v148, v117, v116, v11
    v_perm_b32 v149, v119, v118, v11
    buffer_store_dwordx4 v[148:151], v3, s[24:27], s37 offen sc1
    s_add_u32 s37, s37, 4096
    s_waitcnt lgkmcnt(4)
    v_perm_b32 v152, v121, v120, v11
    v_perm_b32 v153, v123, v122, v11
    buffer_store_dwordx4 v[152:155], v3, s[24:27], s37 offen sc1
    s_add_u32 s37, s37, 4096
    s_waitcnt lgkmcnt(0)
    v_perm_b32 v156, v125, v124, v11
    v_perm_b32 v157, v127, v126, v11
    buffer_store_dwordx4 v[156:159], v3, s[24:27], s37 offen sc1
    s_branch Lk01_fin
Lk01_help:
    s_sub_u32 s43, s2, 160
    s_lshl_b32 s44, s43, 2
    s_add_u32 s44, s44, s40
    v_and_b32 v8, 15, v2
    v_lshrrev_b32 v9, 4, v2
    v_lshlrev_b32 v238, 4, v2
    s_mul_i32 s45, s40, 16640
    v_add_u32 v239, s45, v238
    v_lshlrev_b32 v235, 8, v2
    s_cmp_lg_u32 s40, 3
    s_cbranch_scc1 Lc3_interleave_layers__ssm_conv_h3__swiglu_ffn__prompt_kernel_17
Lng_interleave_layers__ssm_conv_h3__swiglu_ffn__prompt_kernel_18:
    buffer_load_dwordx2 v[16:17], off, s[20:23], 0 sc1
    s_waitcnt vmcnt(0)
    v_readfirstlane_b32 s56, v16
    v_readfirstlane_b32 s57, v17
    s_sub_u32 s58, s58, 1
    s_cbranch_scc1 Lk2_end
    s_cmp_eq_u32 s56, 0
    s_cbranch_scc1 Lng_interleave_layers__ssm_conv_h3__swiglu_ffn__prompt_kernel_18
Lc3_interleave_layers__ssm_conv_h3__swiglu_ffn__prompt_kernel_17:
    s_waitcnt vmcnt(0)
    s_barrier
    s_cmp_lg_u32 s40, 3
    s_cbranch_scc1 Lcw_interleave_layers__ssm_conv_h3__swiglu_ffn__prompt_kernel_16
    s_lshl_b32 s6, s41, 5
    s_add_u32 s6, s6, s42
    s_lshl_b32 s6, s6, 8
    s_add_u32 s6, s6, 13631488
    v_mov_b32 v16, s56
    v_mov_b32 v17, s57
    s_mov_b64 exec, 1
    buffer_store_dwordx2 v[16:17], off, s[24:27], s6 sc1
    s_mov_b64 exec, -1
Lcw_interleave_layers__ssm_conv_h3__swiglu_ffn__prompt_kernel_16:
    s_cmp_ge_u32 s43, 60
    s_cbranch_scc1 Lh_interleave_layers__ssm_conv_h3__swiglu_ffn__prompt_kernel_10
    s_mov_b32 s8, s78
    s_mov_b32 s9, s79
    s_mov_b32 s10, 1966080
    s_mov_b32 s11, 0x20000
    s_mov_b32 s16, s80
    s_mov_b32 s17, s81
    s_mov_b32 s18, 1966080
    s_mov_b32 s19, 0x20000
    s_mul_i32 s52, s44, 171
    s_lshr_b32 s52, s52, 11
    s_mul_i32 s3, s52, 12
    s_sub_u32 s53, s44, s3
    s_mul_i32 s7, s52, 98304
    s_lshl_b32 s3, s53, 8
    s_add_u32 s7, s7, s3
    v_mul_u32_u24 v16, 24576, v9
    v_lshl_add_u32 v16, v8, 4, v16
    buffer_load_dwordx4 v[32:35], v16, s[8:11], s7 offen nt
    buffer_load_dwordx4 v[64:67], v16, s[16:19], s7 offen nt
    s_add_u32 s7, s7, 3072
    buffer_load_dwordx4 v[36:39], v16, s[8:11], s7 offen nt
    buffer_load_dwordx4 v[68:71], v16, s[16:19], s7 offen nt
    s_add_u32 s7, s7, 3072
    buffer_load_dwordx4 v[40:43], v16, s[8:11], s7 offen nt
    buffer_load_dwordx4 v[72:75], v16, s[16:19], s7 offen nt
    s_add_u32 s7, s7, 3072
    buffer_load_dwordx4 v[44:47], v16, s[8:11], s7 offen nt
    buffer_load_dwordx4 v[76:79], v16, s[16:19], s7 offen nt
    s_add_u32 s7, s7, 3072
    buffer_load_dwordx4 v[48:51], v16, s[8:11], s7 offen nt
    buffer_load_dwordx4 v[80:83], v16, s[16:19], s7 offen nt
    s_add_u32 s7, s7, 3072
    buffer_load_dwordx4 v[52:55], v16, s[8:11], s7 offen nt
    buffer_load_dwordx4 v[84:87], v16, s[16:19], s7 offen nt
    s_add_u32 s7, s7, 3072
    buffer_load_dwordx4 v[56:59], v16, s[8:11], s7 offen nt
    buffer_load_dwordx4 v[88:91], v16, s[16:19], s7 offen nt
    s_add_u32 s7, s7, 3072
    buffer_load_dwordx4 v[60:63], v16, s[8:11], s7 offen nt
    buffer_load_dwordx4 v[92:95], v16, s[16:19], s7 offen nt
    s_branch Lh_interleave_layers__ssm_conv_h3__swiglu_ffn__prompt_kernel_12
Lh_interleave_layers__ssm_conv_h3__swiglu_ffn__prompt_kernel_10:
    s_cmp_ge_u32 s43, 92
    s_cbranch_scc1 Lh_interleave_layers__ssm_conv_h3__swiglu_ffn__prompt_kernel_12
    s_mov_b32 s16, s64
    s_mov_b32 s17, s65
    s_mov_b32 s18, 2621440
    s_mov_b32 s19, 0x20000
    s_sub_u32 s3, s44, 240
    s_lshl_b32 s3, s3, 4
    v_lshrrev_b32 v7, 3, v2
    v_add_u32 v4, s3, v7
    v_mul_u32_u24 v5, 1280, v4
    v_and_b32 v6, 7, v2
    v_lshl_add_u32 v5, v6, 4, v5
    s_movk_i32 s7, 10240
    buffer_load_dwordx4 v[16:19], v5, s[16:19], 0 offen offset:0
    buffer_load_dwordx4 v[20:23], v5, s[16:19], 0 offen offset:128
    buffer_load_dwordx4 v[24:27], v5, s[16:19], 0 offen offset:256
    buffer_load_dwordx4 v[28:31], v5, s[16:19], 0 offen offset:384
    buffer_load_dwordx4 v[32:35], v5, s[16:19], 0 offen offset:512
    buffer_load_dwordx4 v[36:39], v5, s[16:19], 0 offen offset:640
    buffer_load_dwordx4 v[40:43], v5, s[16:19], 0 offen offset:768
    buffer_load_dwordx4 v[44:47], v5, s[16:19], 0 offen offset:896
    buffer_load_dwordx4 v[48:51], v5, s[16:19], 0 offen offset:1024
    buffer_load_dwordx4 v[52:55], v5, s[16:19], 0 offen offset:1152
    buffer_load_dwordx4 v[56:59], v5, s[16:19], s7 offen offset:0
    buffer_load_dwordx4 v[60:63], v5, s[16:19], s7 offen offset:128
    buffer_load_dwordx4 v[64:67], v5, s[16:19], s7 offen offset:256
    buffer_load_dwordx4 v[68:71], v5, s[16:19], s7 offen offset:384
    buffer_load_dwordx4 v[72:75], v5, s[16:19], s7 offen offset:512
    buffer_load_dwordx4 v[76:79], v5, s[16:19], s7 offen offset:640
    buffer_load_dwordx4 v[80:83], v5, s[16:19], s7 offen offset:768
    buffer_load_dwordx4 v[84:87], v5, s[16:19], s7 offen offset:896
    buffer_load_dwordx4 v[88:91], v5, s[16:19], s7 offen offset:1024
    buffer_load_dwordx4 v[92:95], v5, s[16:19], s7 offen offset:1152
Lh_interleave_layers__ssm_conv_h3__swiglu_ffn__prompt_kernel_12:
    s_nop 1
    s_mov_b32 s12, s82
    s_mov_b32 s13, s83
    s_mov_b32 s14, 1966080
    s_mov_b32 s15, 0x20000
    s_lshr_b32 s46, s44, 3
    s_and_b32 s47, s44, 7
    s_mul_i32 s3, s46, 171
    s_lshr_b32 s3, s3, 9
    s_mul_i32 s4, s3, 3
    s_sub_u32 s4, s46, s4
    s_mul_i32 s5, s3, 122880
    s_mul_i32 s7, s47, 160
    s_add_u32 s5, s5, s7
    s_add_u32 s48, s5, 10240
    s_add_u32 s49, s5, 20480
    s_lshl_b32 s4, s4, 2
    v_add_u32 v10, s4, v9
    v_mul_u32_u24 v11, 171, v10
    v_lshrrev_b32 v11, 9, v11
    v_mul_u32_u24 v12, 3, v11
    v_sub_u32 v12, v10, v12
    v_mul_u32_u24 v11, 30720, v11
    v_min_u32 v14, 9, v8
    v_lshl_add_u32 v11, v14, 4, v11
    v_mul_u32_u24 v15, 2560, v12
    v_add_u32 v15, v15, v11
    v_mul_u32_u24 v13, 10240, v12
    v_add_u32 v13, v13, v11
    v_add_u32 v13, 7680, v13
    buffer_load_dwordx4 v[96:99], v15, s[12:15], s5 offen nt
    buffer_load_dwordx4 v[100:103], v15, s[12:15], s5 offen offset:1280 nt
    buffer_load_dwordx4 v[104:107], v15, s[12:15], s48 offen nt
    buffer_load_dwordx4 v[108:111], v15, s[12:15], s48 offen offset:1280 nt
    buffer_load_dwordx4 v[112:115], v15, s[12:15], s49 offen nt
    buffer_load_dwordx4 v[116:119], v15, s[12:15], s49 offen offset:1280 nt
    buffer_load_dwordx4 v[120:123], v13, s[12:15], s5 offen nt
    buffer_load_dwordx4 v[124:127], v13, s[12:15], s5 offen offset:1280 nt
    s_cmp_ge_u32 s43, 60
    s_cbranch_scc1 Lh_interleave_layers__ssm_conv_h3__swiglu_ffn__prompt_kernel_13
    v_mul_u32_u24 v17, 1040, v8
    v_lshl_add_u32 v17, v9, 8, v17
    v_add_u32 v17, s45, v17
    s_waitcnt vmcnt(8)
    v_perm_b32 v192, v36, v32, s50
    v_perm_b32 v193, v44, v40, s50
    v_perm_b32 v194, v52, v48, s50
    v_perm_b32 v195, v60, v56, s50
    ds_write_b128 v17, v[192:195] offset:0
    v_perm_b32 v196, v36, v32, s51
    v_perm_b32 v197, v44, v40, s51
    v_perm_b32 v198, v52, v48, s51
    v_perm_b32 v199, v60, v56, s51
    ds_write_b128 v17, v[196:199] offset:16
    v_perm_b32 v200, v37, v33, s50
    v_perm_b32 v201, v45, v41, s50
    v_perm_b32 v202, v53, v49, s50
    v_perm_b32 v203, v61, v57, s50
    ds_write_b128 v17, v[200:203] offset:64
    v_perm_b32 v204, v37, v33, s51
    v_perm_b32 v205, v45, v41, s51
    v_perm_b32 v206, v53, v49, s51
    v_perm_b32 v207, v61, v57, s51
    ds_write_b128 v17, v[204:207] offset:80
    v_perm_b32 v208, v38, v34, s50
    v_perm_b32 v209, v46, v42, s50
    v_perm_b32 v210, v54, v50, s50
    v_perm_b32 v211, v62, v58, s50
    ds_write_b128 v17, v[208:211] offset:128
    v_perm_b32 v212, v38, v34, s51
    v_perm_b32 v213, v46, v42, s51
    v_perm_b32 v214, v54, v50, s51
    v_perm_b32 v215, v62, v58, s51
    ds_write_b128 v17, v[212:215] offset:144
    v_perm_b32 v216, v39, v35, s50
    v_perm_b32 v217, v47, v43, s50
    v_perm_b32 v218, v55, v51, s50
    v_perm_b32 v219, v63, v59, s50
    ds_write_b128 v17, v[216:219] offset:192
    v_perm_b32 v220, v39, v35, s51
    v_perm_b32 v221, v47, v43, s51
    v_perm_b32 v222, v55, v51, s51
    v_perm_b32 v223, v63, v59, s51
    ds_write_b128 v17, v[220:223] offset:208
    v_perm_b32 v192, v68, v64, s50
    v_perm_b32 v193, v76, v72, s50
    v_perm_b32 v194, v84, v80, s50
    v_perm_b32 v195, v92, v88, s50
    ds_write_b128 v17, v[192:195] offset:32
    v_perm_b32 v196, v68, v64, s51
    v_perm_b32 v197, v76, v72, s51
    v_perm_b32 v198, v84, v80, s51
    v_perm_b32 v199, v92, v88, s51
    ds_write_b128 v17, v[196:199] offset:48
    v_perm_b32 v200, v69, v65, s50
    v_perm_b32 v201, v77, v73, s50
    v_perm_b32 v202, v85, v81, s50
    v_perm_b32 v203, v93, v89, s50
    ds_write_b128 v17, v[200:203] offset:96
    v_perm_b32 v204, v69, v65, s51
    v_perm_b32 v205, v77, v73, s51
    v_perm_b32 v206, v85, v81, s51
    v_perm_b32 v207, v93, v89, s51
    ds_write_b128 v17, v[204:207] offset:112
    v_perm_b32 v208, v70, v66, s50
    v_perm_b32 v209, v78, v74, s50
    v_perm_b32 v210, v86, v82, s50
    v_perm_b32 v211, v94, v90, s50
    ds_write_b128 v17, v[208:211] offset:160
    v_perm_b32 v212, v70, v66, s51
    v_perm_b32 v213, v78, v74, s51
    v_perm_b32 v214, v86, v82, s51
    v_perm_b32 v215, v94, v90, s51
    ds_write_b128 v17, v[212:215] offset:176
    v_perm_b32 v216, v71, v67, s50
    v_perm_b32 v217, v79, v75, s50
    v_perm_b32 v218, v87, v83, s50
    v_perm_b32 v219, v95, v91, s50
    ds_write_b128 v17, v[216:219] offset:224
    v_perm_b32 v220, v71, v67, s51
    v_perm_b32 v221, v79, v75, s51
    v_perm_b32 v222, v87, v83, s51
    v_perm_b32 v223, v95, v91, s51
    ds_write_b128 v17, v[220:223] offset:240
    s_waitcnt lgkmcnt(0)
    ds_read_b128 v[32:35], v239 offset:0
    ds_read_b128 v[36:39], v239 offset:1040
    ds_read_b128 v[40:43], v239 offset:2080
    ds_read_b128 v[44:47], v239 offset:3120
    ds_read_b128 v[48:51], v239 offset:4160
    ds_read_b128 v[52:55], v239 offset:5200
    ds_read_b128 v[56:59], v239 offset:6240
    ds_read_b128 v[60:63], v239 offset:7280
    ds_read_b128 v[64:67], v239 offset:8320
    ds_read_b128 v[68:71], v239 offset:9360
    ds_read_b128 v[72:75], v239 offset:10400
    ds_read_b128 v[76:79], v239 offset:11440
    ds_read_b128 v[80:83], v239 offset:12480
    ds_read_b128 v[84:87], v239 offset:13520
    ds_read_b128 v[88:91], v239 offset:14560
    ds_read_b128 v[92:95], v239 offset:15600
    s_lshl_b32 s54, s53, 4
    s_mul_i32 s55, s52, 3072
    s_add_u32 s55, s55, 6291456
    s_add_u32 s3, s54, 0
    s_mul_i32 s4, s3, 171
    s_lshr_b32 s4, s4, 9
    s_mul_i32 s5, s4, 58368
    s_lshl_b32 s3, s3, 10
    s_add_u32 s3, s3, s5
    s_add_u32 s3, s3, s55
    s_waitcnt lgkmcnt(15)
    buffer_store_dwordx4 v[32:35], v238, s[24:27], s3 offen sc1
    s_add_u32 s3, s54, 1
    s_mul_i32 s4, s3, 171
    s_lshr_b32 s4, s4, 9
    s_mul_i32 s5, s4, 58368
    s_lshl_b32 s3, s3, 10
    s_add_u32 s3, s3, s5
    s_add_u32 s3, s3, s55
    s_waitcnt lgkmcnt(14)
    buffer_store_dwordx4 v[36:39], v238, s[24:27], s3 offen sc1
    s_add_u32 s3, s54, 2
    s_mul_i32 s4, s3, 171
    s_lshr_b32 s4, s4, 9
    s_mul_i32 s5, s4, 58368
    s_lshl_b32 s3, s3, 10
    s_add_u32 s3, s3, s5
    s_add_u32 s3, s3, s55
    s_waitcnt lgkmcnt(13)
    buffer_store_dwordx4 v[40:43], v238, s[24:27], s3 offen sc1
    s_add_u32 s3, s54, 3
    s_mul_i32 s4, s3, 171
    s_lshr_b32 s4, s4, 9
    s_mul_i32 s5, s4, 58368
    s_lshl_b32 s3, s3, 10
    s_add_u32 s3, s3, s5
    s_add_u32 s3, s3, s55
    s_waitcnt lgkmcnt(12)
    buffer_store_dwordx4 v[44:47], v238, s[24:27], s3 offen sc1
    s_add_u32 s3, s54, 4
    s_mul_i32 s4, s3, 171
    s_lshr_b32 s4, s4, 9
    s_mul_i32 s5, s4, 58368
    s_lshl_b32 s3, s3, 10
    s_add_u32 s3, s3, s5
    s_add_u32 s3, s3, s55
    s_waitcnt lgkmcnt(11)
    buffer_store_dwordx4 v[48:51], v238, s[24:27], s3 offen sc1
    s_add_u32 s3, s54, 5
    s_mul_i32 s4, s3, 171
    s_lshr_b32 s4, s4, 9
    s_mul_i32 s5, s4, 58368
    s_lshl_b32 s3, s3, 10
    s_add_u32 s3, s3, s5
    s_add_u32 s3, s3, s55
    s_waitcnt lgkmcnt(10)
    buffer_store_dwordx4 v[52:55], v238, s[24:27], s3 offen sc1
    s_add_u32 s3, s54, 6
    s_mul_i32 s4, s3, 171
    s_lshr_b32 s4, s4, 9
    s_mul_i32 s5, s4, 58368
    s_lshl_b32 s3, s3, 10
    s_add_u32 s3, s3, s5
    s_add_u32 s3, s3, s55
    s_waitcnt lgkmcnt(9)
    buffer_store_dwordx4 v[56:59], v238, s[24:27], s3 offen sc1
    s_add_u32 s3, s54, 7
    s_mul_i32 s4, s3, 171
    s_lshr_b32 s4, s4, 9
    s_mul_i32 s5, s4, 58368
    s_lshl_b32 s3, s3, 10
    s_add_u32 s3, s3, s5
    s_add_u32 s3, s3, s55
    s_waitcnt lgkmcnt(8)
    buffer_store_dwordx4 v[60:63], v238, s[24:27], s3 offen sc1
    s_add_u32 s3, s54, 8
    s_mul_i32 s4, s3, 171
    s_lshr_b32 s4, s4, 9
    s_mul_i32 s5, s4, 58368
    s_lshl_b32 s3, s3, 10
    s_add_u32 s3, s3, s5
    s_add_u32 s3, s3, s55
    s_waitcnt lgkmcnt(7)
    buffer_store_dwordx4 v[64:67], v238, s[24:27], s3 offen sc1
    s_add_u32 s3, s54, 9
    s_mul_i32 s4, s3, 171
    s_lshr_b32 s4, s4, 9
    s_mul_i32 s5, s4, 58368
    s_lshl_b32 s3, s3, 10
    s_add_u32 s3, s3, s5
    s_add_u32 s3, s3, s55
    s_waitcnt lgkmcnt(6)
    buffer_store_dwordx4 v[68:71], v238, s[24:27], s3 offen sc1
    s_add_u32 s3, s54, 10
    s_mul_i32 s4, s3, 171
    s_lshr_b32 s4, s4, 9
    s_mul_i32 s5, s4, 58368
    s_lshl_b32 s3, s3, 10
    s_add_u32 s3, s3, s5
    s_add_u32 s3, s3, s55
    s_waitcnt lgkmcnt(5)
    buffer_store_dwordx4 v[72:75], v238, s[24:27], s3 offen sc1
    s_add_u32 s3, s54, 11
    s_mul_i32 s4, s3, 171
    s_lshr_b32 s4, s4, 9
    s_mul_i32 s5, s4, 58368
    s_lshl_b32 s3, s3, 10
    s_add_u32 s3, s3, s5
    s_add_u32 s3, s3, s55
    s_waitcnt lgkmcnt(4)
    buffer_store_dwordx4 v[76:79], v238, s[24:27], s3 offen sc1
    s_add_u32 s3, s54, 12
    s_mul_i32 s4, s3, 171
    s_lshr_b32 s4, s4, 9
    s_mul_i32 s5, s4, 58368
    s_lshl_b32 s3, s3, 10
    s_add_u32 s3, s3, s5
    s_add_u32 s3, s3, s55
    s_waitcnt lgkmcnt(3)
    buffer_store_dwordx4 v[80:83], v238, s[24:27], s3 offen sc1
    s_add_u32 s3, s54, 13
    s_mul_i32 s4, s3, 171
    s_lshr_b32 s4, s4, 9
    s_mul_i32 s5, s4, 58368
    s_lshl_b32 s3, s3, 10
    s_add_u32 s3, s3, s5
    s_add_u32 s3, s3, s55
    s_waitcnt lgkmcnt(2)
    buffer_store_dwordx4 v[84:87], v238, s[24:27], s3 offen sc1
    s_add_u32 s3, s54, 14
    s_mul_i32 s4, s3, 171
    s_lshr_b32 s4, s4, 9
    s_mul_i32 s5, s4, 58368
    s_lshl_b32 s3, s3, 10
    s_add_u32 s3, s3, s5
    s_add_u32 s3, s3, s55
    s_waitcnt lgkmcnt(1)
    buffer_store_dwordx4 v[88:91], v238, s[24:27], s3 offen sc1
    s_add_u32 s3, s54, 15
    s_mul_i32 s4, s3, 171
    s_lshr_b32 s4, s4, 9
    s_mul_i32 s5, s4, 58368
    s_lshl_b32 s3, s3, 10
    s_add_u32 s3, s3, s5
    s_add_u32 s3, s3, s55
    s_waitcnt lgkmcnt(0)
    buffer_store_dwordx4 v[92:95], v238, s[24:27], s3 offen sc1
    s_waitcnt vmcnt(16)
    s_branch Lh_interleave_layers__ssm_conv_h3__swiglu_ffn__prompt_kernel_15
Lh_interleave_layers__ssm_conv_h3__swiglu_ffn__prompt_kernel_13:
    s_waitcnt vmcnt(0)
    s_cmp_ge_u32 s43, 92
    s_cbranch_scc1 Lh_interleave_layers__ssm_conv_h3__swiglu_ffn__prompt_kernel_15
    s_mov_b32 s3, 0x3f803f80
    v_dot2_f32_bf16 v176, v16, s3, 0
    v_dot2_f32_bf16 v177, v16, v16, 0
    v_dot2_f32_bf16 v178, v17, s3, 0
    v_dot2_f32_bf16 v179, v17, v17, 0
    v_dot2_f32_bf16 v176, v18, s3, v176
    v_dot2_f32_bf16 v177, v18, v18, v177
    v_dot2_f32_bf16 v178, v19, s3, v178
    v_dot2_f32_bf16 v179, v19, v19, v179
    v_dot2_f32_bf16 v176, v20, s3, v176
    v_dot2_f32_bf16 v177, v20, v20, v177
    v_dot2_f32_bf16 v178, v21, s3, v178
    v_dot2_f32_bf16 v179, v21, v21, v179
    v_dot2_f32_bf16 v176, v22, s3, v176
    v_dot2_f32_bf16 v177, v22, v22, v177
    v_dot2_f32_bf16 v178, v23, s3, v178
    v_dot2_f32_bf16 v179, v23, v23, v179
    v_dot2_f32_bf16 v176, v24, s3, v176
    v_dot2_f32_bf16 v177, v24, v24, v177
    v_dot2_f32_bf16 v178, v25, s3, v178
    v_dot2_f32_bf16 v179, v25, v25, v179
    v_dot2_f32_bf16 v176, v26, s3, v176
    v_dot2_f32_bf16 v177, v26, v26, v177
    v_dot2_f32_bf16 v178, v27, s3, v178
    v_dot2_f32_bf16 v179, v27, v27, v179
    v_dot2_f32_bf16 v176, v28, s3, v176
    v_dot2_f32_bf16 v177, v28, v28, v177
    v_dot2_f32_bf16 v178, v29, s3, v178
    v_dot2_f32_bf16 v179, v29, v29, v179
    v_dot2_f32_bf16 v176, v30, s3, v176
    v_dot2_f32_bf16 v177, v30, v30, v177
    v_dot2_f32_bf16 v178, v31, s3, v178
    v_dot2_f32_bf16 v179, v31, v31, v179
    v_dot2_f32_bf16 v176, v32, s3, v176
    v_dot2_f32_bf16 v177, v32, v32, v177
    v_dot2_f32_bf16 v178, v33, s3, v178
    v_dot2_f32_bf16 v179, v33, v33, v179
    v_dot2_f32_bf16 v176, v34, s3, v176
    v_dot2_f32_bf16 v177, v34, v34, v177
    v_dot2_f32_bf16 v178, v35, s3, v178
    v_dot2_f32_bf16 v179, v35, v35, v179
    v_dot2_f32_bf16 v176, v36, s3, v176
    v_dot2_f32_bf16 v177, v36, v36, v177
    v_dot2_f32_bf16 v178, v37, s3, v178
    v_dot2_f32_bf16 v179, v37, v37, v179
    v_dot2_f32_bf16 v176, v38, s3, v176
    v_dot2_f32_bf16 v177, v38, v38, v177
    v_dot2_f32_bf16 v178, v39, s3, v178
    v_dot2_f32_bf16 v179, v39, v39, v179
    v_dot2_f32_bf16 v176, v40, s3, v176
    v_dot2_f32_bf16 v177, v40, v40, v177
    v_dot2_f32_bf16 v178, v41, s3, v178
    v_dot2_f32_bf16 v179, v41, v41, v179
    v_dot2_f32_bf16 v176, v42, s3, v176
    v_dot2_f32_bf16 v177, v42, v42, v177
    v_dot2_f32_bf16 v178, v43, s3, v178
    v_dot2_f32_bf16 v179, v43, v43, v179
    v_dot2_f32_bf16 v176, v44, s3, v176
    v_dot2_f32_bf16 v177, v44, v44, v177
    v_dot2_f32_bf16 v178, v45, s3, v178
    v_dot2_f32_bf16 v179, v45, v45, v179
    v_dot2_f32_bf16 v176, v46, s3, v176
    v_dot2_f32_bf16 v177, v46, v46, v177
    v_dot2_f32_bf16 v178, v47, s3, v178
    v_dot2_f32_bf16 v179, v47, v47, v179
    v_dot2_f32_bf16 v176, v48, s3, v176
    v_dot2_f32_bf16 v177, v48, v48, v177
    v_dot2_f32_bf16 v178, v49, s3, v178
    v_dot2_f32_bf16 v179, v49, v49, v179
    v_dot2_f32_bf16 v176, v50, s3, v176
    v_dot2_f32_bf16 v177, v50, v50, v177
    v_dot2_f32_bf16 v178, v51, s3, v178
    v_dot2_f32_bf16 v179, v51, v51, v179
    v_dot2_f32_bf16 v176, v52, s3, v176
    v_dot2_f32_bf16 v177, v52, v52, v177
    v_dot2_f32_bf16 v178, v53, s3, v178
    v_dot2_f32_bf16 v179, v53, v53, v179
    v_dot2_f32_bf16 v176, v54, s3, v176
    v_dot2_f32_bf16 v177, v54, v54, v177
    v_dot2_f32_bf16 v178, v55, s3, v178
    v_dot2_f32_bf16 v179, v55, v55, v179
    v_dot2_f32_bf16 v180, v56, s3, 0
    v_dot2_f32_bf16 v181, v56, v56, 0
    v_dot2_f32_bf16 v182, v57, s3, 0
    v_dot2_f32_bf16 v183, v57, v57, 0
    v_dot2_f32_bf16 v180, v58, s3, v180
    v_dot2_f32_bf16 v181, v58, v58, v181
    v_dot2_f32_bf16 v182, v59, s3, v182
    v_dot2_f32_bf16 v183, v59, v59, v183
    v_dot2_f32_bf16 v180, v60, s3, v180
    v_dot2_f32_bf16 v181, v60, v60, v181
    v_dot2_f32_bf16 v182, v61, s3, v182
    v_dot2_f32_bf16 v183, v61, v61, v183
    v_dot2_f32_bf16 v180, v62, s3, v180
    v_dot2_f32_bf16 v181, v62, v62, v181
    v_dot2_f32_bf16 v182, v63, s3, v182
    v_dot2_f32_bf16 v183, v63, v63, v183
    v_dot2_f32_bf16 v180, v64, s3, v180
    v_dot2_f32_bf16 v181, v64, v64, v181
    v_dot2_f32_bf16 v182, v65, s3, v182
    v_dot2_f32_bf16 v183, v65, v65, v183
    v_dot2_f32_bf16 v180, v66, s3, v180
    v_dot2_f32_bf16 v181, v66, v66, v181
    v_dot2_f32_bf16 v182, v67, s3, v182
    v_dot2_f32_bf16 v183, v67, v67, v183
    v_dot2_f32_bf16 v180, v68, s3, v180
    v_dot2_f32_bf16 v181, v68, v68, v181
    v_dot2_f32_bf16 v182, v69, s3, v182
    v_dot2_f32_bf16 v183, v69, v69, v183
    v_dot2_f32_bf16 v180, v70, s3, v180
    v_dot2_f32_bf16 v181, v70, v70, v181
    v_dot2_f32_bf16 v182, v71, s3, v182
    v_dot2_f32_bf16 v183, v71, v71, v183
    v_dot2_f32_bf16 v180, v72, s3, v180
    v_dot2_f32_bf16 v181, v72, v72, v181
    v_dot2_f32_bf16 v182, v73, s3, v182
    v_dot2_f32_bf16 v183, v73, v73, v183
    v_dot2_f32_bf16 v180, v74, s3, v180
    v_dot2_f32_bf16 v181, v74, v74, v181
    v_dot2_f32_bf16 v182, v75, s3, v182
    v_dot2_f32_bf16 v183, v75, v75, v183
    v_dot2_f32_bf16 v180, v76, s3, v180
    v_dot2_f32_bf16 v181, v76, v76, v181
    v_dot2_f32_bf16 v182, v77, s3, v182
    v_dot2_f32_bf16 v183, v77, v77, v183
    v_dot2_f32_bf16 v180, v78, s3, v180
    v_dot2_f32_bf16 v181, v78, v78, v181
    v_dot2_f32_bf16 v182, v79, s3, v182
    v_dot2_f32_bf16 v183, v79, v79, v183
    v_dot2_f32_bf16 v180, v80, s3, v180
    v_dot2_f32_bf16 v181, v80, v80, v181
    v_dot2_f32_bf16 v182, v81, s3, v182
    v_dot2_f32_bf16 v183, v81, v81, v183
    v_dot2_f32_bf16 v180, v82, s3, v180
    v_dot2_f32_bf16 v181, v82, v82, v181
    v_dot2_f32_bf16 v182, v83, s3, v182
    v_dot2_f32_bf16 v183, v83, v83, v183
    v_dot2_f32_bf16 v180, v84, s3, v180
    v_dot2_f32_bf16 v181, v84, v84, v181
    v_dot2_f32_bf16 v182, v85, s3, v182
    v_dot2_f32_bf16 v183, v85, v85, v183
    v_dot2_f32_bf16 v180, v86, s3, v180
    v_dot2_f32_bf16 v181, v86, v86, v181
    v_dot2_f32_bf16 v182, v87, s3, v182
    v_dot2_f32_bf16 v183, v87, v87, v183
    v_dot2_f32_bf16 v180, v88, s3, v180
    v_dot2_f32_bf16 v181, v88, v88, v181
    v_dot2_f32_bf16 v182, v89, s3, v182
    v_dot2_f32_bf16 v183, v89, v89, v183
    v_dot2_f32_bf16 v180, v90, s3, v180
    v_dot2_f32_bf16 v181, v90, v90, v181
    v_dot2_f32_bf16 v182, v91, s3, v182
    v_dot2_f32_bf16 v183, v91, v91, v183
    v_dot2_f32_bf16 v180, v92, s3, v180
    v_dot2_f32_bf16 v181, v92, v92, v181
    v_dot2_f32_bf16 v182, v93, s3, v182
    v_dot2_f32_bf16 v183, v93, v93, v183
    v_dot2_f32_bf16 v180, v94, s3, v180
    v_dot2_f32_bf16 v181, v94, v94, v181
    v_dot2_f32_bf16 v182, v95, s3, v182
    v_dot2_f32_bf16 v183, v95, v95, v183
    v_add_f32 v176, v176, v178
    v_add_f32 v177, v177, v179
    v_add_f32 v180, v180, v182
    v_add_f32 v181, v181, v183
    v_add_f32_dpp v176, v176, v176 quad_perm:[1,0,3,2] row_mask:0xf bank_mask:0xf
    v_add_f32_dpp v177, v177, v177 quad_perm:[1,0,3,2] row_mask:0xf bank_mask:0xf
    v_add_f32_dpp v180, v180, v180 quad_perm:[1,0,3,2] row_mask:0xf bank_mask:0xf
    v_add_f32_dpp v181, v181, v181 quad_perm:[1,0,3,2] row_mask:0xf bank_mask:0xf
    v_add_f32_dpp v176, v176, v176 quad_perm:[2,3,0,1] row_mask:0xf bank_mask:0xf
    v_add_f32_dpp v177, v177, v177 quad_perm:[2,3,0,1] row_mask:0xf bank_mask:0xf
    v_add_f32_dpp v180, v180, v180 quad_perm:[2,3,0,1] row_mask:0xf bank_mask:0xf
    v_add_f32_dpp v181, v181, v181 quad_perm:[2,3,0,1] row_mask:0xf bank_mask:0xf
    v_add_f32_dpp v176, v176, v176 row_half_mirror row_mask:0xf bank_mask:0xf
    v_add_f32_dpp v177, v177, v177 row_half_mirror row_mask:0xf bank_mask:0xf
    v_add_f32_dpp v180, v180, v180 row_half_mirror row_mask:0xf bank_mask:0xf
    v_add_f32_dpp v181, v181, v181 row_half_mirror row_mask:0xf bank_mask:0xf
    v_mul_f32 v176, 0x3acccccd, v176
    v_mul_f32 v177, 0x3acccccd, v177
    v_fma_f32 v177, -v176, v176, v177
    v_max_f32 v177, 0, v177
    v_cvt_pk_bf16_f32 v178, v176, v177
    v_lshlrev_b32 v176, 16, v178
    v_and_b32 v177, 0xffff0000, v178
    v_add_f32 v177, 0x3727c5ac, v177
    v_cvt_pk_bf16_f32 v178, v177, v177
    v_lshlrev_b32 v177, 16, v178
    v_sqrt_f32 v177, v177
    s_nop 0
    v_cvt_pk_bf16_f32 v178, v177, v177
    v_lshlrev_b32 v177, 16, v178
    v_rcp_f32 v177, v177
    s_nop 0
    v_mul_f32 v176, v176, v177
    v_mul_f32 v180, 0x3acccccd, v180
    v_mul_f32 v181, 0x3acccccd, v181
    v_fma_f32 v181, -v180, v180, v181
    v_max_f32 v181, 0, v181
    v_cvt_pk_bf16_f32 v182, v180, v181
    v_lshlrev_b32 v180, 16, v182
    v_and_b32 v181, 0xffff0000, v182
    v_add_f32 v181, 0x3727c5ac, v181
    v_cvt_pk_bf16_f32 v182, v181, v181
    v_lshlrev_b32 v181, 16, v182
    v_sqrt_f32 v181, v181
    s_nop 0
    v_cvt_pk_bf16_f32 v182, v181, v181
    v_lshlrev_b32 v181, 16, v182
    v_rcp_f32 v181, v181
    s_nop 0
    v_mul_f32 v180, v180, v181
    v_lshlrev_b32 v4, 4, v4
Lng_interleave_layers__ssm_conv_h3__swiglu_ffn__prompt_kernel_19:
    buffer_load_dwordx2 v[178:179], off, s[20:23], 0 sc1
    s_waitcnt vmcnt(0)
    v_readfirstlane_b32 s56, v178
    v_readfirstlane_b32 s57, v179
    s_sub_u32 s58, s58, 1
    s_cbranch_scc1 Lk2_end
    s_cmp_eq_u32 s56, 0
    s_cbranch_scc1 Lng_interleave_layers__ssm_conv_h3__swiglu_ffn__prompt_kernel_19
    v_mov_b32 v182, v178
    v_mov_b32 v183, v179
    s_mov_b32 s3, 12582912
    s_mov_b32 exec_lo, 0x01010101
    s_mov_b32 exec_hi, 0x01010101
    buffer_store_dwordx4 v[176:179], v4, s[24:27], s3 offen sc1
    buffer_store_dwordx4 v[180:183], v4, s[24:27], s3 offen offset:128 sc1
    s_mov_b64 exec, -1
Lh_interleave_layers__ssm_conv_h3__swiglu_ffn__prompt_kernel_15:
    s_nop 1
    v_lshrrev_b32 v19, 2, v14
    v_mul_u32_u24 v19, 2080, v19
    v_and_b32 v20, 3, v14
    v_cmp_le_u32 vcc, 8, v14
    v_lshlrev_b32 v21, 6, v20
    v_lshlrev_b32 v22, 7, v20
    v_cndmask_b32 v21, v21, v22, vcc
    v_add_u32 v19, v19, v21
    v_mov_b32 v21, 1040
    v_cndmask_b32 v21, v21, 64, vcc
    v_lshl_add_u32 v19, v9, 8, v19
    v_add_u32 v24, s45, v19
    v_add_u32 v25, v24, v21
    s_mul_i32 s3, s47, 48
    s_add_u32 s3, s3, s46
    s_mul_i32 s3, s3, 5120
    s_add_u32 s3, s3, 10485760
    s_add_u32 s4, s3, 4096
    s_waitcnt lgkmcnt(0)
    v_perm_b32 v192, v100, v96, s50
    v_perm_b32 v193, v108, v104, s50
    v_perm_b32 v194, v116, v112, s50
    v_perm_b32 v195, v124, v120, s50
    ds_write_b128 v24, v[192:195] offset:0
    v_perm_b32 v196, v100, v96, s51
    v_perm_b32 v197, v108, v104, s51
    v_perm_b32 v198, v116, v112, s51
    v_perm_b32 v199, v124, v120, s51
    ds_write_b128 v24, v[196:199] offset:16
    v_perm_b32 v200, v101, v97, s50
    v_perm_b32 v201, v109, v105, s50
    v_perm_b32 v202, v117, v113, s50
    v_perm_b32 v203, v125, v121, s50
    ds_write_b128 v24, v[200:203] offset:32
    v_perm_b32 v204, v101, v97, s51
    v_perm_b32 v205, v109, v105, s51
    v_perm_b32 v206, v117, v113, s51
    v_perm_b32 v207, v125, v121, s51
    ds_write_b128 v24, v[204:207] offset:48
    v_perm_b32 v208, v102, v98, s50
    v_perm_b32 v209, v110, v106, s50
    v_perm_b32 v210, v118, v114, s50
    v_perm_b32 v211, v126, v122, s50
    ds_write_b128 v25, v[208:211] offset:0
    v_perm_b32 v212, v102, v98, s51
    v_perm_b32 v213, v110, v106, s51
    v_perm_b32 v214, v118, v114, s51
    v_perm_b32 v215, v126, v122, s51
    ds_write_b128 v25, v[212:215] offset:16
    v_perm_b32 v216, v103, v99, s50
    v_perm_b32 v217, v111, v107, s50
    v_perm_b32 v218, v119, v115, s50
    v_perm_b32 v219, v127, v123, s50
    ds_write_b128 v25, v[216:219] offset:32
    v_perm_b32 v220, v103, v99, s51
    v_perm_b32 v221, v111, v107, s51
    v_perm_b32 v222, v119, v115, s51
    v_perm_b32 v223, v127, v123, s51
    ds_write_b128 v25, v[220:223] offset:48
    s_waitcnt lgkmcnt(0)
    ds_read_b128 v[128:131], v239 offset:0
    ds_read_b128 v[132:135], v239 offset:1040
    ds_read_b128 v[136:139], v239 offset:2080
    ds_read_b128 v[140:143], v239 offset:3120
    ds_read_b128 v[144:147], v239 offset:4160
    s_cmp_ge_u32 s43, 60
    s_cbranch_scc1 Lf1_interleave_layers__ssm_conv_h3__swiglu_ffn__prompt_kernel_20
    s_waitcnt vmcnt(0)
    s_barrier
    s_cmp_lg_u32 s40, 3
    s_cbranch_scc1 Lf1_interleave_layers__ssm_conv_h3__swiglu_ffn__prompt_kernel_20
    s_lshl_b32 s5, s43, 8
    s_add_u32 s5, s5, 15728640
    v_mov_b32 v180, s56
    v_mov_b32 v181, s57
    v_lshlrev_b32 v182, 16, v2
    s_mov_b64 exec, 0xff
    buffer_store_dwordx2 v[180:181], v182, s[24:27], s5 offen sc1
    s_mov_b64 exec, -1
Lf1_interleave_layers__ssm_conv_h3__swiglu_ffn__prompt_kernel_20:
    s_waitcnt lgkmcnt(4)
    buffer_store_dwordx4 v[128:131], v238, s[24:27], s3 offen offset:0 sc1
    s_waitcnt lgkmcnt(3)
    buffer_store_dwordx4 v[132:135], v238, s[24:27], s3 offen offset:1024 sc1
    s_waitcnt lgkmcnt(2)
    buffer_store_dwordx4 v[136:139], v238, s[24:27], s3 offen offset:2048 sc1
    s_waitcnt lgkmcnt(1)
    buffer_store_dwordx4 v[140:143], v238, s[24:27], s3 offen offset:3072 sc1
    s_waitcnt lgkmcnt(0)
    buffer_store_dwordx4 v[144:147], v238, s[24:27], s4 offen sc1
    s_waitcnt vmcnt(0)
    s_barrier
    s_cmp_lg_u32 s40, 3
    s_cbranch_scc1 Lhp_interleave_layers__ssm_conv_h3__swiglu_ffn__prompt_kernel_21
    s_lshl_b32 s3, s43, 8
    s_add_u32 s3, s3, 13697024
    v_mov_b32 v180, s56
    v_mov_b32 v181, s57
    s_mov_b64 exec, 1
    buffer_store_dwordx2 v[180:181], off, s[24:27], s3 sc1
    s_mov_b64 exec, -1
    s_mul_i32 s3, s43, 5
    s_mul_i32 s3, s3, 171
    s_lshr_b32 s3, s3, 9
    s_lshl_b32 s3, s3, 15
    s_add_u32 s3, s3, 44040200
Lhh_interleave_layers__ssm_conv_h3__swiglu_ffn__prompt_kernel_22:
    s_sleep 8
    buffer_load_dwordx2 v[180:181], off, s[24:27], s3 sc1
    s_waitcnt vmcnt(0)
    s_sub_u32 s58, s58, 1
    s_cbranch_scc1 Lk2_end
    v_cmp_ne_u64 vcc, s[56:57], v[180:181]
    s_cbranch_vccnz Lhh_interleave_layers__ssm_conv_h3__swiglu_ffn__prompt_kernel_22
Lhp_interleave_layers__ssm_conv_h3__swiglu_ffn__prompt_kernel_21:
Lk01_fin:
    s_nop 4
    s_load_dwordx2 s[16:17], s[0:1], 80
    s_mov_b32 s8, s64
    s_mov_b32 s9, s65
    s_and_b32 s3, s2, 7
    s_lshr_b32 s4, s2, 3
    s_lshr_b32 s41, s3, 2
    s_lshl_b32 s41, s41, 3
    s_and_b32 s5, s4, 7
    s_add_u32 s41, s41, s5
    s_and_b32 s42, s3, 3
    s_lshl_b32 s42, s42, 2
    s_lshr_b32 s5, s4, 3
    s_add_u32 s42, s42, s5
    s_lshl_b32 s45, s41, 4
    s_add_u32 s45, s45, s42
    s_lshl_b32 s3, s45, 3
    v_and_b32 v132, 7, v0
    v_add_u32 v133, s3, v132
    v_lshrrev_b32 v134, 3, v0
    v_lshlrev_b32 v136, 4, v133
    v_lshl_add_u32 v137, v134, 16, v136
    v_mul_u32_u24 v135, 1280, v133
    v_lshl_add_u32 v135, v134, 4, v135
    s_mov_b32 s10, 2621440
    s_mov_b32 s11, 0x20000
    s_cmp_lt_u32 s40, 2
    s_cselect_b32 s28, 0, 0x70000000
    s_cselect_b64 s[74:75], -1, 0
    v_and_b32 v9, 63, v0
    v_lshlrev_b32 v9, 8, v9
    buffer_load_dwordx2 v[2:3], off, s[20:23], 0 sc1
    buffer_load_dwordx4 v[80:83], v135, s[8:11], 0 offen
    buffer_load_dwordx4 v[84:87], v135, s[8:11], 0 offen offset:512
    buffer_load_dwordx4 v[88:91], v135, s[8:11], s28 offen offset:1024
    s_cmp_eq_u32 s40, 3
    s_cselect_b32 exec_hi, 0, -1
    s_cmp_lg_u32 s40, 3
    s_cbranch_scc1 Lwi_interleave_layers__ssm_conv_h3__swiglu_ffn__prompt_kernel_23
    s_and_b32 s3, s2, 7
    s_lshl_b32 s3, s3, 16
    s_add_u32 s3, s3, 15728640
    s_and_b32 s4, s2, 7
    s_lshl_b32 s4, s4, 16
    s_add_u32 s4, s4, 15735808
    buffer_load_dwordx2 v[72:73], v9, s[24:27], s3 offen sc1
    buffer_load_dwordx2 v[74:75], v9, s[24:27], s4 offen sc1
Lwi_interleave_layers__ssm_conv_h3__swiglu_ffn__prompt_kernel_23:
    s_cmp_lg_u32 s40, 3
    s_cbranch_scc1 Lpw_interleave_layers__ssm_conv_h3__swiglu_ffn__prompt_kernel_24
    s_mov_b32 exec_hi, 0
    s_waitcnt vmcnt(0)
    s_branch Lp2_interleave_layers__ssm_conv_h3__swiglu_ffn__prompt_kernel_26
Lp1_interleave_layers__ssm_conv_h3__swiglu_ffn__prompt_kernel_25:
    s_sleep 4
    s_and_b32 s3, s2, 7
    s_lshl_b32 s3, s3, 16
    s_add_u32 s3, s3, 15728640
    s_and_b32 s4, s2, 7
    s_lshl_b32 s4, s4, 16
    s_add_u32 s4, s4, 15735808
    buffer_load_dwordx2 v[72:73], v9, s[24:27], s3 offen sc1
    buffer_load_dwordx2 v[74:75], v9, s[24:27], s4 offen sc1
    s_waitcnt vmcnt(0)
    s_sub_u32 s58, s58, 1
    s_cbranch_scc1 Lk2_end
Lp2_interleave_layers__ssm_conv_h3__swiglu_ffn__prompt_kernel_26:
    v_cmp_ne_u64 vcc, s[56:57], v[72:73]
    v_cmp_ne_u64 s[68:69], s[56:57], v[74:75]
    s_nop 0
    s_or_b64 vcc, vcc, s[68:69]
    s_cbranch_vccnz Lp1_interleave_layers__ssm_conv_h3__swiglu_ffn__prompt_kernel_25
    s_mov_b64 exec, -1
Lpw_interleave_layers__ssm_conv_h3__swiglu_ffn__prompt_kernel_24:
    s_barrier
    s_add_u32 s3, 0, 44040192
    buffer_load_dwordx4 v[176:179], v137, s[24:27], s3 offen sc1
    s_add_u32 s3, 0, 44072960
    buffer_load_dwordx4 v[180:183], v137, s[24:27], s3 offen sc1
    s_add_u32 s3, 0, 46137344
    buffer_load_dwordx4 v[184:187], v137, s[24:27], s3 offen sc1
    s_add_u32 s3, 0, 46170112
    buffer_load_dwordx4 v[188:191], v137, s[24:27], s3 offen sc1
    s_add_u32 s3, s28, 48234496
    buffer_load_dwordx4 v[192:195], v137, s[24:27], s3 offen sc1
    s_add_u32 s3, s28, 48267264
    buffer_load_dwordx4 v[196:199], v137, s[24:27], s3 offen sc1
    s_mov_b32 s3, 12582912
    buffer_load_dwordx4 v[104:107], v136, s[24:27], s3 offen sc1
    v_and_b32 v64, 63, v0
    s_lshl_b32 s46, s42, 2
    s_add_u32 s46, s46, s40
    s_mul_i32 s46, s46, 61440
    s_add_u32 s46, s46, 6291456
    v_lshlrev_b32 v7, 4, v64
    s_add_u32 s62, s46, 24576
    buffer_load_dwordx4 a[96:99], v7, s[24:27], s62 offen offset:0 sc1
    buffer_load_dwordx4 a[100:103], v7, s[24:27], s62 offen offset:1024 sc1
    buffer_load_dwordx4 a[104:107], v7, s[24:27], s62 offen offset:2048 sc1
    buffer_load_dwordx4 a[108:111], v7, s[24:27], s62 offen offset:3072 sc1
    s_add_u32 s62, s46, 28672
    buffer_load_dwordx4 a[112:115], v7, s[24:27], s62 offen offset:0 sc1
    buffer_load_dwordx4 a[116:119], v7, s[24:27], s62 offen offset:1024 sc1
    buffer_load_dwordx4 a[120:123], v7, s[24:27], s62 offen offset:2048 sc1
    buffer_load_dwordx4 a[124:127], v7, s[24:27], s62 offen offset:3072 sc1
    s_mov_b32 s55, 0x3f803f80
    v_lshrrev_b32 v232, 4, v133
    v_mul_u32_u24 v232, 20480, v232
    v_and_b32 v139, 15, v133
    v_lshl_add_u32 v232, v139, 4, v232
    v_lshl_add_u32 v232, v134, 8, v232
    s_lshl_b32 s5, s40, 6
    v_lshlrev_b32 v139, 3, v132
    v_add_u32 v139, 159744, v139
    v_add_u32 v140, s5, v139
    s_mov_b32 s18, 2621440
    s_mov_b32 s19, 0x20000
    s_lshr_b32 s43, s42, 3
    s_and_b32 s44, s42, 7
    s_mul_i32 s47, s44, 48
    s_mul_i32 s5, s40, 12
    s_add_u32 s47, s47, s5
    s_mul_i32 s47, s47, 5120
    s_add_u32 s47, s47, 10485760
    s_lshl_b32 s37, s41, 3
    s_add_u32 s37, s37, s40
    s_mul_i32 s48, s37, 20480
    s_mul_i32 s49, s40, 12288
    s_mul_i32 s51, s40, 27648
    s_add_u32 s51, s51, 49152
    v_add_u32 v4, s51, v7
    v_lshlrev_b32 v9, 8, v64
    v_and_b32 v63, 15, v64
    v_lshrrev_b32 v58, 4, v64
    s_lshl_b32 s52, s41, 3
    s_lshl_b32 s5, s43, 1
    s_add_u32 s52, s52, s5
    s_and_b32 s5, s40, 1
    s_add_u32 s53, s52, s5
    s_lshr_b32 s54, s40, 1
    s_mul_i32 s5, s44, 10
    s_lshl_b32 s6, s54, 2
    s_add_u32 s6, s6, s5
    v_add_u32 v56, s6, v58
    s_mul_i32 s7, s53, 20480
    v_lshl_add_u32 v59, v63, 4, s7
    v_lshl_add_u32 v12, v56, 8, v59
    s_lshl_b32 s7, s53, 4
    v_add_u32 v57, s7, v63
    v_mul_u32_u24 v17, 1280, v57
    v_lshl_add_u32 v16, v56, 4, v17
    v_lshlrev_b32 v57, 3, v57
    v_lshl_add_u32 v60, v56, 15, v57
    s_lshl_b32 s5, s5, 1
    s_add_u32 s5, s5, 16
    v_add_u32 v56, s5, v58
    v_lshl_add_u32 v61, v56, 14, v57
    v_lshl_add_u32 v17, v56, 3, v17
    v_lshrrev_b32 v62, 1, v56
    v_lshl_add_u32 v13, v62, 8, v59
    v_and_b32 v62, 1, v56
    v_lshl_add_u32 v13, v62, 3, v13
    s_waitcnt vmcnt(8)
    s_branch Lyq_interleave_layers__ssm_conv_h3__swiglu_ffn__prompt_kernel_28
Lyp_interleave_layers__ssm_conv_h3__swiglu_ffn__prompt_kernel_27:
    s_sleep 8
    s_add_u32 s3, 0, 44040192
    buffer_load_dwordx4 v[176:179], v137, s[24:27], s3 offen sc1
    s_add_u32 s3, 0, 44072960
    buffer_load_dwordx4 v[180:183], v137, s[24:27], s3 offen sc1
    s_add_u32 s3, 0, 46137344
    buffer_load_dwordx4 v[184:187], v137, s[24:27], s3 offen sc1
    s_add_u32 s3, 0, 46170112
    buffer_load_dwordx4 v[188:191], v137, s[24:27], s3 offen sc1
    s_add_u32 s3, s28, 48234496
    buffer_load_dwordx4 v[192:195], v137, s[24:27], s3 offen sc1
    s_add_u32 s3, s28, 48267264
    buffer_load_dwordx4 v[196:199], v137, s[24:27], s3 offen sc1
    s_mov_b32 s3, 12582912
    buffer_load_dwordx4 v[104:107], v136, s[24:27], s3 offen sc1
    s_waitcnt vmcnt(0)
    s_sub_u32 s58, s58, 1
    s_cbranch_scc1 Lk2_end
Lyq_interleave_layers__ssm_conv_h3__swiglu_ffn__prompt_kernel_28:
    v_cmp_ne_u64 s[76:77], v[2:3], v[178:179]
    v_cmp_ne_u64 s[78:79], v[2:3], v[182:183]
    v_cmp_ne_u64 s[80:81], v[2:3], v[186:187]
    v_cmp_ne_u64 s[82:83], v[2:3], v[190:191]
    v_cmp_ne_u64 s[84:85], v[2:3], v[194:195]
    v_cmp_ne_u64 s[86:87], v[2:3], v[198:199]
    v_cmp_ne_u64 vcc, v[2:3], v[106:107]
    s_or_b64 s[84:85], s[84:85], s[86:87]
    s_and_b64 s[84:85], s[84:85], s[74:75]
    s_or_b64 s[76:77], s[76:77], s[78:79]
    s_or_b64 s[80:81], s[80:81], s[82:83]
    s_or_b64 vcc, vcc, s[84:85]
    s_or_b64 s[76:77], s[76:77], s[80:81]
    s_or_b64 vcc, vcc, s[76:77]
    s_cbranch_vccnz Lyp_interleave_layers__ssm_conv_h3__swiglu_ffn__prompt_kernel_27
    v_lshlrev_b32 v142, 16, v80
    v_and_b32 v143, 0xffff0000, v80
    v_lshlrev_b32 v144, 16, v176
    v_and_b32 v145, 0xffff0000, v176
    v_pk_fma_f32 v[146:147], v[142:143], v[104:105], v[104:105] op_sel:[0,1,0] op_sel_hi:[1,1,0] neg_lo:[0,0,1] neg_hi:[0,0,1]
    v_pk_fma_f32 v[146:147], v[146:147], v[144:145], v[142:143]
    v_cvt_pk_bf16_f32 v220, v146, v147
    v_lshlrev_b32 v148, 16, v81
    v_and_b32 v149, 0xffff0000, v81
    v_lshlrev_b32 v150, 16, v177
    v_and_b32 v151, 0xffff0000, v177
    v_pk_fma_f32 v[152:153], v[148:149], v[104:105], v[104:105] op_sel:[0,1,0] op_sel_hi:[1,1,0] neg_lo:[0,0,1] neg_hi:[0,0,1]
    v_pk_fma_f32 v[152:153], v[152:153], v[150:151], v[148:149]
    v_cvt_pk_bf16_f32 v221, v152, v153
    v_lshlrev_b32 v142, 16, v82
    v_and_b32 v143, 0xffff0000, v82
    s_add_u32 s62, s46, 32768
    buffer_load_dwordx4 a[128:131], v7, s[24:27], s62 offen offset:0 sc1
    v_lshlrev_b32 v144, 16, v180
    v_and_b32 v145, 0xffff0000, v180
    v_pk_fma_f32 v[146:147], v[142:143], v[104:105], v[104:105] op_sel:[0,1,0] op_sel_hi:[1,1,0] neg_lo:[0,0,1] neg_hi:[0,0,1]
    v_pk_fma_f32 v[146:147], v[146:147], v[144:145], v[142:143]
    v_cvt_pk_bf16_f32 v222, v146, v147
    v_lshlrev_b32 v148, 16, v83
    v_and_b32 v149, 0xffff0000, v83
    v_lshlrev_b32 v150, 16, v181
    v_and_b32 v151, 0xffff0000, v181
    v_pk_fma_f32 v[152:153], v[148:149], v[104:105], v[104:105] op_sel:[0,1,0] op_sel_hi:[1,1,0] neg_lo:[0,0,1] neg_hi:[0,0,1]
    v_pk_fma_f32 v[152:153], v[152:153], v[150:151], v[148:149]
    v_cvt_pk_bf16_f32 v223, v152, v153
    v_dot2_f32_bf16 v154, v220, s55, 0
    v_dot2_f32_bf16 v155, v220, v220, 0
    buffer_load_dwordx4 a[132:135], v7, s[24:27], s62 offen offset:1024 sc1
    v_dot2_f32_bf16 v156, v221, s55, 0
    v_dot2_f32_bf16 v157, v221, v221, 0
    v_dot2_f32_bf16 v154, v222, s55, v154
    v_dot2_f32_bf16 v155, v222, v222, v155
    v_dot2_f32_bf16 v156, v223, s55, v156
    v_dot2_f32_bf16 v157, v223, v223, v157
    v_lshlrev_b32 v142, 16, v84
    v_and_b32 v143, 0xffff0000, v84
    v_lshlrev_b32 v144, 16, v184
    v_and_b32 v145, 0xffff0000, v184
    buffer_load_dwordx4 a[136:139], v7, s[24:27], s62 offen offset:2048 sc1
    v_pk_fma_f32 v[146:147], v[142:143], v[104:105], v[104:105] op_sel:[0,1,0] op_sel_hi:[1,1,0] neg_lo:[0,0,1] neg_hi:[0,0,1]
    v_pk_fma_f32 v[146:147], v[146:147], v[144:145], v[142:143]
    v_cvt_pk_bf16_f32 v224, v146, v147
    v_lshlrev_b32 v148, 16, v85
    v_and_b32 v149, 0xffff0000, v85
    v_lshlrev_b32 v150, 16, v185
    v_and_b32 v151, 0xffff0000, v185
    v_pk_fma_f32 v[152:153], v[148:149], v[104:105], v[104:105] op_sel:[0,1,0] op_sel_hi:[1,1,0] neg_lo:[0,0,1] neg_hi:[0,0,1]
    v_pk_fma_f32 v[152:153], v[152:153], v[150:151], v[148:149]
    v_cvt_pk_bf16_f32 v225, v152, v153
    v_lshlrev_b32 v142, 16, v86
    v_and_b32 v143, 0xffff0000, v86
    v_lshlrev_b32 v144, 16, v188
    v_and_b32 v145, 0xffff0000, v188
    v_pk_fma_f32 v[146:147], v[142:143], v[104:105], v[104:105] op_sel:[0,1,0] op_sel_hi:[1,1,0] neg_lo:[0,0,1] neg_hi:[0,0,1]
    v_pk_fma_f32 v[146:147], v[146:147], v[144:145], v[142:143]
    buffer_load_dwordx4 a[140:143], v7, s[24:27], s62 offen offset:3072 sc1
    v_cvt_pk_bf16_f32 v226, v146, v147
    v_lshlrev_b32 v148, 16, v87
    v_and_b32 v149, 0xffff0000, v87
    v_lshlrev_b32 v150, 16, v189
    v_and_b32 v151, 0xffff0000, v189
    v_pk_fma_f32 v[152:153], v[148:149], v[104:105], v[104:105] op_sel:[0,1,0] op_sel_hi:[1,1,0] neg_lo:[0,0,1] neg_hi:[0,0,1]
    v_pk_fma_f32 v[152:153], v[152:153], v[150:151], v[148:149]
    v_cvt_pk_bf16_f32 v227, v152, v153
    v_dot2_f32_bf16 v154, v224, s55, v154
    v_dot2_f32_bf16 v155, v224, v224, v155
    v_dot2_f32_bf16 v156, v225, s55, v156
    v_dot2_f32_bf16 v157, v225, v225, v157
    s_add_u32 s62, s46, 36864
    buffer_load_dwordx4 a[144:147], v7, s[24:27], s62 offen offset:0 sc1
    v_dot2_f32_bf16 v154, v226, s55, v154
    v_dot2_f32_bf16 v155, v226, v226, v155
    v_dot2_f32_bf16 v156, v227, s55, v156
    v_dot2_f32_bf16 v157, v227, v227, v157
    v_lshlrev_b32 v142, 16, v88
    v_and_b32 v143, 0xffff0000, v88
    v_lshlrev_b32 v144, 16, v192
    v_and_b32 v145, 0xffff0000, v192
    v_pk_fma_f32 v[146:147], v[142:143], v[104:105], v[104:105] op_sel:[0,1,0] op_sel_hi:[1,1,0] neg_lo:[0,0,1] neg_hi:[0,0,1]
    v_pk_fma_f32 v[146:147], v[146:147], v[144:145], v[142:143]
    v_cvt_pk_bf16_f32 v228, v146, v147
    v_lshlrev_b32 v148, 16, v89
    buffer_load_dwordx4 a[148:151], v7, s[24:27], s62 offen offset:1024 sc1
    v_and_b32 v149, 0xffff0000, v89
    v_lshlrev_b32 v150, 16, v193
    v_and_b32 v151, 0xffff0000, v193
    v_pk_fma_f32 v[152:153], v[148:149], v[104:105], v[104:105] op_sel:[0,1,0] op_sel_hi:[1,1,0] neg_lo:[0,0,1] neg_hi:[0,0,1]
    v_pk_fma_f32 v[152:153], v[152:153], v[150:151], v[148:149]
    v_cvt_pk_bf16_f32 v229, v152, v153
    v_lshlrev_b32 v142, 16, v90
    v_and_b32 v143, 0xffff0000, v90
    v_lshlrev_b32 v144, 16, v196
    v_and_b32 v145, 0xffff0000, v196
    v_pk_fma_f32 v[146:147], v[142:143], v[104:105], v[104:105] op_sel:[0,1,0] op_sel_hi:[1,1,0] neg_lo:[0,0,1] neg_hi:[0,0,1]
    v_pk_fma_f32 v[146:147], v[146:147], v[144:145], v[142:143]
    v_cvt_pk_bf16_f32 v230, v146, v147
    v_lshlrev_b32 v148, 16, v91
    v_and_b32 v149, 0xffff0000, v91
    v_lshlrev_b32 v150, 16, v197
    buffer_load_dwordx4 a[152:155], v7, s[24:27], s62 offen offset:2048 sc1
    v_and_b32 v151, 0xffff0000, v197
    v_pk_fma_f32 v[152:153], v[148:149], v[104:105], v[104:105] op_sel:[0,1,0] op_sel_hi:[1,1,0] neg_lo:[0,0,1] neg_hi:[0,0,1]
    v_pk_fma_f32 v[152:153], v[152:153], v[150:151], v[148:149]
    v_cvt_pk_bf16_f32 v231, v152, v153
    v_dot2_f32_bf16 v154, v228, s55, v154
    v_dot2_f32_bf16 v155, v228, v228, v155
    v_dot2_f32_bf16 v156, v229, s55, v156
    v_dot2_f32_bf16 v157, v229, v229, v157
    v_dot2_f32_bf16 v154, v230, s55, v154
    v_dot2_f32_bf16 v155, v230, v230, v155
    buffer_load_dwordx4 a[156:159], v7, s[24:27], s62 offen offset:3072 sc1
    v_dot2_f32_bf16 v156, v231, s55, v156
    v_dot2_f32_bf16 v157, v231, v231, v157
    v_lshlrev_b32 v80, 16, v220
    v_and_b32 v81, 0xffff0000, v220
    v_lshlrev_b32 v82, 16, v221
    v_and_b32 v83, 0xffff0000, v221
    v_pk_add_f32 v[154:155], v[154:155], v[156:157]
    s_nop 1
    v_add_f32_dpp v154, v154, v154 row_ror:8 row_mask:0xf bank_mask:0xf
    v_add_f32_dpp v155, v155, v155 row_ror:8 row_mask:0xf bank_mask:0xf
    v_mov_b32 v142, v154
    v_mov_b32 v143, v155
    s_nop 0
    v_permlane16_swap_b32 v154, v142
    v_permlane16_swap_b32 v155, v143
    v_add_f32 v154, v154, v142
    v_add_f32 v155, v155, v143
    v_mov_b32 v142, v154
    v_mov_b32 v143, v155
    s_nop 0
    v_permlane32_swap_b32 v154, v142
    v_permlane32_swap_b32 v155, v143
    v_add_f32 v154, v154, v142
    v_add_f32 v155, v155, v143
    ds_write_b64 v140, v[154:155]
    v_lshlrev_b32 v84, 16, v222
    v_and_b32 v85, 0xffff0000, v222
    v_lshlrev_b32 v86, 16, v223
    v_and_b32 v87, 0xffff0000, v223
    v_lshlrev_b32 v88, 16, v224
    v_and_b32 v89, 0xffff0000, v224
    v_lshlrev_b32 v90, 16, v225
    v_and_b32 v91, 0xffff0000, v225
    v_lshlrev_b32 v92, 16, v226
    v_and_b32 v93, 0xffff0000, v226
    s_waitcnt lgkmcnt(0)
    s_barrier
    ds_read_b64 v[142:143], v139 offset:0
    ds_read_b64 v[144:145], v139 offset:64
    ds_read_b64 v[146:147], v139 offset:128
    ds_read_b64 v[148:149], v139 offset:192
    v_lshlrev_b32 v94, 16, v227
    v_and_b32 v95, 0xffff0000, v227
    v_lshlrev_b32 v96, 16, v228
    v_and_b32 v97, 0xffff0000, v228
    v_lshlrev_b32 v98, 16, v229
    v_and_b32 v99, 0xffff0000, v229
    v_lshlrev_b32 v100, 16, v230
    v_and_b32 v101, 0xffff0000, v230
    v_lshlrev_b32 v102, 16, v231
    v_and_b32 v103, 0xffff0000, v231
    s_waitcnt lgkmcnt(0)
    v_pk_add_f32 v[142:143], v[142:143], v[144:145]
    v_pk_add_f32 v[146:147], v[146:147], v[148:149]
    v_pk_add_f32 v[154:155], v[142:143], v[146:147]
    v_mul_f32 v154, 0x3acccccd, v154
    v_mul_f32 v155, 0x3acccccd, v155
    v_fma_f32 v155, -v154, v154, v155
    v_max_f32 v155, 0, v155
    v_cvt_pk_bf16_f32 v142, v154, v155
    v_lshlrev_b32 v154, 16, v142
    v_and_b32 v155, 0xffff0000, v142
    v_add_f32 v155, 0x3727c5ac, v155
    v_cvt_pk_bf16_f32 v142, v155, v155
    v_lshlrev_b32 v155, 16, v142
    v_sqrt_f32 v155, v155
    s_nop 0
    v_cvt_pk_bf16_f32 v142, v155, v155
    v_lshlrev_b32 v155, 16, v142
    v_rcp_f32 v155, v155
    s_nop 0
    v_mul_f32 v154, v154, v155
    v_pk_fma_f32 v[80:81], v[80:81], v[154:155], v[154:155] op_sel:[0,1,0] op_sel_hi:[1,1,0] neg_lo:[0,0,1] neg_hi:[0,0,1]
    v_pk_fma_f32 v[82:83], v[82:83], v[154:155], v[154:155] op_sel:[0,1,0] op_sel_hi:[1,1,0] neg_lo:[0,0,1] neg_hi:[0,0,1]
    v_pk_fma_f32 v[84:85], v[84:85], v[154:155], v[154:155] op_sel:[0,1,0] op_sel_hi:[1,1,0] neg_lo:[0,0,1] neg_hi:[0,0,1]
    v_pk_fma_f32 v[86:87], v[86:87], v[154:155], v[154:155] op_sel:[0,1,0] op_sel_hi:[1,1,0] neg_lo:[0,0,1] neg_hi:[0,0,1]
    v_cvt_pk_bf16_f32 v120, v80, v81
    v_cvt_pk_bf16_f32 v121, v82, v83
    v_cvt_pk_bf16_f32 v122, v84, v85
    v_cvt_pk_bf16_f32 v123, v86, v87
    s_add_u32 s3, 0, 16777216
    buffer_store_dwordx4 v[120:123], v232, s[24:27], s3 offen sc1
    v_pk_fma_f32 v[88:89], v[88:89], v[154:155], v[154:155] op_sel:[0,1,0] op_sel_hi:[1,1,0] neg_lo:[0,0,1] neg_hi:[0,0,1]
    v_pk_fma_f32 v[90:91], v[90:91], v[154:155], v[154:155] op_sel:[0,1,0] op_sel_hi:[1,1,0] neg_lo:[0,0,1] neg_hi:[0,0,1]
    v_pk_fma_f32 v[92:93], v[92:93], v[154:155], v[154:155] op_sel:[0,1,0] op_sel_hi:[1,1,0] neg_lo:[0,0,1] neg_hi:[0,0,1]
    v_pk_fma_f32 v[94:95], v[94:95], v[154:155], v[154:155] op_sel:[0,1,0] op_sel_hi:[1,1,0] neg_lo:[0,0,1] neg_hi:[0,0,1]
    v_cvt_pk_bf16_f32 v124, v88, v89
    v_cvt_pk_bf16_f32 v125, v90, v91
    v_cvt_pk_bf16_f32 v126, v92, v93
    v_cvt_pk_bf16_f32 v127, v94, v95
    s_add_u32 s3, 0, 16785408
    buffer_store_dwordx4 v[124:127], v232, s[24:27], s3 offen sc1
    v_pk_fma_f32 v[96:97], v[96:97], v[154:155], v[154:155] op_sel:[0,1,0] op_sel_hi:[1,1,0] neg_lo:[0,0,1] neg_hi:[0,0,1]
    v_pk_fma_f32 v[98:99], v[98:99], v[154:155], v[154:155] op_sel:[0,1,0] op_sel_hi:[1,1,0] neg_lo:[0,0,1] neg_hi:[0,0,1]
    v_pk_fma_f32 v[100:101], v[100:101], v[154:155], v[154:155] op_sel:[0,1,0] op_sel_hi:[1,1,0] neg_lo:[0,0,1] neg_hi:[0,0,1]
    v_pk_fma_f32 v[102:103], v[102:103], v[154:155], v[154:155] op_sel:[0,1,0] op_sel_hi:[1,1,0] neg_lo:[0,0,1] neg_hi:[0,0,1]
    v_cvt_pk_bf16_f32 v128, v96, v97
    v_cvt_pk_bf16_f32 v129, v98, v99
    v_cvt_pk_bf16_f32 v130, v100, v101
    v_cvt_pk_bf16_f32 v131, v102, v103
    s_add_u32 s3, s28, 16793600
    buffer_store_dwordx4 v[128:131], v232, s[24:27], s3 offen sc1
    s_add_u32 s62, s46, 40960
    buffer_load_dwordx4 a[160:163], v7, s[24:27], s62 offen offset:0 sc1
    buffer_load_dwordx4 a[164:167], v7, s[24:27], s62 offen offset:1024 sc1
    buffer_load_dwordx4 a[168:171], v7, s[24:27], s62 offen offset:2048 sc1
    buffer_load_dwordx4 a[172:175], v7, s[24:27], s62 offen offset:3072 sc1
    s_add_u32 s62, s46, 45056
    buffer_load_dwordx4 a[176:179], v7, s[24:27], s62 offen offset:0 sc1
    buffer_load_dwordx4 a[180:183], v7, s[24:27], s62 offen offset:1024 sc1
    buffer_load_dwordx4 a[184:187], v7, s[24:27], s62 offen offset:2048 sc1
    buffer_load_dwordx4 a[188:191], v7, s[24:27], s62 offen offset:3072 sc1
    s_and_b32 s5, s40, 1
    s_mul_i32 s5, s5, 5120
    s_lshl_b32 s6, s54, 11
    s_add_u32 s6, s6, s5
    v_add_u32 v14, s6, v7
    s_add_u32 s5, s5, 4096
    v_add_u32 v15, s5, v7
    s_lshl_b32 s5, s44, 1
    s_add_u32 s5, s5, s54
    s_lshl_b32 s5, s5, 8
    s_lshl_b32 s39, s53, 12
    s_add_u32 s5, s5, s39
    v_lshlrev_b32 v56, 4, v63
    v_add_u32 v18, s5, v56
    v_lshl_add_u32 v19, v58, 10, v56
    v_mov_b32 v56, s55
    v_accvgpr_write_b32 a252, v56
    v_accvgpr_write_b32 a253, v56
    v_accvgpr_write_b32 a254, v56
    v_accvgpr_write_b32 a255, v56
    s_mul_i32 s36, s41, 393216
    s_mul_i32 s5, s42, 3072
    s_add_u32 s36, s36, s5
    s_mul_i32 s5, s40, 768
    s_add_u32 s36, s36, s5
    s_mul_i32 s35, s52, 49152
    s_mul_i32 s5, s40, 12288
    s_add_u32 s35, s35, s5
    s_mov_b32 s64, -1
    s_mov_b32 s65, 0xffff
    s_lshl_b32 s66, s45, 10
    s_lshl_b32 s5, s40, 8
    s_add_u32 s66, s66, s5
    s_lshl_b32 s67, s41, 14
    s_lshl_b32 s5, s40, 12
    s_add_u32 s67, s67, s5
    s_cmp_eq_u32 s54, 0
    s_cselect_b32 s34, 1.0, 0
    v_mov_b32 v208, v176
    v_mov_b32 v209, v177
    v_mov_b32 v210, v180
    v_mov_b32 v211, v181
    v_mov_b32 v212, v184
    v_mov_b32 v213, v185
    v_mov_b32 v214, v188
    v_mov_b32 v215, v189
    v_mov_b32 v216, v192
    v_mov_b32 v217, v193
    v_mov_b32 v218, v196
    v_mov_b32 v219, v197
    s_waitcnt vmcnt(24)
    v_mfma_f32_16x16x32_bf16 v[20:23], a[96:99], a[252:255], 0
    v_mfma_f32_16x16x32_bf16 v[24:27], a[100:103], a[252:255], 0
    v_mfma_f32_16x16x32_bf16 v[28:31], a[104:107], a[252:255], 0
    s_waitcnt vmcnt(21)
    v_mfma_f32_16x16x32_bf16 v[20:23], a[108:111], a[252:255], v[20:23]
    v_mfma_f32_16x16x32_bf16 v[24:27], a[112:115], a[252:255], v[24:27]
    v_mfma_f32_16x16x32_bf16 v[28:31], a[116:119], a[252:255], v[28:31]
    s_waitcnt vmcnt(18)
    v_mfma_f32_16x16x32_bf16 v[20:23], a[120:123], a[252:255], v[20:23]
    v_mfma_f32_16x16x32_bf16 v[24:27], a[124:127], a[252:255], v[24:27]
    v_mfma_f32_16x16x32_bf16 v[28:31], a[128:131], a[252:255], v[28:31]
    s_waitcnt vmcnt(15)
    v_mfma_f32_16x16x32_bf16 v[20:23], a[132:135], a[252:255], v[20:23]
    v_mfma_f32_16x16x32_bf16 v[24:27], a[136:139], a[252:255], v[24:27]
    v_mfma_f32_16x16x32_bf16 v[28:31], a[140:143], a[252:255], v[28:31]
    s_waitcnt vmcnt(12)
    v_mfma_f32_16x16x32_bf16 v[20:23], a[144:147], a[252:255], v[20:23]
    v_mfma_f32_16x16x32_bf16 v[24:27], a[148:151], a[252:255], v[24:27]
    v_mfma_f32_16x16x32_bf16 v[28:31], a[152:155], a[252:255], v[28:31]
    s_waitcnt vmcnt(8)
    s_barrier
    s_cmp_lg_u32 s40, 0
    s_cbranch_scc1 Lsg_interleave_layers__ssm_conv_h3__swiglu_ffn__prompt_kernel_29
    s_lshl_b32 s3, s45, 8
    s_add_u32 s3, s3, 14024704
    s_mov_b64 exec, 1
    buffer_store_dwordx2 v[2:3], off, s[24:27], s3 sc1
    s_mov_b64 exec, -1
Lsg_interleave_layers__ssm_conv_h3__swiglu_ffn__prompt_kernel_29:
    s_add_u32 s62, s46, 49152
    buffer_load_dwordx4 a[192:195], v7, s[24:27], s62 offen offset:0 sc1
    buffer_load_dwordx4 a[196:199], v7, s[24:27], s62 offen offset:1024 sc1
    buffer_load_dwordx4 a[200:203], v7, s[24:27], s62 offen offset:2048 sc1
    buffer_load_dwordx4 a[204:207], v7, s[24:27], s62 offen offset:3072 sc1
    s_add_u32 s62, s46, 53248
    buffer_load_dwordx4 a[208:211], v7, s[24:27], s62 offen offset:0 sc1
    buffer_load_dwordx4 a[212:215], v7, s[24:27], s62 offen offset:1024 sc1
    buffer_load_dwordx4 a[216:219], v7, s[24:27], s62 offen offset:2048 sc1
    buffer_load_dwordx4 a[220:223], v7, s[24:27], s62 offen offset:3072 sc1
    s_waitcnt vmcnt(14)
    v_mfma_f32_16x16x32_bf16 v[20:23], a[156:159], a[252:255], v[20:23]
    v_mfma_f32_16x16x32_bf16 v[24:27], a[160:163], a[252:255], v[24:27]
    v_mfma_f32_16x16x32_bf16 v[28:31], a[164:167], a[252:255], v[28:31]
    s_waitcnt vmcnt(11)
    v_mfma_f32_16x16x32_bf16 v[20:23], a[168:171], a[252:255], v[20:23]
    v_mfma_f32_16x16x32_bf16 v[24:27], a[172:175], a[252:255], v[24:27]
    v_mfma_f32_16x16x32_bf16 v[28:31], a[176:179], a[252:255], v[28:31]
    s_waitcnt vmcnt(8)
    v_mfma_f32_16x16x32_bf16 v[20:23], a[180:183], a[252:255], v[20:23]
    v_mfma_f32_16x16x32_bf16 v[24:27], a[184:187], a[252:255], v[24:27]
    v_mfma_f32_16x16x32_bf16 v[28:31], a[188:191], a[252:255], v[28:31]
    s_cmp_lg_u32 s40, 3
    s_cbranch_scc1 Lwi_interleave_layers__ssm_conv_h3__swiglu_ffn__prompt_kernel_30
    s_mov_b32 s3, 13697024
    s_mov_b32 s4, 13705216
    buffer_load_dwordx2 v[72:73], v9, s[24:27], s3 offen sc1
    buffer_load_dwordx2 v[74:75], v9, s[24:27], s4 offen sc1
Lwi_interleave_layers__ssm_conv_h3__swiglu_ffn__prompt_kernel_30:
    s_lshl_b32 s33, s37, 9
    s_add_u32 s33, s33, 14024704
    s_mov_b64 exec, 3
    buffer_load_dwordx2 v[10:11], v9, s[24:27], s33 offen sc1
    s_mov_b64 exec, -1
    s_add_u32 s62, s46, 57344
    buffer_load_dwordx4 a[224:227], v7, s[24:27], s62 offen offset:0 sc1
    buffer_load_dwordx4 a[228:231], v7, s[24:27], s62 offen offset:1024 sc1
    buffer_load_dwordx4 a[232:235], v7, s[24:27], s62 offen offset:2048 sc1
    buffer_load_dwordx4 a[236:239], v7, s[24:27], s62 offen offset:3072 sc1
    s_add_u32 s62, s46, 0
    buffer_load_dwordx4 a[0:3], v7, s[24:27], s62 offen offset:0 sc1
    buffer_load_dwordx4 a[4:7], v7, s[24:27], s62 offen offset:1024 sc1
    buffer_load_dwordx4 a[8:11], v7, s[24:27], s62 offen offset:2048 sc1
    buffer_load_dwordx4 a[12:15], v7, s[24:27], s62 offen offset:3072 sc1
    s_waitcnt vmcnt(8)
    s_mov_b64 exec, 3
    s_branch Lpo_interleave_layers__ssm_conv_h3__swiglu_ffn__prompt_kernel_32
Lpr_interleave_layers__ssm_conv_h3__swiglu_ffn__prompt_kernel_31:
    s_sleep 2
    buffer_load_dwordx2 v[10:11], v9, s[24:27], s33 offen sc1
    s_waitcnt vmcnt(0)
    s_sub_u32 s58, s58, 1
    s_cbranch_scc1 Lk2_end
Lpo_interleave_layers__ssm_conv_h3__swiglu_ffn__prompt_kernel_32:
    v_cmp_ne_u64 vcc, v[2:3], v[10:11]
    s_cbranch_vccnz Lpr_interleave_layers__ssm_conv_h3__swiglu_ffn__prompt_kernel_31
    s_mov_b64 exec, -1
    s_cmp_lg_u32 s40, 3
    s_cbranch_scc1 Lpw_interleave_layers__ssm_conv_h3__swiglu_ffn__prompt_kernel_33
    s_branch Lp2_interleave_layers__ssm_conv_h3__swiglu_ffn__prompt_kernel_35
Lp1_interleave_layers__ssm_conv_h3__swiglu_ffn__prompt_kernel_34:
    s_sleep 4
    s_mov_b32 s3, 13697024
    s_mov_b32 s4, 13705216
    buffer_load_dwordx2 v[72:73], v9, s[24:27], s3 offen sc1
    buffer_load_dwordx2 v[74:75], v9, s[24:27], s4 offen sc1
    s_waitcnt vmcnt(0)
    s_sub_u32 s58, s58, 1
    s_cbranch_scc1 Lk2_end
Lp2_interleave_layers__ssm_conv_h3__swiglu_ffn__prompt_kernel_35:
    v_cmp_ne_u64 vcc, s[56:57], v[72:73]
    v_cmp_ne_u64 s[68:69], s[56:57], v[74:75]
    s_nop 0
    s_or_b64 vcc, vcc, s[68:69]
    s_cbranch_vccnz Lp1_interleave_layers__ssm_conv_h3__swiglu_ffn__prompt_kernel_34
    s_mov_b64 exec, -1
Lpw_interleave_layers__ssm_conv_h3__swiglu_ffn__prompt_kernel_33:
    s_add_u32 m0, s49, 0
    s_add_u32 s38, s48, 16785408
    buffer_load_dwordx4 v7, s[24:27], s38 offen offset:0 sc1 lds
    buffer_load_dwordx4 v7, s[24:27], s38 offen offset:1024 sc1 lds
    buffer_load_dwordx4 v7, s[24:27], s38 offen offset:2048 sc1 lds
    buffer_load_dwordx4 v7, s[24:27], s38 offen offset:3072 sc1 lds
    s_add_u32 m0, s49, 4096
    s_add_u32 s38, s48, 16789504
    buffer_load_dwordx4 v7, s[24:27], s38 offen offset:0 sc1 lds
    buffer_load_dwordx4 v7, s[24:27], s38 offen offset:1024 sc1 lds
    buffer_load_dwordx4 v7, s[24:27], s38 offen offset:2048 sc1 lds
    buffer_load_dwordx4 v7, s[24:27], s38 offen offset:3072 sc1 lds
    v_mfma_f32_16x16x32_bf16 v[20:23], a[192:195], a[252:255], v[20:23]
    v_mfma_f32_16x16x32_bf16 v[24:27], a[196:199], a[252:255], v[24:27]
    v_mfma_f32_16x16x32_bf16 v[28:31], a[200:203], a[252:255], v[28:31]
    v_mfma_f32_16x16x32_bf16 v[20:23], a[204:207], a[252:255], v[20:23]
    v_mfma_f32_16x16x32_bf16 v[24:27], a[208:211], a[252:255], v[24:27]
    v_mfma_f32_16x16x32_bf16 v[28:31], a[212:215], a[252:255], v[28:31]
    s_waitcnt vmcnt(15)
    v_mfma_f32_16x16x32_bf16 v[20:23], a[216:219], a[252:255], v[20:23]
    v_mfma_f32_16x16x32_bf16 v[24:27], a[220:223], a[252:255], v[24:27]
    v_mfma_f32_16x16x32_bf16 v[28:31], a[224:227], a[252:255], v[28:31]
    s_waitcnt vmcnt(12)
    v_mfma_f32_16x16x32_bf16 v[20:23], a[228:231], a[252:255], v[20:23]
    v_mfma_f32_16x16x32_bf16 v[24:27], a[232:235], a[252:255], v[24:27]
    v_mfma_f32_16x16x32_bf16 v[28:31], a[236:239], a[252:255], v[28:31]
    s_waitcnt vmcnt(4)
    s_barrier
    ds_read_b128 v[176:179], v7 offset:0
    ds_read_b128 v[180:183], v7 offset:12288
    ds_read_b128 v[184:187], v7 offset:24576
    ds_read_b128 v[188:191], v7 offset:36864
    s_waitcnt lgkmcnt(0)
    v_mfma_f32_16x16x32_bf16 v[80:83], a[96:99], v[176:179], 0
    ds_read_b128 v[192:195], v7 offset:1024
    ds_read_b128 v[196:199], v7 offset:13312
    v_mfma_f32_16x16x32_bf16 v[84:87], a[100:103], v[176:179], 0
    v_mfma_f32_16x16x32_bf16 v[88:91], a[104:107], v[176:179], 0
    ds_read_b128 v[200:203], v7 offset:25600
    ds_read_b128 v[204:207], v7 offset:37888
    v_mfma_f32_16x16x32_bf16 v[92:95], a[96:99], v[180:183], 0
    v_mfma_f32_16x16x32_bf16 v[96:99], a[100:103], v[180:183], 0
    s_add_u32 m0, s49, 8192
    s_add_u32 s38, s48, 16793600
    buffer_load_dwordx4 v7, s[24:27], s38 offen offset:0 sc1 lds
    v_mfma_f32_16x16x32_bf16 v[100:103], a[104:107], v[180:183], 0
    v_mfma_f32_16x16x32_bf16 v[104:107], a[96:99], v[184:187], 0
    v_mfma_f32_16x16x32_bf16 v[108:111], a[100:103], v[184:187], 0
    v_mfma_f32_16x16x32_bf16 v[112:115], a[104:107], v[184:187], 0
    v_mfma_f32_16x16x32_bf16 v[116:119], a[96:99], v[188:191], 0
    buffer_load_dwordx4 v7, s[24:27], s38 offen offset:1024 sc1 lds
    v_mfma_f32_16x16x32_bf16 v[120:123], a[100:103], v[188:191], 0
    v_mfma_f32_16x16x32_bf16 v[124:127], a[104:107], v[188:191], 0
    s_waitcnt lgkmcnt(0)
    v_mfma_f32_16x16x32_bf16 v[80:83], a[108:111], v[192:195], v[80:83]
    ds_read_b128 v[176:179], v7 offset:2048
    ds_read_b128 v[180:183], v7 offset:14336
    v_mfma_f32_16x16x32_bf16 v[84:87], a[112:115], v[192:195], v[84:87]
    v_mfma_f32_16x16x32_bf16 v[88:91], a[116:119], v[192:195], v[88:91]
    ds_read_b128 v[184:187], v7 offset:26624
    ds_read_b128 v[188:191], v7 offset:38912
    buffer_load_dwordx4 v7, s[24:27], s38 offen offset:2048 sc1 lds
    v_mfma_f32_16x16x32_bf16 v[92:95], a[108:111], v[196:199], v[92:95]
    v_mfma_f32_16x16x32_bf16 v[96:99], a[112:115], v[196:199], v[96:99]
    v_mfma_f32_16x16x32_bf16 v[100:103], a[116:119], v[196:199], v[100:103]
    v_mfma_f32_16x16x32_bf16 v[104:107], a[108:111], v[200:203], v[104:107]
    v_mfma_f32_16x16x32_bf16 v[108:111], a[112:115], v[200:203], v[108:111]
    buffer_load_dwordx4 v7, s[24:27], s38 offen offset:3072 sc1 lds
    v_mfma_f32_16x16x32_bf16 v[112:115], a[116:119], v[200:203], v[112:115]
    v_mfma_f32_16x16x32_bf16 v[116:119], a[108:111], v[204:207], v[116:119]
    v_mfma_f32_16x16x32_bf16 v[120:123], a[112:115], v[204:207], v[120:123]
    v_mfma_f32_16x16x32_bf16 v[124:127], a[116:119], v[204:207], v[124:127]
    s_waitcnt lgkmcnt(0)
    v_mfma_f32_16x16x32_bf16 v[80:83], a[120:123], v[176:179], v[80:83]
    ds_read_b128 v[192:195], v7 offset:3072
    ds_read_b128 v[196:199], v7 offset:15360
    s_add_u32 s62, s46, 4096
    buffer_load_dwordx4 a[16:19], v7, s[24:27], s62 offen offset:0 sc1
    v_mfma_f32_16x16x32_bf16 v[84:87], a[124:127], v[176:179], v[84:87]
    s_lshl_b32 s33, s37, 9
    s_add_u32 s33, s33, 14026752
    s_mov_b64 exec, 3
    buffer_load_dwordx2 v[10:11], v9, s[24:27], s33 offen sc1
    s_mov_b64 exec, -1
    v_mfma_f32_16x16x32_bf16 v[88:91], a[128:131], v[176:179], v[88:91]
    ds_read_b128 v[200:203], v7 offset:27648
    ds_read_b128 v[204:207], v7 offset:39936
    v_mfma_f32_16x16x32_bf16 v[92:95], a[120:123], v[180:183], v[92:95]
    v_mfma_f32_16x16x32_bf16 v[96:99], a[124:127], v[180:183], v[96:99]
    v_mfma_f32_16x16x32_bf16 v[100:103], a[128:131], v[180:183], v[100:103]
    buffer_load_dwordx4 a[20:23], v7, s[24:27], s62 offen offset:1024 sc1
    v_mfma_f32_16x16x32_bf16 v[104:107], a[120:123], v[184:187], v[104:107]
    v_mfma_f32_16x16x32_bf16 v[108:111], a[124:127], v[184:187], v[108:111]
    v_mfma_f32_16x16x32_bf16 v[112:115], a[128:131], v[184:187], v[112:115]
    v_mfma_f32_16x16x32_bf16 v[116:119], a[120:123], v[188:191], v[116:119]
    v_mfma_f32_16x16x32_bf16 v[120:123], a[124:127], v[188:191], v[120:123]
    buffer_load_dwordx4 a[24:27], v7, s[24:27], s62 offen offset:2048 sc1
    v_mfma_f32_16x16x32_bf16 v[124:127], a[128:131], v[188:191], v[124:127]
    s_waitcnt lgkmcnt(0)
    s_waitcnt vmcnt(8)
    s_barrier
    v_mfma_f32_16x16x32_bf16 v[80:83], a[132:135], v[192:195], v[80:83]
    ds_read_b128 v[176:179], v7 offset:4096
    ds_read_b128 v[180:183], v7 offset:16384
    v_mfma_f32_16x16x32_bf16 v[84:87], a[136:139], v[192:195], v[84:87]
    v_mfma_f32_16x16x32_bf16 v[88:91], a[140:143], v[192:195], v[88:91]
    ds_read_b128 v[184:187], v7 offset:28672
    ds_read_b128 v[188:191], v7 offset:40960
    v_mfma_f32_16x16x32_bf16 v[92:95], a[132:135], v[196:199], v[92:95]
    s_add_u32 m0, s49, 0
    s_add_u32 s38, s48, 16777216
    buffer_load_dwordx4 v7, s[24:27], s38 offen offset:0 sc1 lds
    v_mfma_f32_16x16x32_bf16 v[96:99], a[136:139], v[196:199], v[96:99]
    v_mfma_f32_16x16x32_bf16 v[100:103], a[140:143], v[196:199], v[100:103]
    v_mfma_f32_16x16x32_bf16 v[104:107], a[132:135], v[200:203], v[104:107]
    v_mfma_f32_16x16x32_bf16 v[108:111], a[136:139], v[200:203], v[108:111]
    v_mfma_f32_16x16x32_bf16 v[112:115], a[140:143], v[200:203], v[112:115]
    buffer_load_dwordx4 v7, s[24:27], s38 offen offset:1024 sc1 lds
    v_mfma_f32_16x16x32_bf16 v[116:119], a[132:135], v[204:207], v[116:119]
    v_mfma_f32_16x16x32_bf16 v[120:123], a[136:139], v[204:207], v[120:123]
    v_mfma_f32_16x16x32_bf16 v[124:127], a[140:143], v[204:207], v[124:127]
    s_waitcnt lgkmcnt(0)
    v_mfma_f32_16x16x32_bf16 v[80:83], a[144:147], v[176:179], v[80:83]
    ds_read_b128 v[192:195], v7 offset:5120
    ds_read_b128 v[196:199], v7 offset:17408
    v_mfma_f32_16x16x32_bf16 v[84:87], a[148:151], v[176:179], v[84:87]
    buffer_load_dwordx4 v7, s[24:27], s38 offen offset:2048 sc1 lds
    v_mfma_f32_16x16x32_bf16 v[88:91], a[152:155], v[176:179], v[88:91]
    ds_read_b128 v[200:203], v7 offset:29696
    ds_read_b128 v[204:207], v7 offset:41984
    v_mfma_f32_16x16x32_bf16 v[92:95], a[144:147], v[180:183], v[92:95]
    v_mfma_f32_16x16x32_bf16 v[96:99], a[148:151], v[180:183], v[96:99]
    v_mfma_f32_16x16x32_bf16 v[100:103], a[152:155], v[180:183], v[100:103]
    v_mfma_f32_16x16x32_bf16 v[104:107], a[144:147], v[184:187], v[104:107]
    buffer_load_dwordx4 v7, s[24:27], s38 offen offset:3072 sc1 lds
    v_mfma_f32_16x16x32_bf16 v[108:111], a[148:151], v[184:187], v[108:111]
    v_mfma_f32_16x16x32_bf16 v[112:115], a[152:155], v[184:187], v[112:115]
    v_mfma_f32_16x16x32_bf16 v[116:119], a[144:147], v[188:191], v[116:119]
    v_mfma_f32_16x16x32_bf16 v[120:123], a[148:151], v[188:191], v[120:123]
    v_mfma_f32_16x16x32_bf16 v[124:127], a[152:155], v[188:191], v[124:127]
    buffer_load_dwordx4 a[28:31], v7, s[24:27], s62 offen offset:3072 sc1
    s_waitcnt lgkmcnt(0)
    v_mfma_f32_16x16x32_bf16 v[80:83], a[156:159], v[192:195], v[80:83]
    ds_read_b128 v[176:179], v7 offset:6144
    ds_read_b128 v[180:183], v7 offset:18432
    v_mfma_f32_16x16x32_bf16 v[84:87], a[160:163], v[192:195], v[84:87]
    v_mfma_f32_16x16x32_bf16 v[88:91], a[164:167], v[192:195], v[88:91]
    ds_read_b128 v[184:187], v7 offset:30720
    ds_read_b128 v[188:191], v7 offset:43008
    v_mfma_f32_16x16x32_bf16 v[92:95], a[156:159], v[196:199], v[92:95]
    v_mfma_f32_16x16x32_bf16 v[96:99], a[160:163], v[196:199], v[96:99]
    s_add_u32 s62, s46, 8192
    buffer_load_dwordx4 a[32:35], v7, s[24:27], s62 offen offset:0 sc1
    v_mfma_f32_16x16x32_bf16 v[100:103], a[164:167], v[196:199], v[100:103]
    v_mfma_f32_16x16x32_bf16 v[104:107], a[156:159], v[200:203], v[104:107]
    v_mfma_f32_16x16x32_bf16 v[108:111], a[160:163], v[200:203], v[108:111]
    v_mfma_f32_16x16x32_bf16 v[112:115], a[164:167], v[200:203], v[112:115]
    v_mfma_f32_16x16x32_bf16 v[116:119], a[156:159], v[204:207], v[116:119]
    buffer_load_dwordx4 a[36:39], v7, s[24:27], s62 offen offset:1024 sc1
    v_mfma_f32_16x16x32_bf16 v[120:123], a[160:163], v[204:207], v[120:123]
    v_mfma_f32_16x16x32_bf16 v[124:127], a[164:167], v[204:207], v[124:127]
    s_waitcnt lgkmcnt(0)
    v_mfma_f32_16x16x32_bf16 v[80:83], a[168:171], v[176:179], v[80:83]
    ds_read_b128 v[192:195], v7 offset:7168
    ds_read_b128 v[196:199], v7 offset:19456
    v_mfma_f32_16x16x32_bf16 v[84:87], a[172:175], v[176:179], v[84:87]
    s_waitcnt vmcnt(9)
    s_mov_b64 exec, 3
    s_branch Lpo_interleave_layers__ssm_conv_h3__swiglu_ffn__prompt_kernel_37
Lpr_interleave_layers__ssm_conv_h3__swiglu_ffn__prompt_kernel_36:
    s_sleep 2
    buffer_load_dwordx2 v[10:11], v9, s[24:27], s33 offen sc1
    s_waitcnt vmcnt(0)
    s_sub_u32 s58, s58, 1
    s_cbranch_scc1 Lk2_end
Lpo_interleave_layers__ssm_conv_h3__swiglu_ffn__prompt_kernel_37:
    v_cmp_ne_u64 vcc, v[2:3], v[10:11]
    s_cbranch_vccnz Lpr_interleave_layers__ssm_conv_h3__swiglu_ffn__prompt_kernel_36
    s_mov_b64 exec, -1
    v_mfma_f32_16x16x32_bf16 v[88:91], a[176:179], v[176:179], v[88:91]
    ds_read_b128 v[200:203], v7 offset:31744
    ds_read_b128 v[204:207], v7 offset:44032
    buffer_load_dwordx4 a[40:43], v7, s[24:27], s62 offen offset:2048 sc1
    v_mfma_f32_16x16x32_bf16 v[92:95], a[168:171], v[180:183], v[92:95]
    s_add_u32 s3, 0, 37748736
    buffer_store_dwordx4 v[220:223], v232, s[24:27], s3 offen sc1
    v_mfma_f32_16x16x32_bf16 v[96:99], a[172:175], v[180:183], v[96:99]
    v_mfma_f32_16x16x32_bf16 v[100:103], a[176:179], v[180:183], v[100:103]
    v_mfma_f32_16x16x32_bf16 v[104:107], a[168:171], v[184:187], v[104:107]
    v_mfma_f32_16x16x32_bf16 v[108:111], a[172:175], v[184:187], v[108:111]
    buffer_load_dwordx4 a[44:47], v7, s[24:27], s62 offen offset:3072 sc1
    v_mfma_f32_16x16x32_bf16 v[112:115], a[176:179], v[184:187], v[112:115]
    v_mfma_f32_16x16x32_bf16 v[116:119], a[168:171], v[188:191], v[116:119]
    v_mfma_f32_16x16x32_bf16 v[120:123], a[172:175], v[188:191], v[120:123]
    v_mfma_f32_16x16x32_bf16 v[124:127], a[176:179], v[188:191], v[124:127]
    s_waitcnt lgkmcnt(0)
    s_barrier
    v_mfma_f32_16x16x32_bf16 v[80:83], a[180:183], v[192:195], v[80:83]
    ds_read_b128 v[176:179], v7 offset:8192
    ds_read_b128 v[180:183], v7 offset:20480
    s_add_u32 m0, s49, 4096
    s_add_u32 s38, s48, 16781312
    buffer_load_dwordx4 v7, s[24:27], s38 offen offset:0 sc1 lds
    v_mfma_f32_16x16x32_bf16 v[84:87], a[184:187], v[192:195], v[84:87]
    v_mfma_f32_16x16x32_bf16 v[88:91], a[188:191], v[192:195], v[88:91]
    ds_read_b128 v[184:187], v7 offset:32768
    ds_read_b128 v[188:191], v7 offset:45056
    v_mfma_f32_16x16x32_bf16 v[92:95], a[180:183], v[196:199], v[92:95]
    v_mfma_f32_16x16x32_bf16 v[96:99], a[184:187], v[196:199], v[96:99]
    v_mfma_f32_16x16x32_bf16 v[100:103], a[188:191], v[196:199], v[100:103]
    buffer_load_dwordx4 v7, s[24:27], s38 offen offset:1024 sc1 lds
    v_mfma_f32_16x16x32_bf16 v[104:107], a[180:183], v[200:203], v[104:107]
    v_mfma_f32_16x16x32_bf16 v[108:111], a[184:187], v[200:203], v[108:111]
    v_mfma_f32_16x16x32_bf16 v[112:115], a[188:191], v[200:203], v[112:115]
    v_mfma_f32_16x16x32_bf16 v[116:119], a[180:183], v[204:207], v[116:119]
    v_mfma_f32_16x16x32_bf16 v[120:123], a[184:187], v[204:207], v[120:123]
    buffer_load_dwordx4 v7, s[24:27], s38 offen offset:2048 sc1 lds
    v_mfma_f32_16x16x32_bf16 v[124:127], a[188:191], v[204:207], v[124:127]
    s_waitcnt lgkmcnt(0)
    v_mfma_f32_16x16x32_bf16 v[80:83], a[192:195], v[176:179], v[80:83]
    ds_read_b128 v[192:195], v7 offset:9216
    ds_read_b128 v[196:199], v7 offset:21504
    v_mfma_f32_16x16x32_bf16 v[84:87], a[196:199], v[176:179], v[84:87]
    s_add_u32 s3, 0, 40894464
    buffer_store_dwordx4 v[208:211], v232, s[24:27], s3 offen sc1
    v_mfma_f32_16x16x32_bf16 v[88:91], a[200:203], v[176:179], v[88:91]
    ds_read_b128 v[200:203], v7 offset:33792
    ds_read_b128 v[204:207], v7 offset:46080
    v_mfma_f32_16x16x32_bf16 v[92:95], a[192:195], v[180:183], v[92:95]
    buffer_load_dwordx4 v7, s[24:27], s38 offen offset:3072 sc1 lds
    v_mfma_f32_16x16x32_bf16 v[96:99], a[196:199], v[180:183], v[96:99]
    v_mfma_f32_16x16x32_bf16 v[100:103], a[200:203], v[180:183], v[100:103]
    v_mfma_f32_16x16x32_bf16 v[104:107], a[192:195], v[184:187], v[104:107]
    v_mfma_f32_16x16x32_bf16 v[108:111], a[196:199], v[184:187], v[108:111]
    v_mfma_f32_16x16x32_bf16 v[112:115], a[200:203], v[184:187], v[112:115]
    s_add_u32 s62, s46, 12288
    buffer_load_dwordx4 a[48:51], v7, s[24:27], s62 offen offset:0 sc1
    v_mfma_f32_16x16x32_bf16 v[116:119], a[192:195], v[188:191], v[116:119]
    v_mfma_f32_16x16x32_bf16 v[120:123], a[196:199], v[188:191], v[120:123]
    v_mfma_f32_16x16x32_bf16 v[124:127], a[200:203], v[188:191], v[124:127]
    s_waitcnt lgkmcnt(0)
    v_mfma_f32_16x16x32_bf16 v[80:83], a[204:207], v[192:195], v[80:83]
    ds_read_b128 v[176:179], v7 offset:10240
    ds_read_b128 v[180:183], v7 offset:22528
    v_mfma_f32_16x16x32_bf16 v[84:87], a[208:211], v[192:195], v[84:87]
    buffer_load_dwordx4 a[52:55], v7, s[24:27], s62 offen offset:1024 sc1
    v_mfma_f32_16x16x32_bf16 v[88:91], a[212:215], v[192:195], v[88:91]
    ds_read_b128 v[184:187], v7 offset:34816
    ds_read_b128 v[188:191], v7 offset:47104
    v_mfma_f32_16x16x32_bf16 v[92:95], a[204:207], v[196:199], v[92:95]
    v_mfma_f32_16x16x32_bf16 v[96:99], a[208:211], v[196:199], v[96:99]
    v_mfma_f32_16x16x32_bf16 v[100:103], a[212:215], v[196:199], v[100:103]
    v_mfma_f32_16x16x32_bf16 v[104:107], a[204:207], v[200:203], v[104:107]
    buffer_load_dwordx4 a[56:59], v7, s[24:27], s62 offen offset:2048 sc1
    v_mfma_f32_16x16x32_bf16 v[108:111], a[208:211], v[200:203], v[108:111]
    v_mfma_f32_16x16x32_bf16 v[112:115], a[212:215], v[200:203], v[112:115]
    v_mfma_f32_16x16x32_bf16 v[116:119], a[204:207], v[204:207], v[116:119]
    v_mfma_f32_16x16x32_bf16 v[120:123], a[208:211], v[204:207], v[120:123]
    s_add_u32 s3, 0, 37756928
    buffer_store_dwordx4 v[224:227], v232, s[24:27], s3 offen sc1
    v_mfma_f32_16x16x32_bf16 v[124:127], a[212:215], v[204:207], v[124:127]
    buffer_load_dwordx4 a[60:63], v7, s[24:27], s62 offen offset:3072 sc1
    s_waitcnt lgkmcnt(0)
    v_mfma_f32_16x16x32_bf16 v[80:83], a[216:219], v[176:179], v[80:83]
    ds_read_b128 v[192:195], v7 offset:11264
    ds_read_b128 v[196:199], v7 offset:23552
    v_mfma_f32_16x16x32_bf16 v[84:87], a[220:223], v[176:179], v[84:87]
    v_mfma_f32_16x16x32_bf16 v[88:91], a[224:227], v[176:179], v[88:91]
    ds_read_b128 v[200:203], v7 offset:35840
    ds_read_b128 v[204:207], v7 offset:48128
    v_mfma_f32_16x16x32_bf16 v[92:95], a[216:219], v[180:183], v[92:95]
    v_mfma_f32_16x16x32_bf16 v[96:99], a[220:223], v[180:183], v[96:99]
    s_add_u32 s62, s46, 16384
    buffer_load_dwordx4 a[64:67], v7, s[24:27], s62 offen offset:0 sc1
    v_mfma_f32_16x16x32_bf16 v[100:103], a[224:227], v[180:183], v[100:103]
    v_mfma_f32_16x16x32_bf16 v[104:107], a[216:219], v[184:187], v[104:107]
    v_mfma_f32_16x16x32_bf16 v[108:111], a[220:223], v[184:187], v[108:111]
    v_mfma_f32_16x16x32_bf16 v[112:115], a[224:227], v[184:187], v[112:115]
    v_mfma_f32_16x16x32_bf16 v[116:119], a[216:219], v[188:191], v[116:119]
    buffer_load_dwordx4 a[68:71], v7, s[24:27], s62 offen offset:1024 sc1
    v_mfma_f32_16x16x32_bf16 v[120:123], a[220:223], v[188:191], v[120:123]
    v_mfma_f32_16x16x32_bf16 v[124:127], a[224:227], v[188:191], v[124:127]
    s_waitcnt lgkmcnt(0)
    s_waitcnt vmcnt(18)
    s_barrier
    v_mfma_f32_16x16x32_bf16 v[80:83], a[228:231], v[192:195], v[80:83]
    ds_read_b128 v[176:179], v7 offset:0
    ds_read_b128 v[180:183], v7 offset:12288
    v_mfma_f32_16x16x32_bf16 v[84:87], a[232:235], v[192:195], v[84:87]
    v_mfma_f32_16x16x32_bf16 v[88:91], a[236:239], v[192:195], v[88:91]
    ds_read_b128 v[184:187], v7 offset:24576
    ds_read_b128 v[188:191], v7 offset:36864
    s_add_u32 m0, s49, 8192
    s_add_u32 s38, s48, 16867328
    buffer_load_dwordx4 v7, s[24:27], s38 offen offset:0 sc1 lds
    v_mfma_f32_16x16x32_bf16 v[92:95], a[228:231], v[196:199], v[92:95]
    v_mfma_f32_16x16x32_bf16 v[96:99], a[232:235], v[196:199], v[96:99]
    v_mfma_f32_16x16x32_bf16 v[100:103], a[236:239], v[196:199], v[100:103]
    v_mfma_f32_16x16x32_bf16 v[104:107], a[228:231], v[200:203], v[104:107]
    v_mfma_f32_16x16x32_bf16 v[108:111], a[232:235], v[200:203], v[108:111]
    buffer_load_dwordx4 v7, s[24:27], s38 offen offset:1024 sc1 lds
    v_mfma_f32_16x16x32_bf16 v[112:115], a[236:239], v[200:203], v[112:115]
    v_mfma_f32_16x16x32_bf16 v[116:119], a[228:231], v[204:207], v[116:119]
    s_add_u32 s3, 0, 40902656
    buffer_store_dwordx4 v[212:215], v232, s[24:27], s3 offen sc1
    v_mfma_f32_16x16x32_bf16 v[120:123], a[232:235], v[204:207], v[120:123]
    v_mfma_f32_16x16x32_bf16 v[124:127], a[236:239], v[204:207], v[124:127]
    s_waitcnt lgkmcnt(0)
    v_mfma_f32_16x16x32_bf16 v[80:83], a[0:3], v[176:179], v[80:83]
    ds_read_b128 v[192:195], v7 offset:1024
    ds_read_b128 v[196:199], v7 offset:13312
    buffer_load_dwordx4 v7, s[24:27], s38 offen offset:2048 sc1 lds
    v_mfma_f32_16x16x32_bf16 v[84:87], a[4:7], v[176:179], v[84:87]
    v_mfma_f32_16x16x32_bf16 v[88:91], a[8:11], v[176:179], v[88:91]
    ds_read_b128 v[200:203], v7 offset:25600
    ds_read_b128 v[204:207], v7 offset:37888
    v_mfma_f32_16x16x32_bf16 v[92:95], a[0:3], v[180:183], v[92:95]
    v_mfma_f32_16x16x32_bf16 v[96:99], a[4:7], v[180:183], v[96:99]
    v_mfma_f32_16x16x32_bf16 v[100:103], a[8:11], v[180:183], v[100:103]
    buffer_load_dwordx4 v7, s[24:27], s38 offen offset:3072 sc1 lds
    v_mfma_f32_16x16x32_bf16 v[104:107], a[0:3], v[184:187], v[104:107]
    v_mfma_f32_16x16x32_bf16 v[108:111], a[4:7], v[184:187], v[108:111]
    v_mfma_f32_16x16x32_bf16 v[112:115], a[8:11], v[184:187], v[112:115]
    v_mfma_f32_16x16x32_bf16 v[116:119], a[0:3], v[188:191], v[116:119]
    v_mfma_f32_16x16x32_bf16 v[120:123], a[4:7], v[188:191], v[120:123]
    buffer_load_dwordx4 a[72:75], v7, s[24:27], s62 offen offset:2048 sc1
    v_mfma_f32_16x16x32_bf16 v[124:127], a[8:11], v[188:191], v[124:127]
    s_waitcnt lgkmcnt(0)
    v_mfma_f32_16x16x32_bf16 v[80:83], a[12:15], v[192:195], v[80:83]
    ds_read_b128 v[176:179], v7 offset:2048
    ds_read_b128 v[180:183], v7 offset:14336
    v_mfma_f32_16x16x32_bf16 v[84:87], a[16:19], v[192:195], v[84:87]
    v_mfma_f32_16x16x32_bf16 v[88:91], a[20:23], v[192:195], v[88:91]
    ds_read_b128 v[184:187], v7 offset:26624
    ds_read_b128 v[188:191], v7 offset:38912
    v_mfma_f32_16x16x32_bf16 v[92:95], a[12:15], v[196:199], v[92:95]
    buffer_load_dwordx4 a[76:79], v7, s[24:27], s62 offen offset:3072 sc1
    v_mfma_f32_16x16x32_bf16 v[96:99], a[16:19], v[196:199], v[96:99]
    v_mfma_f32_16x16x32_bf16 v[100:103], a[20:23], v[196:199], v[100:103]
    v_mfma_f32_16x16x32_bf16 v[104:107], a[12:15], v[200:203], v[104:107]
    s_add_u32 s3, s28, 37765120
    buffer_store_dwordx4 v[228:231], v232, s[24:27], s3 offen sc1
    v_mfma_f32_16x16x32_bf16 v[108:111], a[16:19], v[200:203], v[108:111]
    v_mfma_f32_16x16x32_bf16 v[112:115], a[20:23], v[200:203], v[112:115]
    s_add_u32 s62, s46, 20480
    buffer_load_dwordx4 a[80:83], v7, s[24:27], s62 offen offset:0 sc1
    v_mfma_f32_16x16x32_bf16 v[116:119], a[12:15], v[204:207], v[116:119]
    v_mfma_f32_16x16x32_bf16 v[120:123], a[16:19], v[204:207], v[120:123]
    v_mfma_f32_16x16x32_bf16 v[124:127], a[20:23], v[204:207], v[124:127]
    s_waitcnt vmcnt(25)
    s_waitcnt lgkmcnt(0)
    v_mfma_f32_16x16x32_bf16 v[80:83], a[24:27], v[176:179], v[80:83]
    ds_read_b128 v[192:195], v7 offset:3072
    ds_read_b128 v[196:199], v7 offset:15360
    v_mfma_f32_16x16x32_bf16 v[84:87], a[28:31], v[176:179], v[84:87]
    buffer_load_dwordx4 a[84:87], v7, s[24:27], s62 offen offset:1024 sc1
    v_mfma_f32_16x16x32_bf16 v[88:91], a[32:35], v[176:179], v[88:91]
    ds_read_b128 v[200:203], v7 offset:27648
    ds_read_b128 v[204:207], v7 offset:39936
    v_mfma_f32_16x16x32_bf16 v[92:95], a[24:27], v[180:183], v[92:95]
    v_mfma_f32_16x16x32_bf16 v[96:99], a[28:31], v[180:183], v[96:99]
    v_mfma_f32_16x16x32_bf16 v[100:103], a[32:35], v[180:183], v[100:103]
    v_mfma_f32_16x16x32_bf16 v[104:107], a[24:27], v[184:187], v[104:107]
    buffer_load_dwordx4 a[88:91], v7, s[24:27], s62 offen offset:2048 sc1
    v_mfma_f32_16x16x32_bf16 v[108:111], a[28:31], v[184:187], v[108:111]
    v_mfma_f32_16x16x32_bf16 v[112:115], a[32:35], v[184:187], v[112:115]
    v_mfma_f32_16x16x32_bf16 v[116:119], a[24:27], v[188:191], v[116:119]
    v_mfma_f32_16x16x32_bf16 v[120:123], a[28:31], v[188:191], v[120:123]
    v_mfma_f32_16x16x32_bf16 v[124:127], a[32:35], v[188:191], v[124:127]
    buffer_load_dwordx4 a[92:95], v7, s[24:27], s62 offen offset:3072 sc1
    s_waitcnt vmcnt(24)
    s_waitcnt lgkmcnt(0)
    s_waitcnt vmcnt(19)
    s_barrier
    v_mfma_f32_16x16x32_bf16 v[80:83], a[36:39], v[192:195], v[80:83]
    ds_read_b128 v[176:179], v7 offset:4096
    ds_read_b128 v[180:183], v7 offset:16384
    v_mfma_f32_16x16x32_bf16 v[84:87], a[40:43], v[192:195], v[84:87]
    v_mfma_f32_16x16x32_bf16 v[88:91], a[44:47], v[192:195], v[88:91]
    ds_read_b128 v[184:187], v7 offset:28672
    ds_read_b128 v[188:191], v7 offset:40960
    v_mfma_f32_16x16x32_bf16 v[92:95], a[36:39], v[196:199], v[92:95]
    v_mfma_f32_16x16x32_bf16 v[96:99], a[40:43], v[196:199], v[96:99]
    s_add_u32 m0, s49, 0
    s_add_u32 s38, s48, 16871424
    buffer_load_dwordx4 v7, s[24:27], s38 offen offset:0 sc1 lds
    v_mfma_f32_16x16x32_bf16 v[100:103], a[44:47], v[196:199], v[100:103]
    v_mfma_f32_16x16x32_bf16 v[104:107], a[36:39], v[200:203], v[104:107]
    s_add_u32 s3, s28, 40910848
    buffer_store_dwordx4 v[216:219], v232, s[24:27], s3 offen sc1
    v_mfma_f32_16x16x32_bf16 v[108:111], a[40:43], v[200:203], v[108:111]
    v_mfma_f32_16x16x32_bf16 v[112:115], a[44:47], v[200:203], v[112:115]
    v_mfma_f32_16x16x32_bf16 v[116:119], a[36:39], v[204:207], v[116:119]
    buffer_load_dwordx4 v7, s[24:27], s38 offen offset:1024 sc1 lds
    v_mfma_f32_16x16x32_bf16 v[120:123], a[40:43], v[204:207], v[120:123]
    v_mfma_f32_16x16x32_bf16 v[124:127], a[44:47], v[204:207], v[124:127]
    s_waitcnt vmcnt(19)
    s_waitcnt lgkmcnt(0)
    v_mfma_f32_16x16x32_bf16 v[80:83], a[48:51], v[176:179], v[80:83]
    ds_read_b128 v[192:195], v7 offset:5120
    ds_read_b128 v[196:199], v7 offset:17408
    v_mfma_f32_16x16x32_bf16 v[84:87], a[52:55], v[176:179], v[84:87]
    v_mfma_f32_16x16x32_bf16 v[88:91], a[56:59], v[176:179], v[88:91]
    ds_read_b128 v[200:203], v7 offset:29696
    ds_read_b128 v[204:207], v7 offset:41984
    buffer_load_dwordx4 v7, s[24:27], s38 offen offset:2048 sc1 lds
    v_mfma_f32_16x16x32_bf16 v[92:95], a[48:51], v[180:183], v[92:95]
    v_mfma_f32_16x16x32_bf16 v[96:99], a[52:55], v[180:183], v[96:99]
    v_mfma_f32_16x16x32_bf16 v[100:103], a[56:59], v[180:183], v[100:103]
    v_mfma_f32_16x16x32_bf16 v[104:107], a[48:51], v[184:187], v[104:107]
    v_mfma_f32_16x16x32_bf16 v[108:111], a[52:55], v[184:187], v[108:111]
    buffer_load_dwordx4 v7, s[24:27], s38 offen offset:3072 sc1 lds
    v_mfma_f32_16x16x32_bf16 v[112:115], a[56:59], v[184:187], v[112:115]
    v_mfma_f32_16x16x32_bf16 v[116:119], a[48:51], v[188:191], v[116:119]
    v_mfma_f32_16x16x32_bf16 v[120:123], a[52:55], v[188:191], v[120:123]
    v_mfma_f32_16x16x32_bf16 v[124:127], a[56:59], v[188:191], v[124:127]
    s_waitcnt vmcnt(17)
    s_waitcnt lgkmcnt(0)
    v_mfma_f32_16x16x32_bf16 v[80:83], a[60:63], v[192:195], v[80:83]
    ds_read_b128 v[176:179], v7 offset:6144
    ds_read_b128 v[180:183], v7 offset:18432
    s_add_u32 m0, s51, 0
    s_add_u32 s38, s47, 0
    buffer_load_dwordx4 v7, s[24:27], s38 offen offset:0 sc1 lds
    v_mfma_f32_16x16x32_bf16 v[84:87], a[64:67], v[192:195], v[84:87]
    v_mfma_f32_16x16x32_bf16 v[88:91], a[68:71], v[192:195], v[88:91]
    ds_read_b128 v[184:187], v7 offset:30720
    ds_read_b128 v[188:191], v7 offset:43008
    v_mfma_f32_16x16x32_bf16 v[92:95], a[60:63], v[196:199], v[92:95]
    v_mfma_f32_16x16x32_bf16 v[96:99], a[64:67], v[196:199], v[96:99]
    v_mfma_f32_16x16x32_bf16 v[100:103], a[68:71], v[196:199], v[100:103]
    buffer_load_dwordx4 v7, s[24:27], s38 offen offset:1024 sc1 lds
    v_mfma_f32_16x16x32_bf16 v[104:107], a[60:63], v[200:203], v[104:107]
    v_mfma_f32_16x16x32_bf16 v[108:111], a[64:67], v[200:203], v[108:111]
    v_mfma_f32_16x16x32_bf16 v[112:115], a[68:71], v[200:203], v[112:115]
    v_mfma_f32_16x16x32_bf16 v[116:119], a[60:63], v[204:207], v[116:119]
    v_mfma_f32_16x16x32_bf16 v[120:123], a[64:67], v[204:207], v[120:123]
    buffer_load_dwordx4 v7, s[24:27], s38 offen offset:2048 sc1 lds
    v_mfma_f32_16x16x32_bf16 v[124:127], a[68:71], v[204:207], v[124:127]
    s_waitcnt vmcnt(11)
    s_waitcnt lgkmcnt(0)
    v_mfma_f32_16x16x32_bf16 v[80:83], a[72:75], v[176:179], v[80:83]
    ds_read_b128 v[192:195], v7 offset:7168
    ds_read_b128 v[196:199], v7 offset:19456
    v_mfma_f32_16x16x32_bf16 v[84:87], a[76:79], v[176:179], v[84:87]
    v_mfma_f32_16x16x32_bf16 v[88:91], a[80:83], v[176:179], v[88:91]
    ds_read_b128 v[200:203], v7 offset:31744
    ds_read_b128 v[204:207], v7 offset:44032
    v_mfma_f32_16x16x32_bf16 v[92:95], a[72:75], v[180:183], v[92:95]
    buffer_load_dwordx4 v7, s[24:27], s38 offen offset:3072 sc1 lds
    v_mfma_f32_16x16x32_bf16 v[96:99], a[76:79], v[180:183], v[96:99]
    v_mfma_f32_16x16x32_bf16 v[100:103], a[80:83], v[180:183], v[100:103]
    v_mfma_f32_16x16x32_bf16 v[104:107], a[72:75], v[184:187], v[104:107]
    v_mfma_f32_16x16x32_bf16 v[108:111], a[76:79], v[184:187], v[108:111]
    v_mfma_f32_16x16x32_bf16 v[112:115], a[80:83], v[184:187], v[112:115]
    s_add_u32 m0, s51, 4096
    s_add_u32 s38, s47, 4096
    buffer_load_dwordx4 v7, s[24:27], s38 offen offset:0 sc1 lds
    v_mfma_f32_16x16x32_bf16 v[116:119], a[72:75], v[188:191], v[116:119]
    v_mfma_f32_16x16x32_bf16 v[120:123], a[76:79], v[188:191], v[120:123]
    v_mfma_f32_16x16x32_bf16 v[124:127], a[80:83], v[188:191], v[124:127]
    s_waitcnt vmcnt(10)
    s_waitcnt lgkmcnt(0)
    s_barrier
    v_mfma_f32_16x16x32_bf16 v[80:83], a[84:87], v[192:195], v[80:83]
    ds_read_b128 v[176:179], v7 offset:8192
    ds_read_b128 v[180:183], v7 offset:20480
    v_mfma_f32_16x16x32_bf16 v[84:87], a[88:91], v[192:195], v[84:87]
    s_add_u32 m0, s49, 4096
    s_add_u32 s38, s48, 16875520
    buffer_load_dwordx4 v7, s[24:27], s38 offen offset:0 sc1 lds
    v_mfma_f32_16x16x32_bf16 v[88:91], a[92:95], v[192:195], v[88:91]
    ds_read_b128 v[184:187], v7 offset:32768
    ds_read_b128 v[188:191], v7 offset:45056
    v_mfma_f32_16x16x32_bf16 v[92:95], a[84:87], v[196:199], v[92:95]
    v_mfma_f32_16x16x32_bf16 v[96:99], a[88:91], v[196:199], v[96:99]
    v_mfma_f32_16x16x32_bf16 v[100:103], a[92:95], v[196:199], v[100:103]
    v_mfma_f32_16x16x32_bf16 v[104:107], a[84:87], v[200:203], v[104:107]
    buffer_load_dwordx4 v7, s[24:27], s38 offen offset:1024 sc1 lds
    v_mfma_f32_16x16x32_bf16 v[108:111], a[88:91], v[200:203], v[108:111]
    v_mfma_f32_16x16x32_bf16 v[112:115], a[92:95], v[200:203], v[112:115]
    v_mfma_f32_16x16x32_bf16 v[116:119], a[84:87], v[204:207], v[116:119]
    v_mfma_f32_16x16x32_bf16 v[120:123], a[88:91], v[204:207], v[120:123]
    v_mfma_f32_16x16x32_bf16 v[124:127], a[92:95], v[204:207], v[124:127]
    buffer_load_dwordx4 v7, s[24:27], s38 offen offset:2048 sc1 lds
    v_mov_b32 v44, 0xbfb8aa3b
    v_pk_mul_f32 v[56:57], v[80:81], v[44:45] op_sel_hi:[1,0]
    v_pk_mul_f32 v[58:59], v[84:85], v[44:45] op_sel_hi:[1,0]
    v_pk_mul_f32 v[60:61], v[88:89], v[44:45] op_sel_hi:[1,0]
    v_pk_mul_f32 v[62:63], v[92:93], v[44:45] op_sel_hi:[1,0]
    v_pk_mul_f32 v[64:65], v[96:97], v[44:45] op_sel_hi:[1,0]
    v_pk_mul_f32 v[66:67], v[100:101], v[44:45] op_sel_hi:[1,0]
    v_exp_f32 v56, v56
    v_exp_f32 v57, v57
    v_exp_f32 v58, v58
    v_exp_f32 v59, v59
    v_exp_f32 v60, v60
    v_exp_f32 v61, v61
    v_exp_f32 v62, v62
    buffer_load_dwordx4 v7, s[24:27], s38 offen offset:3072 sc1 lds
    v_exp_f32 v63, v63
    v_exp_f32 v64, v64
    v_exp_f32 v65, v65
    v_exp_f32 v66, v66
    v_exp_f32 v67, v67
    v_pk_mul_f32 v[80:81], v[80:81], v[82:83]
    v_pk_mul_f32 v[84:85], v[84:85], v[86:87]
    v_pk_mul_f32 v[88:89], v[88:89], v[90:91]
    v_pk_mul_f32 v[92:93], v[92:93], v[94:95]
    v_pk_mul_f32 v[96:97], v[96:97], v[98:99]
    v_pk_mul_f32 v[100:101], v[100:101], v[102:103]
    v_pk_add_f32 v[56:57], v[56:57], 1.0 op_sel_hi:[1,0]
    v_pk_add_f32 v[58:59], v[58:59], 1.0 op_sel_hi:[1,0]
    v_pk_add_f32 v[60:61], v[60:61], 1.0 op_sel_hi:[1,0]
    v_pk_add_f32 v[62:63], v[62:63], 1.0 op_sel_hi:[1,0]
    s_add_u32 m0, s51, 4096
    s_add_u32 s38, s47, 4096
    buffer_load_dwordx4 v7, s[24:27], s38 offen offset:1024 sc1 lds
    v_pk_add_f32 v[64:65], v[64:65], 1.0 op_sel_hi:[1,0]
    v_pk_add_f32 v[66:67], v[66:67], 1.0 op_sel_hi:[1,0]
    v_rcp_f32 v56, v56
    v_rcp_f32 v57, v57
    v_rcp_f32 v58, v58
    v_rcp_f32 v59, v59
    v_rcp_f32 v60, v60
    v_rcp_f32 v61, v61
    v_rcp_f32 v62, v62
    v_rcp_f32 v63, v63
    v_rcp_f32 v64, v64
    buffer_load_dwordx4 v7, s[24:27], s38 offen offset:2048 sc1 lds
    v_rcp_f32 v65, v65
    v_rcp_f32 v66, v66
    v_rcp_f32 v67, v67
    v_pk_mul_f32 v[80:81], v[80:81], v[56:57]
    v_pk_mul_f32 v[84:85], v[84:85], v[58:59]
    v_pk_mul_f32 v[88:89], v[88:89], v[60:61]
    v_pk_mul_f32 v[92:93], v[92:93], v[62:63]
    v_pk_mul_f32 v[96:97], v[96:97], v[64:65]
    v_pk_mul_f32 v[100:101], v[100:101], v[66:67]
    v_cvt_pk_bf16_f32 v76, v80, v81
    v_cvt_pk_bf16_f32 v77, v84, v85
    v_cvt_pk_bf16_f32 v78, v88, v89
    v_cvt_pk_bf16_f32 v71, v88, v89
    v_cvt_pk_bf16_f32 v68, v80, v81
    v_permlane16_swap_b32 v76, v77
    v_cvt_pk_bf16_f32 v69, v84, v85
    v_permlane16_swap_b32 v78, v71
    buffer_load_dwordx4 v7, s[24:27], s38 offen offset:3072 sc1 lds
    v_cvt_pk_bf16_f32 v70, v88, v89
    s_add_u32 s6, s36, 23068672
    v_permlane32_swap_b32 v77, v71
    s_mov_b64 exec, s[64:65]
    buffer_store_dwordx4 v[68:71], v7, s[24:27], s6 offen sc1
    s_mov_b64 exec, -1
    v_cvt_pk_bf16_f32 v76, v92, v93
    v_cvt_pk_bf16_f32 v77, v96, v97
    v_cvt_pk_bf16_f32 v78, v100, v101
    v_cvt_pk_bf16_f32 v75, v100, v101
    v_cvt_pk_bf16_f32 v72, v92, v93
    v_permlane16_swap_b32 v76, v77
    v_cvt_pk_bf16_f32 v73, v96, v97
    v_permlane16_swap_b32 v78, v75
    v_cvt_pk_bf16_f32 v74, v100, v101
    s_add_u32 s6, s36, 23117824
    v_permlane32_swap_b32 v77, v75
    s_mov_b64 exec, s[64:65]
    buffer_store_dwordx4 v[72:75], v7, s[24:27], s6 offen sc1
    s_mov_b64 exec, -1
    v_pk_mul_f32 v[56:57], v[104:105], v[44:45] op_sel_hi:[1,0]
    v_pk_mul_f32 v[58:59], v[108:109], v[44:45] op_sel_hi:[1,0]
    v_pk_mul_f32 v[60:61], v[112:113], v[44:45] op_sel_hi:[1,0]
    v_pk_mul_f32 v[62:63], v[116:117], v[44:45] op_sel_hi:[1,0]
    v_pk_mul_f32 v[64:65], v[120:121], v[44:45] op_sel_hi:[1,0]
    v_pk_mul_f32 v[66:67], v[124:125], v[44:45] op_sel_hi:[1,0]
    s_add_u32 m0, s51, 8192
    s_add_u32 s38, s47, 8192
    buffer_load_dwordx4 v7, s[24:27], s38 offen offset:0 sc1 lds
    v_exp_f32 v56, v56
    v_exp_f32 v57, v57
    v_exp_f32 v58, v58
    v_exp_f32 v59, v59
    v_exp_f32 v60, v60
    v_exp_f32 v61, v61
    v_exp_f32 v62, v62
    v_exp_f32 v63, v63
    v_exp_f32 v64, v64
    v_exp_f32 v65, v65
    buffer_load_dwordx4 v7, s[24:27], s38 offen offset:1024 sc1 lds
    v_exp_f32 v66, v66
    v_exp_f32 v67, v67
    v_pk_mul_f32 v[104:105], v[104:105], v[106:107]
    v_pk_mul_f32 v[108:109], v[108:109], v[110:111]
    v_pk_mul_f32 v[112:113], v[112:113], v[114:115]
    v_pk_mul_f32 v[116:117], v[116:117], v[118:119]
    v_pk_mul_f32 v[120:121], v[120:121], v[122:123]
    v_pk_mul_f32 v[124:125], v[124:125], v[126:127]
    v_pk_add_f32 v[56:57], v[56:57], 1.0 op_sel_hi:[1,0]
    v_pk_add_f32 v[58:59], v[58:59], 1.0 op_sel_hi:[1,0]
    v_pk_add_f32 v[60:61], v[60:61], 1.0 op_sel_hi:[1,0]
    v_pk_add_f32 v[62:63], v[62:63], 1.0 op_sel_hi:[1,0]
    v_pk_add_f32 v[64:65], v[64:65], 1.0 op_sel_hi:[1,0]
    v_pk_add_f32 v[66:67], v[66:67], 1.0 op_sel_hi:[1,0]
    v_rcp_f32 v56, v56
    v_rcp_f32 v57, v57
    buffer_load_dwordx4 v7, s[24:27], s38 offen offset:2048 sc1 lds
    v_rcp_f32 v58, v58
    v_rcp_f32 v59, v59
    v_rcp_f32 v60, v60
    v_rcp_f32 v61, v61
    v_rcp_f32 v62, v62
    v_rcp_f32 v63, v63
    v_rcp_f32 v64, v64
    v_rcp_f32 v65, v65
    v_rcp_f32 v66, v66
    v_rcp_f32 v67, v67
    buffer_load_dwordx4 v7, s[24:27], s38 offen offset:3072 sc1 lds
    v_pk_mul_f32 v[104:105], v[104:105], v[56:57]
    v_pk_mul_f32 v[108:109], v[108:109], v[58:59]
    v_pk_mul_f32 v[112:113], v[112:113], v[60:61]
    v_pk_mul_f32 v[116:117], v[116:117], v[62:63]
    v_pk_mul_f32 v[120:121], v[120:121], v[64:65]
    v_pk_mul_f32 v[124:125], v[124:125], v[66:67]
    v_cvt_pk_bf16_f32 v76, v104, v105
    v_cvt_pk_bf16_f32 v77, v108, v109
    v_cvt_pk_bf16_f32 v78, v112, v113
    v_cvt_pk_bf16_f32 v71, v112, v113
    v_cvt_pk_bf16_f32 v68, v104, v105
    v_permlane16_swap_b32 v76, v77
    v_cvt_pk_bf16_f32 v69, v108, v109
    v_permlane16_swap_b32 v78, v71
    v_cvt_pk_bf16_f32 v70, v112, v113
    s_add_u32 s6, s36, 23166976
    v_permlane32_swap_b32 v77, v71
    s_mov_b64 exec, s[64:65]
    buffer_store_dwordx4 v[68:71], v7, s[24:27], s6 offen sc1
    s_mov_b64 exec, -1
    v_cvt_pk_bf16_f32 v76, v116, v117
    v_cvt_pk_bf16_f32 v77, v120, v121
    v_cvt_pk_bf16_f32 v78, v124, v125
    s_add_u32 m0, s51, 12288
    s_add_u32 s38, s47, 12288
    buffer_load_dwordx4 v7, s[24:27], s38 offen offset:0 sc1 lds
    v_cvt_pk_bf16_f32 v75, v124, v125
    v_cvt_pk_bf16_f32 v72, v116, v117
    v_permlane16_swap_b32 v76, v77
    v_cvt_pk_bf16_f32 v73, v120, v121
    v_permlane16_swap_b32 v78, v75
    v_cvt_pk_bf16_f32 v74, v124, v125
    s_add_u32 s6, s36, 23216128
    v_permlane32_swap_b32 v77, v75
    s_mov_b64 exec, s[64:65]
    buffer_store_dwordx4 v[72:75], v7, s[24:27], s6 offen sc1
    s_mov_b64 exec, -1
    s_waitcnt lgkmcnt(0)
    v_mfma_f32_16x16x32_bf16 v[128:131], a[96:99], v[176:179], 0
    ds_read_b128 v[192:195], v7 offset:9216
    ds_read_b128 v[196:199], v7 offset:21504
    v_mfma_f32_16x16x32_bf16 v[132:135], a[100:103], v[176:179], 0
    v_mfma_f32_16x16x32_bf16 v[136:139], a[104:107], v[176:179], 0
    ds_read_b128 v[200:203], v7 offset:33792
    ds_read_b128 v[204:207], v7 offset:46080
    buffer_load_dwordx4 v7, s[24:27], s38 offen offset:1024 sc1 lds
    v_mfma_f32_16x16x32_bf16 v[140:143], a[96:99], v[180:183], 0
    v_mfma_f32_16x16x32_bf16 v[144:147], a[100:103], v[180:183], 0
    v_mfma_f32_16x16x32_bf16 v[148:151], a[104:107], v[180:183], 0
    v_mfma_f32_16x16x32_bf16 v[152:155], a[96:99], v[184:187], 0
    v_mfma_f32_16x16x32_bf16 v[156:159], a[100:103], v[184:187], 0
    buffer_load_dwordx4 v7, s[24:27], s38 offen offset:2048 sc1 lds
    v_mfma_f32_16x16x32_bf16 v[160:163], a[104:107], v[184:187], 0
    v_mfma_f32_16x16x32_bf16 v[164:167], a[96:99], v[188:191], 0
    v_mfma_f32_16x16x32_bf16 v[168:171], a[100:103], v[188:191], 0
    v_mfma_f32_16x16x32_bf16 v[172:175], a[104:107], v[188:191], 0
    s_waitcnt lgkmcnt(0)
    v_mfma_f32_16x16x32_bf16 v[128:131], a[108:111], v[192:195], v[128:131]
    ds_read_b128 v[176:179], v7 offset:10240
    ds_read_b128 v[180:183], v7 offset:22528
    buffer_load_dwordx4 v7, s[24:27], s38 offen offset:3072 sc1 lds
    v_mfma_f32_16x16x32_bf16 v[132:135], a[112:115], v[192:195], v[132:135]
    v_mfma_f32_16x16x32_bf16 v[136:139], a[116:119], v[192:195], v[136:139]
    ds_read_b128 v[184:187], v7 offset:34816
    ds_read_b128 v[188:191], v7 offset:47104
    v_mfma_f32_16x16x32_bf16 v[140:143], a[108:111], v[196:199], v[140:143]
    v_mfma_f32_16x16x32_bf16 v[144:147], a[112:115], v[196:199], v[144:147]
    v_mfma_f32_16x16x32_bf16 v[148:151], a[116:119], v[196:199], v[148:151]
    s_add_u32 m0, s51, 16384
    s_add_u32 s38, s47, 16384
    buffer_load_dwordx4 v7, s[24:27], s38 offen offset:0 sc1 lds
    v_mfma_f32_16x16x32_bf16 v[152:155], a[108:111], v[200:203], v[152:155]
    v_mfma_f32_16x16x32_bf16 v[156:159], a[112:115], v[200:203], v[156:159]
    v_mfma_f32_16x16x32_bf16 v[160:163], a[116:119], v[200:203], v[160:163]
    v_mfma_f32_16x16x32_bf16 v[164:167], a[108:111], v[204:207], v[164:167]
    v_mfma_f32_16x16x32_bf16 v[168:171], a[112:115], v[204:207], v[168:171]
    buffer_load_dwordx4 v7, s[24:27], s38 offen offset:1024 sc1 lds
    v_mfma_f32_16x16x32_bf16 v[172:175], a[116:119], v[204:207], v[172:175]
    s_waitcnt lgkmcnt(0)
    v_mfma_f32_16x16x32_bf16 v[128:131], a[120:123], v[176:179], v[128:131]
    ds_read_b128 v[192:195], v7 offset:11264
    ds_read_b128 v[196:199], v7 offset:23552
    v_mfma_f32_16x16x32_bf16 v[132:135], a[124:127], v[176:179], v[132:135]
    v_mfma_f32_16x16x32_bf16 v[136:139], a[128:131], v[176:179], v[136:139]
    ds_read_b128 v[200:203], v7 offset:35840
    ds_read_b128 v[204:207], v7 offset:48128
    v_mfma_f32_16x16x32_bf16 v[140:143], a[120:123], v[180:183], v[140:143]
    buffer_load_dwordx4 v7, s[24:27], s38 offen offset:2048 sc1 lds
    v_mfma_f32_16x16x32_bf16 v[144:147], a[124:127], v[180:183], v[144:147]
    v_mfma_f32_16x16x32_bf16 v[148:151], a[128:131], v[180:183], v[148:151]
    v_mfma_f32_16x16x32_bf16 v[152:155], a[120:123], v[184:187], v[152:155]
    v_mfma_f32_16x16x32_bf16 v[156:159], a[124:127], v[184:187], v[156:159]
    v_mfma_f32_16x16x32_bf16 v[160:163], a[128:131], v[184:187], v[160:163]
    buffer_load_dwordx4 v7, s[24:27], s38 offen offset:3072 sc1 lds
    v_mfma_f32_16x16x32_bf16 v[164:167], a[120:123], v[188:191], v[164:167]
    v_mfma_f32_16x16x32_bf16 v[168:171], a[124:127], v[188:191], v[168:171]
    v_mfma_f32_16x16x32_bf16 v[172:175], a[128:131], v[188:191], v[172:175]
    s_waitcnt lgkmcnt(0)
    s_waitcnt vmcnt(28)
    s_barrier
    v_mfma_f32_16x16x32_bf16 v[128:131], a[132:135], v[192:195], v[128:131]
    ds_read_b128 v[176:179], v7 offset:0
    ds_read_b128 v[180:183], v7 offset:12288
    v_mfma_f32_16x16x32_bf16 v[132:135], a[136:139], v[192:195], v[132:135]
    s_add_u32 m0, s49, 8192
    s_add_u32 s38, s48, 16859136
    buffer_load_dwordx4 v7, s[24:27], s38 offen offset:0 sc1 lds
    v_mfma_f32_16x16x32_bf16 v[136:139], a[140:143], v[192:195], v[136:139]
    ds_read_b128 v[184:187], v7 offset:24576
    ds_read_b128 v[188:191], v7 offset:36864
    v_mfma_f32_16x16x32_bf16 v[140:143], a[132:135], v[196:199], v[140:143]
    s_waitcnt vmcnt(8)
    s_add_u32 s3, s66, 14680064
    s_mov_b64 exec, 1
    buffer_store_dwordx2 v[2:3], off, s[24:27], s3 sc1
    s_mov_b64 exec, -1
    v_mfma_f32_16x16x32_bf16 v[144:147], a[136:139], v[196:199], v[144:147]
    v_mfma_f32_16x16x32_bf16 v[148:151], a[140:143], v[196:199], v[148:151]
    v_mfma_f32_16x16x32_bf16 v[152:155], a[132:135], v[200:203], v[152:155]
    buffer_load_dwordx4 v7, s[24:27], s38 offen offset:1024 sc1 lds
    v_mfma_f32_16x16x32_bf16 v[156:159], a[136:139], v[200:203], v[156:159]
    v_mfma_f32_16x16x32_bf16 v[160:163], a[140:143], v[200:203], v[160:163]
    v_mfma_f32_16x16x32_bf16 v[164:167], a[132:135], v[204:207], v[164:167]
    v_mfma_f32_16x16x32_bf16 v[168:171], a[136:139], v[204:207], v[168:171]
    v_mfma_f32_16x16x32_bf16 v[172:175], a[140:143], v[204:207], v[172:175]
    buffer_load_dwordx4 v7, s[24:27], s38 offen offset:2048 sc1 lds
    s_waitcnt lgkmcnt(0)
    v_mfma_f32_16x16x32_bf16 v[128:131], a[144:147], v[176:179], v[128:131]
    ds_read_b128 v[192:195], v7 offset:1024
    ds_read_b128 v[196:199], v7 offset:13312
    v_mfma_f32_16x16x32_bf16 v[132:135], a[148:151], v[176:179], v[132:135]
    v_mfma_f32_16x16x32_bf16 v[136:139], a[152:155], v[176:179], v[136:139]
    ds_read_b128 v[200:203], v7 offset:25600
    ds_read_b128 v[204:207], v7 offset:37888
    v_mfma_f32_16x16x32_bf16 v[140:143], a[144:147], v[180:183], v[140:143]
    v_mfma_f32_16x16x32_bf16 v[144:147], a[148:151], v[180:183], v[144:147]
    buffer_load_dwordx4 v7, s[24:27], s38 offen offset:3072 sc1 lds
    v_mfma_f32_16x16x32_bf16 v[148:151], a[152:155], v[180:183], v[148:151]
    v_mfma_f32_16x16x32_bf16 v[152:155], a[144:147], v[184:187], v[152:155]
    v_mfma_f32_16x16x32_bf16 v[156:159], a[148:151], v[184:187], v[156:159]
    v_mfma_f32_16x16x32_bf16 v[160:163], a[152:155], v[184:187], v[160:163]
    v_mfma_f32_16x16x32_bf16 v[164:167], a[144:147], v[188:191], v[164:167]
    s_add_u32 m0, s51, 20480
    s_add_u32 s38, s47, 20480
    buffer_load_dwordx4 v7, s[24:27], s38 offen offset:0 sc1 lds
    v_mfma_f32_16x16x32_bf16 v[168:171], a[148:151], v[188:191], v[168:171]
    v_mfma_f32_16x16x32_bf16 v[172:175], a[152:155], v[188:191], v[172:175]
    s_waitcnt lgkmcnt(0)
    v_mfma_f32_16x16x32_bf16 v[128:131], a[156:159], v[192:195], v[128:131]
    ds_read_b128 v[176:179], v7 offset:2048
    ds_read_b128 v[180:183], v7 offset:14336
    v_mfma_f32_16x16x32_bf16 v[132:135], a[160:163], v[192:195], v[132:135]
    v_mfma_f32_16x16x32_bf16 v[136:139], a[164:167], v[192:195], v[136:139]
    ds_read_b128 v[184:187], v7 offset:26624
    ds_read_b128 v[188:191], v7 offset:38912
    buffer_load_dwordx4 v7, s[24:27], s38 offen offset:1024 sc1 lds
    v_mfma_f32_16x16x32_bf16 v[140:143], a[156:159], v[196:199], v[140:143]
    v_mfma_f32_16x16x32_bf16 v[144:147], a[160:163], v[196:199], v[144:147]
    v_mfma_f32_16x16x32_bf16 v[148:151], a[164:167], v[196:199], v[148:151]
    v_mfma_f32_16x16x32_bf16 v[152:155], a[156:159], v[200:203], v[152:155]
    v_mfma_f32_16x16x32_bf16 v[156:159], a[160:163], v[200:203], v[156:159]
    buffer_load_dwordx4 v7, s[24:27], s38 offen offset:2048 sc1 lds
    v_mfma_f32_16x16x32_bf16 v[160:163], a[164:167], v[200:203], v[160:163]
    v_mfma_f32_16x16x32_bf16 v[164:167], a[156:159], v[204:207], v[164:167]
    v_mfma_f32_16x16x32_bf16 v[168:171], a[160:163], v[204:207], v[168:171]
    v_mfma_f32_16x16x32_bf16 v[172:175], a[164:167], v[204:207], v[172:175]
    s_waitcnt lgkmcnt(0)
    v_mfma_f32_16x16x32_bf16 v[128:131], a[168:171], v[176:179], v[128:131]
    ds_read_b128 v[192:195], v7 offset:3072
    ds_read_b128 v[196:199], v7 offset:15360
    buffer_load_dwordx4 v7, s[24:27], s38 offen offset:3072 sc1 lds
    v_mfma_f32_16x16x32_bf16 v[132:135], a[172:175], v[176:179], v[132:135]
    v_mfma_f32_16x16x32_bf16 v[136:139], a[176:179], v[176:179], v[136:139]
    ds_read_b128 v[200:203], v7 offset:27648
    ds_read_b128 v[204:207], v7 offset:39936
    v_mfma_f32_16x16x32_bf16 v[140:143], a[168:171], v[180:183], v[140:143]
    v_mfma_f32_16x16x32_bf16 v[144:147], a[172:175], v[180:183], v[144:147]
    v_mfma_f32_16x16x32_bf16 v[148:151], a[176:179], v[180:183], v[148:151]
    s_add_u32 m0, s51, 24576
    s_add_u32 s38, s47, 24576
    buffer_load_dwordx4 v7, s[24:27], s38 offen offset:0 sc1 lds
    v_mfma_f32_16x16x32_bf16 v[152:155], a[168:171], v[184:187], v[152:155]
    v_mfma_f32_16x16x32_bf16 v[156:159], a[172:175], v[184:187], v[156:159]
    v_mfma_f32_16x16x32_bf16 v[160:163], a[176:179], v[184:187], v[160:163]
    v_mfma_f32_16x16x32_bf16 v[164:167], a[168:171], v[188:191], v[164:167]
    v_mfma_f32_16x16x32_bf16 v[168:171], a[172:175], v[188:191], v[168:171]
    buffer_load_dwordx4 v7, s[24:27], s38 offen offset:1024 sc1 lds
    v_mfma_f32_16x16x32_bf16 v[172:175], a[176:179], v[188:191], v[172:175]
    s_waitcnt lgkmcnt(0)
    s_barrier
    v_mfma_f32_16x16x32_bf16 v[128:131], a[180:183], v[192:195], v[128:131]
    ds_read_b128 v[176:179], v7 offset:4096
    ds_read_b128 v[180:183], v7 offset:16384
    v_mfma_f32_16x16x32_bf16 v[132:135], a[184:187], v[192:195], v[132:135]
    s_add_u32 s33, s67, 14680064
    s_mov_b64 exec, 0xffff
    buffer_load_dwordx2 v[10:11], v9, s[24:27], s33 offen sc1
    s_mov_b64 exec, -1
    v_mfma_f32_16x16x32_bf16 v[136:139], a[188:191], v[192:195], v[136:139]
    ds_read_b128 v[184:187], v7 offset:28672
    ds_read_b128 v[188:191], v7 offset:40960
    v_mfma_f32_16x16x32_bf16 v[140:143], a[180:183], v[196:199], v[140:143]
    s_add_u32 m0, s49, 0
    s_add_u32 s38, s48, 16863232
    buffer_load_dwordx4 v7, s[24:27], s38 offen offset:0 sc1 lds
    v_mfma_f32_16x16x32_bf16 v[144:147], a[184:187], v[196:199], v[144:147]
    v_mfma_f32_16x16x32_bf16 v[148:151], a[188:191], v[196:199], v[148:151]
    v_mfma_f32_16x16x32_bf16 v[152:155], a[180:183], v[200:203], v[152:155]
    v_mfma_f32_16x16x32_bf16 v[156:159], a[184:187], v[200:203], v[156:159]
    v_mfma_f32_16x16x32_bf16 v[160:163], a[188:191], v[200:203], v[160:163]
    buffer_load_dwordx4 v7, s[24:27], s38 offen offset:1024 sc1 lds
    v_mfma_f32_16x16x32_bf16 v[164:167], a[180:183], v[204:207], v[164:167]
    v_mfma_f32_16x16x32_bf16 v[168:171], a[184:187], v[204:207], v[168:171]
    v_mfma_f32_16x16x32_bf16 v[172:175], a[188:191], v[204:207], v[172:175]
    s_waitcnt lgkmcnt(0)
    v_mfma_f32_16x16x32_bf16 v[128:131], a[192:195], v[176:179], v[128:131]
    ds_read_b128 v[192:195], v7 offset:5120
    ds_read_b128 v[196:199], v7 offset:17408
    v_mfma_f32_16x16x32_bf16 v[132:135], a[196:199], v[176:179], v[132:135]
    buffer_load_dwordx4 v7, s[24:27], s38 offen offset:2048 sc1 lds
    v_mfma_f32_16x16x32_bf16 v[136:139], a[200:203], v[176:179], v[136:139]
    ds_read_b128 v[200:203], v7 offset:29696
    ds_read_b128 v[204:207], v7 offset:41984
    v_mfma_f32_16x16x32_bf16 v[140:143], a[192:195], v[180:183], v[140:143]
    v_mfma_f32_16x16x32_bf16 v[144:147], a[196:199], v[180:183], v[144:147]
    v_mfma_f32_16x16x32_bf16 v[148:151], a[200:203], v[180:183], v[148:151]
    v_mfma_f32_16x16x32_bf16 v[152:155], a[192:195], v[184:187], v[152:155]
    buffer_load_dwordx4 v7, s[24:27], s38 offen offset:3072 sc1 lds
    v_mfma_f32_16x16x32_bf16 v[156:159], a[196:199], v[184:187], v[156:159]
    v_mfma_f32_16x16x32_bf16 v[160:163], a[200:203], v[184:187], v[160:163]
    v_mfma_f32_16x16x32_bf16 v[164:167], a[192:195], v[188:191], v[164:167]
    v_mfma_f32_16x16x32_bf16 v[168:171], a[196:199], v[188:191], v[168:171]
    v_mfma_f32_16x16x32_bf16 v[172:175], a[200:203], v[188:191], v[172:175]
    s_add_u32 m0, s51, 24576
    s_add_u32 s38, s47, 24576
    buffer_load_dwordx4 v7, s[24:27], s38 offen offset:2048 sc1 lds
    s_waitcnt lgkmcnt(0)
    v_mfma_f32_16x16x32_bf16 v[128:131], a[204:207], v[192:195], v[128:131]
    ds_read_b128 v[176:179], v7 offset:6144
    ds_read_b128 v[180:183], v7 offset:18432
    v_mfma_f32_16x16x32_bf16 v[132:135], a[208:211], v[192:195], v[132:135]
    v_mfma_f32_16x16x32_bf16 v[136:139], a[212:215], v[192:195], v[136:139]
    ds_read_b128 v[184:187], v7 offset:30720
    ds_read_b128 v[188:191], v7 offset:43008
    v_mfma_f32_16x16x32_bf16 v[140:143], a[204:207], v[196:199], v[140:143]
    v_mfma_f32_16x16x32_bf16 v[144:147], a[208:211], v[196:199], v[144:147]
    s_add_u32 s62, s47, 24576
    buffer_load_dwordx4 a[108:111], v7, s[24:27], s62 offen offset:3072 sc1
    v_mfma_f32_16x16x32_bf16 v[148:151], a[212:215], v[196:199], v[148:151]
    v_mfma_f32_16x16x32_bf16 v[152:155], a[204:207], v[200:203], v[152:155]
    v_mfma_f32_16x16x32_bf16 v[156:159], a[208:211], v[200:203], v[156:159]
    v_mfma_f32_16x16x32_bf16 v[160:163], a[212:215], v[200:203], v[160:163]
    v_mfma_f32_16x16x32_bf16 v[164:167], a[204:207], v[204:207], v[164:167]
    s_add_u32 s62, s47, 28672
    buffer_load_dwordx4 a[112:115], v7, s[24:27], s62 offen offset:0 sc1
    v_mfma_f32_16x16x32_bf16 v[168:171], a[208:211], v[204:207], v[168:171]
    v_mfma_f32_16x16x32_bf16 v[172:175], a[212:215], v[204:207], v[172:175]
    s_waitcnt lgkmcnt(0)
    v_mfma_f32_16x16x32_bf16 v[128:131], a[216:219], v[176:179], v[128:131]
    ds_read_b128 v[192:195], v7 offset:7168
    ds_read_b128 v[196:199], v7 offset:19456
    v_mfma_f32_16x16x32_bf16 v[132:135], a[220:223], v[176:179], v[132:135]
    s_waitcnt vmcnt(7)
    s_mov_b64 exec, 0xffff
    s_branch Lpo_interleave_layers__ssm_conv_h3__swiglu_ffn__prompt_kernel_39
Lpr_interleave_layers__ssm_conv_h3__swiglu_ffn__prompt_kernel_38:
    s_sleep 2
    buffer_load_dwordx2 v[10:11], v9, s[24:27], s33 offen sc1
    s_waitcnt vmcnt(0)
    s_sub_u32 s58, s58, 1
    s_cbranch_scc1 Lk2_end
Lpo_interleave_layers__ssm_conv_h3__swiglu_ffn__prompt_kernel_39:
    v_cmp_ne_u64 vcc, v[2:3], v[10:11]
    s_cbranch_vccnz Lpr_interleave_layers__ssm_conv_h3__swiglu_ffn__prompt_kernel_38
    s_mov_b64 exec, -1
    v_mfma_f32_16x16x32_bf16 v[136:139], a[224:227], v[176:179], v[136:139]
    ds_read_b128 v[200:203], v7 offset:31744
    ds_read_b128 v[204:207], v7 offset:44032
    s_add_u32 s32, s35, 23068672
    buffer_load_dwordx4 v[80:83], v7, s[24:27], s32 offen offset:0 sc1
    v_mfma_f32_16x16x32_bf16 v[140:143], a[216:219], v[180:183], v[140:143]
    v_mfma_f32_16x16x32_bf16 v[144:147], a[220:223], v[180:183], v[144:147]
    v_mfma_f32_16x16x32_bf16 v[148:151], a[224:227], v[180:183], v[148:151]
    v_mfma_f32_16x16x32_bf16 v[152:155], a[216:219], v[184:187], v[152:155]
    v_mfma_f32_16x16x32_bf16 v[156:159], a[220:223], v[184:187], v[156:159]
    buffer_load_dwordx4 v[84:87], v7, s[24:27], s32 offen offset:1024 sc1
    v_mfma_f32_16x16x32_bf16 v[160:163], a[224:227], v[184:187], v[160:163]
    v_mfma_f32_16x16x32_bf16 v[164:167], a[216:219], v[188:191], v[164:167]
    v_mfma_f32_16x16x32_bf16 v[168:171], a[220:223], v[188:191], v[168:171]
    v_mfma_f32_16x16x32_bf16 v[172:175], a[224:227], v[188:191], v[172:175]
    s_waitcnt lgkmcnt(0)
    s_barrier
    v_mfma_f32_16x16x32_bf16 v[128:131], a[228:231], v[192:195], v[128:131]
    ds_read_b128 v[176:179], v7 offset:8192
    ds_read_b128 v[180:183], v7 offset:20480
    buffer_load_dwordx4 v[88:91], v7, s[24:27], s32 offen offset:2048 sc1
    v_mfma_f32_16x16x32_bf16 v[132:135], a[232:235], v[192:195], v[132:135]
    v_mfma_f32_16x16x32_bf16 v[136:139], a[236:239], v[192:195], v[136:139]
    ds_read_b128 v[184:187], v7 offset:32768
    ds_read_b128 v[188:191], v7 offset:45056
    v_mfma_f32_16x16x32_bf16 v[140:143], a[228:231], v[196:199], v[140:143]
    v_mfma_f32_16x16x32_bf16 v[144:147], a[232:235], v[196:199], v[144:147]
    v_mfma_f32_16x16x32_bf16 v[148:151], a[236:239], v[196:199], v[148:151]
    s_add_u32 s32, s35, 23117824
    buffer_load_dwordx4 v[92:95], v7, s[24:27], s32 offen offset:0 sc1
    v_mfma_f32_16x16x32_bf16 v[152:155], a[228:231], v[200:203], v[152:155]
    v_mfma_f32_16x16x32_bf16 v[156:159], a[232:235], v[200:203], v[156:159]
    v_mfma_f32_16x16x32_bf16 v[160:163], a[236:239], v[200:203], v[160:163]
    v_mfma_f32_16x16x32_bf16 v[164:167], a[228:231], v[204:207], v[164:167]
    v_mfma_f32_16x16x32_bf16 v[168:171], a[232:235], v[204:207], v[168:171]
    buffer_load_dwordx4 v[96:99], v7, s[24:27], s32 offen offset:1024 sc1
    v_mfma_f32_16x16x32_bf16 v[172:175], a[236:239], v[204:207], v[172:175]
    s_waitcnt lgkmcnt(0)
    v_mfma_f32_16x16x32_bf16 v[128:131], a[0:3], v[176:179], v[128:131]
    ds_read_b128 v[192:195], v7 offset:9216
    ds_read_b128 v[196:199], v7 offset:21504
    v_mfma_f32_16x16x32_bf16 v[132:135], a[4:7], v[176:179], v[132:135]
    v_mfma_f32_16x16x32_bf16 v[136:139], a[8:11], v[176:179], v[136:139]
    ds_read_b128 v[200:203], v7 offset:33792
    ds_read_b128 v[204:207], v7 offset:46080
    v_mfma_f32_16x16x32_bf16 v[140:143], a[0:3], v[180:183], v[140:143]
    buffer_load_dwordx4 v[100:103], v7, s[24:27], s32 offen offset:2048 sc1
    v_mfma_f32_16x16x32_bf16 v[144:147], a[4:7], v[180:183], v[144:147]
    v_mfma_f32_16x16x32_bf16 v[148:151], a[8:11], v[180:183], v[148:151]
    v_mfma_f32_16x16x32_bf16 v[152:155], a[0:3], v[184:187], v[152:155]
    v_mfma_f32_16x16x32_bf16 v[156:159], a[4:7], v[184:187], v[156:159]
    v_mfma_f32_16x16x32_bf16 v[160:163], a[8:11], v[184:187], v[160:163]
    s_add_u32 s32, s35, 23071744
    buffer_load_dwordx4 v[104:107], v7, s[24:27], s32 offen offset:0 sc1
    v_mfma_f32_16x16x32_bf16 v[164:167], a[0:3], v[188:191], v[164:167]
    v_mfma_f32_16x16x32_bf16 v[168:171], a[4:7], v[188:191], v[168:171]
    v_mfma_f32_16x16x32_bf16 v[172:175], a[8:11], v[188:191], v[172:175]
    s_waitcnt lgkmcnt(0)
    v_mfma_f32_16x16x32_bf16 v[128:131], a[12:15], v[192:195], v[128:131]
    ds_read_b128 v[176:179], v7 offset:10240
    ds_read_b128 v[180:183], v7 offset:22528
    v_mfma_f32_16x16x32_bf16 v[132:135], a[16:19], v[192:195], v[132:135]
    buffer_load_dwordx4 v[108:111], v7, s[24:27], s32 offen offset:1024 sc1
    v_mfma_f32_16x16x32_bf16 v[136:139], a[20:23], v[192:195], v[136:139]
    ds_read_b128 v[184:187], v7 offset:34816
    ds_read_b128 v[188:191], v7 offset:47104
    v_mfma_f32_16x16x32_bf16 v[140:143], a[12:15], v[196:199], v[140:143]
    v_mfma_f32_16x16x32_bf16 v[144:147], a[16:19], v[196:199], v[144:147]
    v_mfma_f32_16x16x32_bf16 v[148:151], a[20:23], v[196:199], v[148:151]
    v_mfma_f32_16x16x32_bf16 v[152:155], a[12:15], v[200:203], v[152:155]
    buffer_load_dwordx4 v[112:115], v7, s[24:27], s32 offen offset:2048 sc1
    v_mfma_f32_16x16x32_bf16 v[156:159], a[16:19], v[200:203], v[156:159]
    v_mfma_f32_16x16x32_bf16 v[160:163], a[20:23], v[200:203], v[160:163]
    v_mfma_f32_16x16x32_bf16 v[164:167], a[12:15], v[204:207], v[164:167]
    v_mfma_f32_16x16x32_bf16 v[168:171], a[16:19], v[204:207], v[168:171]
    v_mfma_f32_16x16x32_bf16 v[172:175], a[20:23], v[204:207], v[172:175]
    s_add_u32 s32, s35, 23120896
    buffer_load_dwordx4 v[116:119], v7, s[24:27], s32 offen offset:0 sc1
    s_waitcnt lgkmcnt(0)
    v_mfma_f32_16x16x32_bf16 v[128:131], a[24:27], v[176:179], v[128:131]
    ds_read_b128 v[192:195], v7 offset:11264
    ds_read_b128 v[196:199], v7 offset:23552
    v_mfma_f32_16x16x32_bf16 v[132:135], a[28:31], v[176:179], v[132:135]
    v_mfma_f32_16x16x32_bf16 v[136:139], a[32:35], v[176:179], v[136:139]
    ds_read_b128 v[200:203], v7 offset:35840
    ds_read_b128 v[204:207], v7 offset:48128
    v_mfma_f32_16x16x32_bf16 v[140:143], a[24:27], v[180:183], v[140:143]
    v_mfma_f32_16x16x32_bf16 v[144:147], a[28:31], v[180:183], v[144:147]
    buffer_load_dwordx4 v[120:123], v7, s[24:27], s32 offen offset:1024 sc1
    v_mfma_f32_16x16x32_bf16 v[148:151], a[32:35], v[180:183], v[148:151]
    v_mfma_f32_16x16x32_bf16 v[152:155], a[24:27], v[184:187], v[152:155]
    v_mfma_f32_16x16x32_bf16 v[156:159], a[28:31], v[184:187], v[156:159]
    v_mfma_f32_16x16x32_bf16 v[160:163], a[32:35], v[184:187], v[160:163]
    v_mfma_f32_16x16x32_bf16 v[164:167], a[24:27], v[188:191], v[164:167]
    buffer_load_dwordx4 v[124:127], v7, s[24:27], s32 offen offset:2048 sc1
    v_mfma_f32_16x16x32_bf16 v[168:171], a[28:31], v[188:191], v[168:171]
    v_mfma_f32_16x16x32_bf16 v[172:175], a[32:35], v[188:191], v[172:175]
    s_waitcnt lgkmcnt(0)
    s_waitcnt vmcnt(15)
    s_barrier
    v_mfma_f32_16x16x32_bf16 v[128:131], a[36:39], v[192:195], v[128:131]
    ds_read_b128 v[176:179], v7 offset:0
    ds_read_b128 v[180:183], v7 offset:12288
    v_mfma_f32_16x16x32_bf16 v[132:135], a[40:43], v[192:195], v[132:135]
    v_mfma_f32_16x16x32_bf16 v[136:139], a[44:47], v[192:195], v[136:139]
    ds_read_b128 v[184:187], v7 offset:24576
    ds_read_b128 v[188:191], v7 offset:36864
    s_add_u32 s32, s35, 23074816
    buffer_load_dwordx4 v[208:211], v7, s[24:27], s32 offen offset:0 sc1
    v_mfma_f32_16x16x32_bf16 v[140:143], a[36:39], v[196:199], v[140:143]
    v_mfma_f32_16x16x32_bf16 v[144:147], a[40:43], v[196:199], v[144:147]
    v_mfma_f32_16x16x32_bf16 v[148:151], a[44:47], v[196:199], v[148:151]
    v_mfma_f32_16x16x32_bf16 v[152:155], a[36:39], v[200:203], v[152:155]
    v_mfma_f32_16x16x32_bf16 v[156:159], a[40:43], v[200:203], v[156:159]
    buffer_load_dwordx4 v[212:215], v7, s[24:27], s32 offen offset:1024 sc1
    v_mfma_f32_16x16x32_bf16 v[160:163], a[44:47], v[200:203], v[160:163]
    v_mfma_f32_16x16x32_bf16 v[164:167], a[36:39], v[204:207], v[164:167]
    v_mfma_f32_16x16x32_bf16 v[168:171], a[40:43], v[204:207], v[168:171]
    v_mfma_f32_16x16x32_bf16 v[172:175], a[44:47], v[204:207], v[172:175]
    s_waitcnt lgkmcnt(0)
    v_mfma_f32_16x16x32_bf16 v[128:131], a[48:51], v[176:179], v[128:131]
    ds_read_b128 v[192:195], v7 offset:1024
    ds_read_b128 v[196:199], v7 offset:13312
    buffer_load_dwordx4 v[216:219], v7, s[24:27], s32 offen offset:2048 sc1
    v_mfma_f32_16x16x32_bf16 v[132:135], a[52:55], v[176:179], v[132:135]
    v_mfma_f32_16x16x32_bf16 v[136:139], a[56:59], v[176:179], v[136:139]
    ds_read_b128 v[200:203], v7 offset:25600
    ds_read_b128 v[204:207], v7 offset:37888
    v_mfma_f32_16x16x32_bf16 v[140:143], a[48:51], v[180:183], v[140:143]
    v_mfma_f32_16x16x32_bf16 v[144:147], a[52:55], v[180:183], v[144:147]
    v_mfma_f32_16x16x32_bf16 v[148:151], a[56:59], v[180:183], v[148:151]
    s_add_u32 s32, s35, 23123968
    buffer_load_dwordx4 v[220:223], v7, s[24:27], s32 offen offset:0 sc1
    v_mfma_f32_16x16x32_bf16 v[152:155], a[48:51], v[184:187], v[152:155]
    v_mfma_f32_16x16x32_bf16 v[156:159], a[52:55], v[184:187], v[156:159]
    v_mfma_f32_16x16x32_bf16 v[160:163], a[56:59], v[184:187], v[160:163]
    v_mfma_f32_16x16x32_bf16 v[164:167], a[48:51], v[188:191], v[164:167]
    v_mfma_f32_16x16x32_bf16 v[168:171], a[52:55], v[188:191], v[168:171]
    buffer_load_dwordx4 v[224:227], v7, s[24:27], s32 offen offset:1024 sc1
    v_mfma_f32_16x16x32_bf16 v[172:175], a[56:59], v[188:191], v[172:175]
    s_waitcnt lgkmcnt(0)
    v_mfma_f32_16x16x32_bf16 v[128:131], a[60:63], v[192:195], v[128:131]
    ds_read_b128 v[176:179], v7 offset:2048
    ds_read_b128 v[180:183], v7 offset:14336
    v_mfma_f32_16x16x32_bf16 v[132:135], a[64:67], v[192:195], v[132:135]
    v_mfma_f32_16x16x32_bf16 v[136:139], a[68:71], v[192:195], v[136:139]
    ds_read_b128 v[184:187], v7 offset:26624
    ds_read_b128 v[188:191], v7 offset:38912
    v_mfma_f32_16x16x32_bf16 v[140:143], a[60:63], v[196:199], v[140:143]
    buffer_load_dwordx4 v[228:231], v7, s[24:27], s32 offen offset:2048 sc1
    v_mfma_f32_16x16x32_bf16 v[144:147], a[64:67], v[196:199], v[144:147]
    v_mfma_f32_16x16x32_bf16 v[148:151], a[68:71], v[196:199], v[148:151]
    v_mfma_f32_16x16x32_bf16 v[152:155], a[60:63], v[200:203], v[152:155]
    v_mfma_f32_16x16x32_bf16 v[156:159], a[64:67], v[200:203], v[156:159]
    v_mfma_f32_16x16x32_bf16 v[160:163], a[68:71], v[200:203], v[160:163]
    buffer_load_dwordx4 a[116:119], v7, s[24:27], s62 offen offset:1024 sc1
    v_mfma_f32_16x16x32_bf16 v[164:167], a[60:63], v[204:207], v[164:167]
    v_mfma_f32_16x16x32_bf16 v[168:171], a[64:67], v[204:207], v[168:171]
    v_mfma_f32_16x16x32_bf16 v[172:175], a[68:71], v[204:207], v[172:175]
    s_waitcnt lgkmcnt(0)
    v_mfma_f32_16x16x32_bf16 v[128:131], a[72:75], v[176:179], v[128:131]
    ds_read_b128 v[192:195], v7 offset:3072
    ds_read_b128 v[196:199], v7 offset:15360
    v_mfma_f32_16x16x32_bf16 v[132:135], a[76:79], v[176:179], v[132:135]
    buffer_load_dwordx4 a[120:123], v7, s[24:27], s62 offen offset:2048 sc1
    v_mfma_f32_16x16x32_bf16 v[136:139], a[80:83], v[176:179], v[136:139]
    ds_read_b128 v[200:203], v7 offset:27648
    ds_read_b128 v[204:207], v7 offset:39936
    v_mfma_f32_16x16x32_bf16 v[140:143], a[72:75], v[180:183], v[140:143]
    v_mfma_f32_16x16x32_bf16 v[144:147], a[76:79], v[180:183], v[144:147]
    v_mfma_f32_16x16x32_bf16 v[148:151], a[80:83], v[180:183], v[148:151]
    v_mfma_f32_16x16x32_bf16 v[152:155], a[72:75], v[184:187], v[152:155]
    buffer_load_dwordx4 a[124:127], v7, s[24:27], s62 offen offset:3072 sc1
    v_mfma_f32_16x16x32_bf16 v[156:159], a[76:79], v[184:187], v[156:159]
    v_mfma_f32_16x16x32_bf16 v[160:163], a[80:83], v[184:187], v[160:163]
    v_mfma_f32_16x16x32_bf16 v[164:167], a[72:75], v[188:191], v[164:167]
    v_mfma_f32_16x16x32_bf16 v[168:171], a[76:79], v[188:191], v[168:171]
    v_mfma_f32_16x16x32_bf16 v[172:175], a[80:83], v[188:191], v[172:175]
    s_add_u32 s62, s47, 32768
    buffer_load_dwordx4 a[128:131], v7, s[24:27], s62 offen offset:0 sc1
    s_waitcnt lgkmcnt(0)
    v_mfma_f32_16x16x32_bf16 v[128:131], a[84:87], v[192:195], v[128:131]
    v_mfma_f32_16x16x32_bf16 v[132:135], a[88:91], v[192:195], v[132:135]
    v_mfma_f32_16x16x32_bf16 v[136:139], a[92:95], v[192:195], v[136:139]
    v_mfma_f32_16x16x32_bf16 v[140:143], a[84:87], v[196:199], v[140:143]
    v_mfma_f32_16x16x32_bf16 v[144:147], a[88:91], v[196:199], v[144:147]
    buffer_load_dwordx4 a[132:135], v7, s[24:27], s62 offen offset:1024 sc1
    v_mfma_f32_16x16x32_bf16 v[148:151], a[92:95], v[196:199], v[148:151]
    v_mfma_f32_16x16x32_bf16 v[152:155], a[84:87], v[200:203], v[152:155]
    v_mfma_f32_16x16x32_bf16 v[156:159], a[88:91], v[200:203], v[156:159]
    v_mfma_f32_16x16x32_bf16 v[160:163], a[92:95], v[200:203], v[160:163]
    v_mfma_f32_16x16x32_bf16 v[164:167], a[84:87], v[204:207], v[164:167]
    buffer_load_dwordx4 a[136:139], v7, s[24:27], s62 offen offset:2048 sc1
    v_mfma_f32_16x16x32_bf16 v[168:171], a[88:91], v[204:207], v[168:171]
    v_mfma_f32_16x16x32_bf16 v[172:175], a[92:95], v[204:207], v[172:175]
    v_mov_b32 v44, 0xbfb8aa3b
    v_pk_mul_f32 v[56:57], v[128:129], v[44:45] op_sel_hi:[1,0]
    v_pk_mul_f32 v[58:59], v[132:133], v[44:45] op_sel_hi:[1,0]
    v_pk_mul_f32 v[60:61], v[136:137], v[44:45] op_sel_hi:[1,0]
    buffer_load_dwordx4 a[140:143], v7, s[24:27], s62 offen offset:3072 sc1
    v_pk_mul_f32 v[62:63], v[140:141], v[44:45] op_sel_hi:[1,0]
    v_pk_mul_f32 v[64:65], v[144:145], v[44:45] op_sel_hi:[1,0]
    v_pk_mul_f32 v[66:67], v[148:149], v[44:45] op_sel_hi:[1,0]
    v_exp_f32 v56, v56
    v_exp_f32 v57, v57
    v_exp_f32 v58, v58
    v_exp_f32 v59, v59
    v_exp_f32 v60, v60
    s_add_u32 s62, s47, 36864
    buffer_load_dwordx4 a[144:147], v7, s[24:27], s62 offen offset:0 sc1
    v_exp_f32 v61, v61
    v_exp_f32 v62, v62
    v_exp_f32 v63, v63
    v_exp_f32 v64, v64
    v_exp_f32 v65, v65
    v_exp_f32 v66, v66
    buffer_load_dwordx4 a[148:151], v7, s[24:27], s62 offen offset:1024 sc1
    v_exp_f32 v67, v67
    v_pk_mul_f32 v[128:129], v[128:129], v[130:131]
    v_pk_mul_f32 v[132:133], v[132:133], v[134:135]
    v_pk_mul_f32 v[136:137], v[136:137], v[138:139]
    v_pk_mul_f32 v[140:141], v[140:141], v[142:143]
    v_pk_mul_f32 v[144:145], v[144:145], v[146:147]
    v_pk_mul_f32 v[148:149], v[148:149], v[150:151]
    v_pk_add_f32 v[56:57], v[56:57], 1.0 op_sel_hi:[1,0]
    v_pk_add_f32 v[58:59], v[58:59], 1.0 op_sel_hi:[1,0]
    v_pk_add_f32 v[60:61], v[60:61], 1.0 op_sel_hi:[1,0]
    v_pk_add_f32 v[62:63], v[62:63], 1.0 op_sel_hi:[1,0]
    buffer_load_dwordx4 a[152:155], v7, s[24:27], s62 offen offset:2048 sc1
    v_pk_add_f32 v[64:65], v[64:65], 1.0 op_sel_hi:[1,0]
    v_pk_add_f32 v[66:67], v[66:67], 1.0 op_sel_hi:[1,0]
    v_rcp_f32 v56, v56
    v_rcp_f32 v57, v57
    v_rcp_f32 v58, v58
    v_rcp_f32 v59, v59
    v_rcp_f32 v60, v60
    buffer_load_dwordx4 a[156:159], v7, s[24:27], s62 offen offset:3072 sc1
    v_rcp_f32 v61, v61
    v_rcp_f32 v62, v62
    v_rcp_f32 v63, v63
    v_rcp_f32 v64, v64
    v_rcp_f32 v65, v65
    v_rcp_f32 v66, v66
    s_add_u32 s62, s47, 40960
    buffer_load_dwordx4 a[160:163], v7, s[24:27], s62 offen offset:0 sc1
    v_rcp_f32 v67, v67
    v_pk_mul_f32 v[128:129], v[128:129], v[56:57]
    v_pk_mul_f32 v[132:133], v[132:133], v[58:59]
    v_pk_mul_f32 v[136:137], v[136:137], v[60:61]
    v_pk_mul_f32 v[140:141], v[140:141], v[62:63]
    v_pk_mul_f32 v[144:145], v[144:145], v[64:65]
    v_pk_mul_f32 v[148:149], v[148:149], v[66:67]
    v_cvt_pk_bf16_f32 v76, v128, v129
    v_cvt_pk_bf16_f32 v77, v132, v133
    v_cvt_pk_bf16_f32 v78, v136, v137
    v_cvt_pk_bf16_f32 v71, v136, v137
    s_add_u32 s32, s35, 23077888
    buffer_load_dwordx4 v[232:235], v7, s[24:27], s32 offen offset:0 sc1
    v_cvt_pk_bf16_f32 v68, v128, v129
    v_permlane16_swap_b32 v76, v77
    v_cvt_pk_bf16_f32 v69, v132, v133
    v_permlane16_swap_b32 v78, v71
    v_cvt_pk_bf16_f32 v70, v136, v137
    s_add_u32 s6, s36, 23265280
    v_permlane32_swap_b32 v77, v71
    s_mov_b64 exec, s[64:65]
    buffer_store_dwordx4 v[68:71], v7, s[24:27], s6 offen sc1
    s_mov_b64 exec, -1
    v_cvt_pk_bf16_f32 v76, v140, v141
    v_cvt_pk_bf16_f32 v77, v144, v145
    v_cvt_pk_bf16_f32 v78, v148, v149
    v_cvt_pk_bf16_f32 v75, v148, v149
    v_cvt_pk_bf16_f32 v72, v140, v141
    buffer_load_dwordx4 v[236:239], v7, s[24:27], s32 offen offset:1024 sc1
    v_permlane16_swap_b32 v76, v77
    v_cvt_pk_bf16_f32 v73, v144, v145
    v_permlane16_swap_b32 v78, v75
    v_cvt_pk_bf16_f32 v74, v148, v149
    s_add_u32 s6, s36, 23314432
    v_permlane32_swap_b32 v77, v75
    s_mov_b64 exec, s[64:65]
    buffer_store_dwordx4 v[72:75], v7, s[24:27], s6 offen sc1
    s_mov_b64 exec, -1
    v_pk_mul_f32 v[56:57], v[152:153], v[44:45] op_sel_hi:[1,0]
    v_pk_mul_f32 v[58:59], v[156:157], v[44:45] op_sel_hi:[1,0]
    v_pk_mul_f32 v[60:61], v[160:161], v[44:45] op_sel_hi:[1,0]
    v_pk_mul_f32 v[62:63], v[164:165], v[44:45] op_sel_hi:[1,0]
    v_pk_mul_f32 v[64:65], v[168:169], v[44:45] op_sel_hi:[1,0]
    v_pk_mul_f32 v[66:67], v[172:173], v[44:45] op_sel_hi:[1,0]
    buffer_load_dwordx4 a[164:167], v7, s[24:27], s62 offen offset:1024 sc1
    v_exp_f32 v56, v56
    v_exp_f32 v57, v57
    v_exp_f32 v58, v58
    v_exp_f32 v59, v59
    v_exp_f32 v60, v60
    v_exp_f32 v61, v61
    buffer_load_dwordx4 v[240:243], v7, s[24:27], s32 offen offset:2048 sc1
    v_exp_f32 v62, v62
    v_exp_f32 v63, v63
    v_exp_f32 v64, v64
    v_exp_f32 v65, v65
    v_exp_f32 v66, v66
    v_exp_f32 v67, v67
    s_add_u32 s32, s35, 23127040
    buffer_load_dwordx4 v[244:247], v7, s[24:27], s32 offen offset:0 sc1
    v_pk_mul_f32 v[152:153], v[152:153], v[154:155]
    v_pk_mul_f32 v[156:157], v[156:157], v[158:159]
    v_pk_mul_f32 v[160:161], v[160:161], v[162:163]
    v_pk_mul_f32 v[164:165], v[164:165], v[166:167]
    v_pk_mul_f32 v[168:169], v[168:169], v[170:171]
    v_pk_mul_f32 v[172:173], v[172:173], v[174:175]
    v_pk_add_f32 v[56:57], v[56:57], 1.0 op_sel_hi:[1,0]
    v_pk_add_f32 v[58:59], v[58:59], 1.0 op_sel_hi:[1,0]
    v_pk_add_f32 v[60:61], v[60:61], 1.0 op_sel_hi:[1,0]
    v_pk_add_f32 v[62:63], v[62:63], 1.0 op_sel_hi:[1,0]
    v_pk_add_f32 v[64:65], v[64:65], 1.0 op_sel_hi:[1,0]
    v_pk_add_f32 v[66:67], v[66:67], 1.0 op_sel_hi:[1,0]
    buffer_load_dwordx4 v[248:251], v7, s[24:27], s32 offen offset:1024 sc1
    v_rcp_f32 v56, v56
    v_rcp_f32 v57, v57
    v_rcp_f32 v58, v58
    v_rcp_f32 v59, v59
    v_rcp_f32 v60, v60
    v_rcp_f32 v61, v61
    buffer_load_dwordx4 v[252:255], v7, s[24:27], s32 offen offset:2048 sc1
    v_rcp_f32 v62, v62
    v_rcp_f32 v63, v63
    v_rcp_f32 v64, v64
    v_rcp_f32 v65, v65
    v_rcp_f32 v66, v66
    v_rcp_f32 v67, v67
    buffer_load_dwordx4 a[168:171], v7, s[24:27], s62 offen offset:2048 sc1
    v_pk_mul_f32 v[152:153], v[152:153], v[56:57]
    v_pk_mul_f32 v[156:157], v[156:157], v[58:59]
    v_pk_mul_f32 v[160:161], v[160:161], v[60:61]
    v_pk_mul_f32 v[164:165], v[164:165], v[62:63]
    v_pk_mul_f32 v[168:169], v[168:169], v[64:65]
    v_pk_mul_f32 v[172:173], v[172:173], v[66:67]
    v_cvt_pk_bf16_f32 v76, v152, v153
    v_cvt_pk_bf16_f32 v77, v156, v157
    v_cvt_pk_bf16_f32 v78, v160, v161
    v_cvt_pk_bf16_f32 v71, v160, v161
    v_cvt_pk_bf16_f32 v68, v152, v153
    v_permlane16_swap_b32 v76, v77
    buffer_load_dwordx4 a[172:175], v7, s[24:27], s62 offen offset:3072 sc1
    v_cvt_pk_bf16_f32 v69, v156, v157
    v_permlane16_swap_b32 v78, v71
    v_cvt_pk_bf16_f32 v70, v160, v161
    s_add_u32 s6, s36, 23363584
    v_permlane32_swap_b32 v77, v71
    s_mov_b64 exec, s[64:65]
    buffer_store_dwordx4 v[68:71], v7, s[24:27], s6 offen sc1
    s_mov_b64 exec, -1
    v_cvt_pk_bf16_f32 v76, v164, v165
    v_cvt_pk_bf16_f32 v77, v168, v169
    v_cvt_pk_bf16_f32 v78, v172, v173
    v_cvt_pk_bf16_f32 v75, v172, v173
    v_cvt_pk_bf16_f32 v72, v164, v165
    v_permlane16_swap_b32 v76, v77
    v_cvt_pk_bf16_f32 v73, v168, v169
    s_add_u32 s62, s47, 45056
    buffer_load_dwordx4 a[176:179], v7, s[24:27], s62 offen offset:0 sc1
    v_permlane16_swap_b32 v78, v75
    v_cvt_pk_bf16_f32 v74, v172, v173
    s_add_u32 s6, s36, 23412736
    v_permlane32_swap_b32 v77, v75
    s_mov_b64 exec, s[64:65]
    buffer_store_dwordx4 v[72:75], v7, s[24:27], s6 offen sc1
    s_mov_b64 exec, -1
    s_barrier
    s_waitcnt vmcnt(46)
    ds_read_b128 v[176:179], v4 offset:0
    ds_read_b128 v[180:183], v4 offset:1024
    ds_read_b128 v[184:187], v4 offset:2048
    ds_read_b128 v[188:191], v4 offset:3072
    ds_read_b128 v[192:195], v4 offset:4096
    ds_read_b128 v[196:199], v4 offset:5120
    s_waitcnt vmcnt(40)
    s_waitcnt lgkmcnt(5)
    v_mfma_f32_16x16x32_bf16 v[128:131], v[176:179], v[80:83], 0
    ds_read_b128 v[200:203], v4 offset:6144
    v_mfma_f32_16x16x32_bf16 v[148:151], v[176:179], v[92:95], 0
    buffer_load_dwordx4 a[180:183], v7, s[24:27], s62 offen offset:1024 sc1
    s_waitcnt lgkmcnt(5)
    v_mfma_f32_16x16x32_bf16 v[132:135], v[180:183], v[80:83], 0
    ds_read_b128 v[204:207], v4 offset:7168
    v_mfma_f32_16x16x32_bf16 v[152:155], v[180:183], v[92:95], 0
    s_waitcnt lgkmcnt(5)
    v_mfma_f32_16x16x32_bf16 v[136:139], v[184:187], v[80:83], 0
    ds_read_b128 v[176:179], v4 offset:8192
    buffer_load_dwordx4 a[184:187], v7, s[24:27], s62 offen offset:2048 sc1
    v_mfma_f32_16x16x32_bf16 v[156:159], v[184:187], v[92:95], 0
    s_waitcnt lgkmcnt(5)
    v_mfma_f32_16x16x32_bf16 v[140:143], v[188:191], v[80:83], 0
    ds_read_b128 v[180:183], v4 offset:9216
    v_mfma_f32_16x16x32_bf16 v[160:163], v[188:191], v[92:95], 0
    buffer_load_dwordx4 a[188:191], v7, s[24:27], s62 offen offset:3072 sc1
    s_waitcnt lgkmcnt(5)
    v_mfma_f32_16x16x32_bf16 v[144:147], v[192:195], v[80:83], 0
    ds_read_b128 v[184:187], v4 offset:10240
    v_mfma_f32_16x16x32_bf16 v[164:167], v[192:195], v[92:95], 0
    s_waitcnt vmcnt(42)
    s_waitcnt lgkmcnt(5)
    v_mfma_f32_16x16x32_bf16 v[128:131], v[196:199], v[84:87], v[128:131]
    ds_read_b128 v[188:191], v4 offset:11264
    s_add_u32 s62, s47, 49152
    buffer_load_dwordx4 a[192:195], v7, s[24:27], s62 offen offset:0 sc1
    v_mfma_f32_16x16x32_bf16 v[148:151], v[196:199], v[96:99], v[148:151]
    s_waitcnt lgkmcnt(5)
    v_mfma_f32_16x16x32_bf16 v[132:135], v[200:203], v[84:87], v[132:135]
    ds_read_b128 v[192:195], v4 offset:12288
    v_mfma_f32_16x16x32_bf16 v[152:155], v[200:203], v[96:99], v[152:155]
    buffer_load_dwordx4 a[196:199], v7, s[24:27], s62 offen offset:1024 sc1
    s_waitcnt lgkmcnt(5)
    v_mfma_f32_16x16x32_bf16 v[136:139], v[204:207], v[84:87], v[136:139]
    ds_read_b128 v[196:199], v4 offset:13312
    v_mfma_f32_16x16x32_bf16 v[156:159], v[204:207], v[96:99], v[156:159]
    s_waitcnt lgkmcnt(5)
    v_mfma_f32_16x16x32_bf16 v[140:143], v[176:179], v[84:87], v[140:143]
    ds_read_b128 v[200:203], v4 offset:14336
    buffer_load_dwordx4 a[200:203], v7, s[24:27], s62 offen offset:2048 sc1
    v_mfma_f32_16x16x32_bf16 v[160:163], v[176:179], v[96:99], v[160:163]
    s_waitcnt lgkmcnt(5)
    v_mfma_f32_16x16x32_bf16 v[144:147], v[180:183], v[84:87], v[144:147]
    ds_read_b128 v[204:207], v4 offset:15360
    v_mfma_f32_16x16x32_bf16 v[164:167], v[180:183], v[96:99], v[164:167]
    buffer_load_dwordx4 a[204:207], v7, s[24:27], s62 offen offset:3072 sc1
    s_waitcnt vmcnt(45)
    s_waitcnt lgkmcnt(5)
    v_mfma_f32_16x16x32_bf16 v[128:131], v[184:187], v[88:91], v[128:131]
    ds_read_b128 v[176:179], v4 offset:16384
    v_mfma_f32_16x16x32_bf16 v[148:151], v[184:187], v[100:103], v[148:151]
    s_waitcnt lgkmcnt(5)
    v_mfma_f32_16x16x32_bf16 v[132:135], v[188:191], v[88:91], v[132:135]
    ds_read_b128 v[180:183], v4 offset:17408
    s_add_u32 s62, s47, 53248
    buffer_load_dwordx4 a[208:211], v7, s[24:27], s62 offen offset:0 sc1
    v_mfma_f32_16x16x32_bf16 v[152:155], v[188:191], v[100:103], v[152:155]
    s_waitcnt lgkmcnt(5)
    v_mfma_f32_16x16x32_bf16 v[136:139], v[192:195], v[88:91], v[136:139]
    ds_read_b128 v[184:187], v4 offset:18432
    v_mfma_f32_16x16x32_bf16 v[156:159], v[192:195], v[100:103], v[156:159]
    buffer_load_dwordx4 a[212:215], v7, s[24:27], s62 offen offset:1024 sc1
    s_waitcnt lgkmcnt(5)
    v_mfma_f32_16x16x32_bf16 v[140:143], v[196:199], v[88:91], v[140:143]
    ds_read_b128 v[188:191], v4 offset:19456
    v_mfma_f32_16x16x32_bf16 v[160:163], v[196:199], v[100:103], v[160:163]
    s_waitcnt lgkmcnt(5)
    v_mfma_f32_16x16x32_bf16 v[144:147], v[200:203], v[88:91], v[144:147]
    ds_read_b128 v[192:195], v4 offset:20480
    buffer_load_dwordx4 a[216:219], v7, s[24:27], s62 offen offset:2048 sc1
    v_mfma_f32_16x16x32_bf16 v[164:167], v[200:203], v[100:103], v[164:167]
    s_waitcnt vmcnt(44)
    s_waitcnt lgkmcnt(5)
    v_mfma_f32_16x16x32_bf16 v[128:131], v[204:207], v[104:107], v[128:131]
    ds_read_b128 v[196:199], v4 offset:21504
    v_mfma_f32_16x16x32_bf16 v[148:151], v[204:207], v[116:119], v[148:151]
    buffer_load_dwordx4 a[220:223], v7, s[24:27], s62 offen offset:3072 sc1
    s_waitcnt lgkmcnt(5)
    v_mfma_f32_16x16x32_bf16 v[132:135], v[176:179], v[104:107], v[132:135]
    ds_read_b128 v[200:203], v4 offset:22528
    v_mfma_f32_16x16x32_bf16 v[152:155], v[176:179], v[116:119], v[152:155]
    s_waitcnt vmcnt(11)
    s_add_u32 s3, s66, 14942208
    s_mov_b64 exec, 1
    buffer_store_dwordx2 v[2:3], off, s[24:27], s3 sc1
    s_mov_b64 exec, -1
    s_waitcnt lgkmcnt(5)
    v_mfma_f32_16x16x32_bf16 v[136:139], v[180:183], v[104:107], v[136:139]
    ds_read_b128 v[204:207], v4 offset:23552
    v_mfma_f32_16x16x32_bf16 v[156:159], v[180:183], v[116:119], v[156:159]
    s_add_u32 s62, s47, 57344
    buffer_load_dwordx4 a[224:227], v7, s[24:27], s62 offen offset:0 sc1
    s_waitcnt lgkmcnt(5)
    v_mfma_f32_16x16x32_bf16 v[140:143], v[184:187], v[104:107], v[140:143]
    ds_read_b128 v[176:179], v4 offset:24576
    v_mfma_f32_16x16x32_bf16 v[160:163], v[184:187], v[116:119], v[160:163]
    s_waitcnt lgkmcnt(5)
    v_mfma_f32_16x16x32_bf16 v[144:147], v[188:191], v[104:107], v[144:147]
    ds_read_b128 v[180:183], v4 offset:25600
    buffer_load_dwordx4 a[228:231], v7, s[24:27], s62 offen offset:1024 sc1
    v_mfma_f32_16x16x32_bf16 v[164:167], v[188:191], v[116:119], v[164:167]
    s_waitcnt lgkmcnt(5)
    v_mfma_f32_16x16x32_bf16 v[128:131], v[192:195], v[108:111], v[128:131]
    ds_read_b128 v[184:187], v4 offset:26624
    v_mfma_f32_16x16x32_bf16 v[148:151], v[192:195], v[120:123], v[148:151]
    buffer_load_dwordx4 a[232:235], v7, s[24:27], s62 offen offset:2048 sc1
    s_waitcnt lgkmcnt(5)
    v_mfma_f32_16x16x32_bf16 v[132:135], v[196:199], v[108:111], v[132:135]
    v_mfma_f32_16x16x32_bf16 v[152:155], v[196:199], v[120:123], v[152:155]
    s_waitcnt lgkmcnt(4)
    v_mfma_f32_16x16x32_bf16 v[136:139], v[200:203], v[108:111], v[136:139]
    buffer_load_dwordx4 a[236:239], v7, s[24:27], s62 offen offset:3072 sc1
    v_mfma_f32_16x16x32_bf16 v[156:159], v[200:203], v[120:123], v[156:159]
    s_waitcnt lgkmcnt(3)
    v_mfma_f32_16x16x32_bf16 v[140:143], v[204:207], v[108:111], v[140:143]
    v_mfma_f32_16x16x32_bf16 v[160:163], v[204:207], v[120:123], v[160:163]
    s_mov_b32 s63, 37748736
    buffer_load_dwordx4 v[32:35], v12, s[24:27], s63 offen sc1
    buffer_load_dwordx2 v[36:37], v13, s[24:27], s63 offen sc1
    s_waitcnt lgkmcnt(2)
    v_mfma_f32_16x16x32_bf16 v[144:147], v[176:179], v[108:111], v[144:147]
    v_mfma_f32_16x16x32_bf16 v[164:167], v[176:179], v[120:123], v[164:167]
    s_waitcnt lgkmcnt(1)
    v_mfma_f32_16x16x32_bf16 v[128:131], v[180:183], v[112:115], v[128:131]
    s_mov_b32 s63, 40894464
    buffer_load_dwordx4 a[240:243], v12, s[24:27], s63 offen sc1
    buffer_load_dwordx2 a[244:245], v13, s[24:27], s63 offen sc1
    v_mfma_f32_16x16x32_bf16 v[148:151], v[180:183], v[124:127], v[148:151]
    s_waitcnt lgkmcnt(0)
    v_mfma_f32_16x16x32_bf16 v[132:135], v[184:187], v[112:115], v[132:135]
    v_mfma_f32_16x16x32_bf16 v[152:155], v[184:187], v[124:127], v[152:155]
    s_mov_b32 s63, 37830656
    buffer_load_dwordx4 v[38:41], v12, s[24:27], s63 offen sc1
    buffer_load_dwordx2 v[42:43], v13, s[24:27], s63 offen sc1
    v_mfma_f32_16x16x32_bf16 v[136:139], a[108:111], v[112:115], v[136:139]
    v_mfma_f32_16x16x32_bf16 v[156:159], a[108:111], v[124:127], v[156:159]
    v_mfma_f32_16x16x32_bf16 v[140:143], a[112:115], v[112:115], v[140:143]
    s_mov_b32 s63, 40976384
    buffer_load_dwordx4 a[246:249], v12, s[24:27], s63 offen sc1
    buffer_load_dwordx2 a[250:251], v13, s[24:27], s63 offen sc1
    v_mfma_f32_16x16x32_bf16 v[160:163], a[112:115], v[124:127], v[160:163]
    v_mfma_f32_16x16x32_bf16 v[144:147], a[116:119], v[112:115], v[144:147]
    v_mfma_f32_16x16x32_bf16 v[164:167], a[116:119], v[124:127], v[164:167]
    v_mfma_f32_16x16x32_bf16 v[128:131], a[120:123], v[208:211], v[128:131]
    v_mfma_f32_16x16x32_bf16 v[148:151], a[120:123], v[220:223], v[148:151]
    v_mfma_f32_16x16x32_bf16 v[132:135], a[124:127], v[208:211], v[132:135]
    v_mfma_f32_16x16x32_bf16 v[152:155], a[124:127], v[220:223], v[152:155]
    v_mfma_f32_16x16x32_bf16 v[136:139], a[128:131], v[208:211], v[136:139]
    v_mfma_f32_16x16x32_bf16 v[156:159], a[128:131], v[220:223], v[156:159]
    v_mfma_f32_16x16x32_bf16 v[140:143], a[132:135], v[208:211], v[140:143]
    v_mfma_f32_16x16x32_bf16 v[160:163], a[132:135], v[220:223], v[160:163]
    v_mfma_f32_16x16x32_bf16 v[144:147], a[136:139], v[208:211], v[144:147]
    v_mfma_f32_16x16x32_bf16 v[164:167], a[136:139], v[220:223], v[164:167]
    v_mfma_f32_16x16x32_bf16 v[128:131], a[140:143], v[212:215], v[128:131]
    v_mfma_f32_16x16x32_bf16 v[148:151], a[140:143], v[224:227], v[148:151]
    v_mfma_f32_16x16x32_bf16 v[132:135], a[144:147], v[212:215], v[132:135]
    v_mfma_f32_16x16x32_bf16 v[152:155], a[144:147], v[224:227], v[152:155]
    v_mfma_f32_16x16x32_bf16 v[136:139], a[148:151], v[212:215], v[136:139]
    v_mfma_f32_16x16x32_bf16 v[156:159], a[148:151], v[224:227], v[156:159]
    v_mfma_f32_16x16x32_bf16 v[140:143], a[152:155], v[212:215], v[140:143]
    v_mfma_f32_16x16x32_bf16 v[160:163], a[152:155], v[224:227], v[160:163]
    v_mfma_f32_16x16x32_bf16 v[144:147], a[156:159], v[212:215], v[144:147]
    v_mfma_f32_16x16x32_bf16 v[164:167], a[156:159], v[224:227], v[164:167]
    v_mfma_f32_16x16x32_bf16 v[128:131], a[160:163], v[216:219], v[128:131]
    v_mfma_f32_16x16x32_bf16 v[148:151], a[160:163], v[228:231], v[148:151]
    v_mfma_f32_16x16x32_bf16 v[132:135], a[164:167], v[216:219], v[132:135]
    v_mfma_f32_16x16x32_bf16 v[152:155], a[164:167], v[228:231], v[152:155]
    v_mfma_f32_16x16x32_bf16 v[136:139], a[168:171], v[216:219], v[136:139]
    v_mfma_f32_16x16x32_bf16 v[156:159], a[168:171], v[228:231], v[156:159]
    v_mfma_f32_16x16x32_bf16 v[140:143], a[172:175], v[216:219], v[140:143]
    v_mfma_f32_16x16x32_bf16 v[160:163], a[172:175], v[228:231], v[160:163]
    s_add_u32 s33, s67, 14942208
    s_mov_b64 exec, 0xffff
    buffer_load_dwordx2 v[10:11], v9, s[24:27], s33 offen sc1
    s_mov_b64 exec, -1
    v_mfma_f32_16x16x32_bf16 v[144:147], a[176:179], v[216:219], v[144:147]
    v_mfma_f32_16x16x32_bf16 v[164:167], a[176:179], v[228:231], v[164:167]
    s_waitcnt vmcnt(24)
    v_mfma_f32_16x16x32_bf16 v[128:131], a[180:183], v[232:235], v[128:131]
    v_mfma_f32_16x16x32_bf16 v[148:151], a[180:183], v[244:247], v[148:151]
    s_waitcnt vmcnt(23)
    v_mfma_f32_16x16x32_bf16 v[132:135], a[184:187], v[232:235], v[132:135]
    v_mfma_f32_16x16x32_bf16 v[152:155], a[184:187], v[244:247], v[152:155]
    s_waitcnt vmcnt(22)
    v_mfma_f32_16x16x32_bf16 v[136:139], a[188:191], v[232:235], v[136:139]
    v_mfma_f32_16x16x32_bf16 v[156:159], a[188:191], v[244:247], v[156:159]
    s_waitcnt vmcnt(21)
    v_mfma_f32_16x16x32_bf16 v[140:143], a[192:195], v[232:235], v[140:143]
    v_mfma_f32_16x16x32_bf16 v[160:163], a[192:195], v[244:247], v[160:163]
    s_waitcnt vmcnt(20)
    v_mfma_f32_16x16x32_bf16 v[144:147], a[196:199], v[232:235], v[144:147]
    v_mfma_f32_16x16x32_bf16 v[164:167], a[196:199], v[244:247], v[164:167]
    s_waitcnt vmcnt(19)
    v_mfma_f32_16x16x32_bf16 v[128:131], a[200:203], v[236:239], v[128:131]
    v_mfma_f32_16x16x32_bf16 v[148:151], a[200:203], v[248:251], v[148:151]
    s_waitcnt vmcnt(18)
    v_mfma_f32_16x16x32_bf16 v[132:135], a[204:207], v[236:239], v[132:135]
    v_mfma_f32_16x16x32_bf16 v[152:155], a[204:207], v[248:251], v[152:155]
    s_waitcnt vmcnt(17)
    v_mfma_f32_16x16x32_bf16 v[136:139], a[208:211], v[236:239], v[136:139]
    v_mfma_f32_16x16x32_bf16 v[156:159], a[208:211], v[248:251], v[156:159]
    s_waitcnt vmcnt(16)
    v_mfma_f32_16x16x32_bf16 v[140:143], a[212:215], v[236:239], v[140:143]
    v_mfma_f32_16x16x32_bf16 v[160:163], a[212:215], v[248:251], v[160:163]
    s_waitcnt vmcnt(15)
    v_mfma_f32_16x16x32_bf16 v[144:147], a[216:219], v[236:239], v[144:147]
    v_mfma_f32_16x16x32_bf16 v[164:167], a[216:219], v[248:251], v[164:167]
    s_waitcnt vmcnt(14)
    v_mfma_f32_16x16x32_bf16 v[128:131], a[220:223], v[240:243], v[128:131]
    v_mfma_f32_16x16x32_bf16 v[148:151], a[220:223], v[252:255], v[148:151]
    s_waitcnt vmcnt(12)
    v_mfma_f32_16x16x32_bf16 v[132:135], a[224:227], v[240:243], v[132:135]
    v_mfma_f32_16x16x32_bf16 v[152:155], a[224:227], v[252:255], v[152:155]
    s_waitcnt vmcnt(11)
    v_mfma_f32_16x16x32_bf16 v[136:139], a[228:231], v[240:243], v[136:139]
    v_mfma_f32_16x16x32_bf16 v[156:159], a[228:231], v[252:255], v[156:159]
    s_waitcnt vmcnt(10)
    v_mfma_f32_16x16x32_bf16 v[140:143], a[232:235], v[240:243], v[140:143]
    v_mfma_f32_16x16x32_bf16 v[160:163], a[232:235], v[252:255], v[160:163]
    s_waitcnt vmcnt(9)
    v_mfma_f32_16x16x32_bf16 v[144:147], a[236:239], v[240:243], v[144:147]
    s_waitcnt vmcnt(0)
    s_mov_b64 exec, 0xffff
    s_branch Lpo_interleave_layers__ssm_conv_h3__swiglu_ffn__prompt_kernel_41
Lpr_interleave_layers__ssm_conv_h3__swiglu_ffn__prompt_kernel_40:
    s_sleep 2
    buffer_load_dwordx2 v[10:11], v9, s[24:27], s33 offen sc1
    s_waitcnt vmcnt(0)
    s_sub_u32 s58, s58, 1
    s_cbranch_scc1 Lk2_end
Lpo_interleave_layers__ssm_conv_h3__swiglu_ffn__prompt_kernel_41:
    v_cmp_ne_u64 vcc, v[2:3], v[10:11]
    s_cbranch_vccnz Lpr_interleave_layers__ssm_conv_h3__swiglu_ffn__prompt_kernel_40
    s_mov_b64 exec, -1
    s_add_u32 s32, s35, 23271424
    buffer_load_dwordx4 v[80:83], v7, s[24:27], s32 offen offset:0 sc1
    buffer_load_dwordx4 v[84:87], v7, s[24:27], s32 offen offset:1024 sc1
    buffer_load_dwordx4 v[88:91], v7, s[24:27], s32 offen offset:2048 sc1
    s_add_u32 s32, s35, 23320576
    buffer_load_dwordx4 v[92:95], v7, s[24:27], s32 offen offset:0 sc1
    buffer_load_dwordx4 v[96:99], v7, s[24:27], s32 offen offset:1024 sc1
    buffer_load_dwordx4 v[100:103], v7, s[24:27], s32 offen offset:2048 sc1
    v_mfma_f32_16x16x32_bf16 v[164:167], a[236:239], v[252:255], v[164:167]
    s_mul_i32 s3, s40, 10240
    v_add_u32 v72, s3, v7
    ds_write_b128 v72, v[128:131] offset:0
    ds_write_b128 v72, v[132:135] offset:1024
    ds_write_b128 v72, v[136:139] offset:2048
    ds_write_b128 v72, v[140:143] offset:3072
    ds_write_b128 v72, v[144:147] offset:4096
    ds_write_b128 v72, v[148:151] offset:5120
    s_add_u32 s32, s35, 23274496
    buffer_load_dwordx4 v[104:107], v7, s[24:27], s32 offen offset:0 sc1
    ds_write_b128 v72, v[152:155] offset:6144
    ds_write_b128 v72, v[156:159] offset:7168
    ds_write_b128 v72, v[160:163] offset:8192
    ds_write_b128 v72, v[164:167] offset:9216
    v_lshlrev_b32 v56, 16, v32
    v_and_b32 v57, 0xffff0000, v32
    v_lshlrev_b32 v58, 16, v33
    v_and_b32 v59, 0xffff0000, v33
    v_lshlrev_b32 v60, 16, v34
    v_and_b32 v61, 0xffff0000, v34
    v_lshlrev_b32 v62, 16, v35
    v_and_b32 v63, 0xffff0000, v35
    buffer_load_dwordx4 v[108:111], v7, s[24:27], s32 offen offset:1024 sc1
    v_lshlrev_b32 v64, 16, v36
    v_and_b32 v65, 0xffff0000, v36
    v_lshlrev_b32 v66, 16, v37
    v_and_b32 v67, 0xffff0000, v37
    s_waitcnt lgkmcnt(0)
    s_barrier
    ds_read_b128 v[128:131], v14 offset:0
    ds_read_b128 v[132:135], v14 offset:10240
    ds_read_b128 v[136:139], v14 offset:20480
    ds_read_b128 v[140:143], v14 offset:30720
    ds_read_b128 v[144:147], v14 offset:1024
    ds_read_b128 v[148:151], v14 offset:11264
    ds_read_b128 v[152:155], v14 offset:21504
    buffer_load_dwordx4 v[112:115], v7, s[24:27], s32 offen offset:2048 sc1
    ds_read_b128 v[156:159], v14 offset:31744
    ds_read_b128 v[160:163], v15 offset:0
    ds_read_b128 v[164:167], v15 offset:10240
    ds_read_b128 v[168:171], v15 offset:20480
    ds_read_b128 v[172:175], v15 offset:30720
    s_waitcnt lgkmcnt(8)
    v_pk_add_f32 v[128:129], v[128:129], v[132:133]
    v_pk_add_f32 v[130:131], v[130:131], v[134:135]
    v_pk_add_f32 v[136:137], v[136:137], v[140:141]
    v_pk_add_f32 v[138:139], v[138:139], v[142:143]
    s_waitcnt lgkmcnt(4)
    v_pk_add_f32 v[144:145], v[144:145], v[148:149]
    v_pk_add_f32 v[146:147], v[146:147], v[150:151]
    v_pk_add_f32 v[152:153], v[152:153], v[156:157]
    s_add_u32 s32, s35, 23323648
    buffer_load_dwordx4 v[116:119], v7, s[24:27], s32 offen offset:0 sc1
    v_pk_add_f32 v[154:155], v[154:155], v[158:159]
    s_waitcnt lgkmcnt(0)
    v_pk_add_f32 v[160:161], v[160:161], v[164:165]
    v_pk_add_f32 v[162:163], v[162:163], v[166:167]
    v_pk_add_f32 v[168:169], v[168:169], v[172:173]
    v_pk_add_f32 v[170:171], v[170:171], v[174:175]
    v_pk_add_f32 v[128:129], v[128:129], v[136:137]
    v_pk_add_f32 v[130:131], v[130:131], v[138:139]
    v_pk_add_f32 v[144:145], v[144:145], v[152:153]
    v_pk_add_f32 v[146:147], v[146:147], v[154:155]
    v_pk_add_f32 v[160:161], v[160:161], v[168:169]
    v_pk_add_f32 v[162:163], v[162:163], v[170:171]
    v_cvt_pk_bf16_f32 v132, v128, v129
    buffer_load_dwordx4 v[120:123], v7, s[24:27], s32 offen offset:1024 sc1
    v_cvt_pk_bf16_f32 v133, v130, v131
    v_cvt_pk_bf16_f32 v148, v144, v145
    v_cvt_pk_bf16_f32 v149, v146, v147
    v_cvt_pk_bf16_f32 v164, v160, v161
    v_cvt_pk_bf16_f32 v165, v162, v163
    v_lshlrev_b32 v128, 16, v132
    v_and_b32 v129, 0xffff0000, v132
    v_lshlrev_b32 v130, 16, v133
    v_and_b32 v131, 0xffff0000, v133
    v_lshlrev_b32 v144, 16, v148
    v_and_b32 v145, 0xffff0000, v148
    v_lshlrev_b32 v146, 16, v149
    buffer_load_dwordx4 v[124:127], v7, s[24:27], s32 offen offset:2048 sc1
    v_and_b32 v147, 0xffff0000, v149
    v_lshlrev_b32 v160, 16, v164
    v_and_b32 v161, 0xffff0000, v164
    v_lshlrev_b32 v162, 16, v165
    v_and_b32 v163, 0xffff0000, v165
    v_pk_add_f32 v[128:129], v[128:129], v[56:57]
    v_pk_add_f32 v[130:131], v[130:131], v[58:59]
    v_pk_add_f32 v[144:145], v[144:145], v[60:61]
    v_pk_add_f32 v[146:147], v[146:147], v[62:63]
    v_pk_add_f32 v[160:161], v[160:161], v[64:65]
    v_pk_add_f32 v[162:163], v[162:163], v[66:67]
    v_cvt_pk_bf16_f32 v32, v128, v129
    s_add_u32 s32, s35, 23265280
    buffer_load_dwordx4 v[208:211], v7, s[24:27], s32 offen offset:0 sc1
    v_cvt_pk_bf16_f32 v33, v130, v131
    v_cvt_pk_bf16_f32 v34, v144, v145
    v_cvt_pk_bf16_f32 v35, v146, v147
    v_cvt_pk_bf16_f32 v36, v160, v161
    v_cvt_pk_bf16_f32 v37, v162, v163
    v_dot2_f32_bf16 v72, v32, s55, 0
    v_dot2_f32_bf16 v73, v32, v32, 0
    v_dot2_f32_bf16 v74, v34, s55, 0
    v_dot2_f32_bf16 v75, v34, v34, 0
    buffer_load_dwordx4 v[212:215], v7, s[24:27], s32 offen offset:1024 sc1
    v_dot2_f32_bf16 v76, v36, s55, 0
    v_dot2_f32_bf16 v77, v36, v36, 0
    v_dot2_f32_bf16 v72, v33, s55, v72
    v_dot2_f32_bf16 v73, v33, v33, v73
    v_dot2_f32_bf16 v74, v35, s55, v74
    v_dot2_f32_bf16 v75, v35, v35, v75
    buffer_load_dwordx4 v[216:219], v7, s[24:27], s32 offen offset:2048 sc1
    v_dot2_f32_bf16 v76, v37, s55, v76
    v_dot2_f32_bf16 v77, v37, v37, v77
    v_add_f32 v72, v72, v74
    v_add_f32 v73, v73, v75
    v_fma_f32 v72, v76, s34, v72
    v_fma_f32 v73, v77, s34, v73
    v_mov_b32 v76, v72
    v_mov_b32 v77, v73
    s_nop 0
    v_permlane16_swap_b32 v72, v76
    v_permlane16_swap_b32 v73, v77
    s_add_u32 s32, s35, 23314432
    buffer_load_dwordx4 v[220:223], v7, s[24:27], s32 offen offset:0 sc1
    v_add_f32 v72, v72, v76
    v_add_f32 v73, v73, v77
    v_mov_b32 v76, v72
    v_mov_b32 v77, v73
    s_nop 0
    v_permlane32_swap_b32 v72, v76
    v_permlane32_swap_b32 v73, v77
    v_add_f32 v72, v72, v76
    v_add_f32 v73, v73, v77
    v_mov_b32 v74, v2
    v_mov_b32 v75, v3
    s_mov_b32 s7, 35651584
    s_mov_b64 exec, 0xffff
    buffer_store_dwordx4 v[72:75], v18, s[24:27], s7 offen sc1
    s_mov_b64 exec, -1
    ds_read_b128 v[176:179], v4 offset:0
    ds_read_b128 v[180:183], v4 offset:1024
    ds_read_b128 v[184:187], v4 offset:2048
    ds_read_b128 v[188:191], v4 offset:3072
    ds_read_b128 v[192:195], v4 offset:4096
    ds_read_b128 v[196:199], v4 offset:5120
    s_waitcnt vmcnt(13)
    v_mfma_f32_16x16x32_bf16 v[128:131], a[120:123], v[80:83], 0
    buffer_load_dwordx4 v[224:227], v7, s[24:27], s32 offen offset:1024 sc1
    v_mfma_f32_16x16x32_bf16 v[148:151], a[120:123], v[92:95], 0
    v_mfma_f32_16x16x32_bf16 v[132:135], a[124:127], v[80:83], 0
    v_mfma_f32_16x16x32_bf16 v[152:155], a[124:127], v[92:95], 0
    buffer_load_dwordx4 v[228:231], v7, s[24:27], s32 offen offset:2048 sc1
    v_mfma_f32_16x16x32_bf16 v[136:139], a[128:131], v[80:83], 0
    v_mfma_f32_16x16x32_bf16 v[156:159], a[128:131], v[92:95], 0
    v_mfma_f32_16x16x32_bf16 v[140:143], a[132:135], v[80:83], 0
    s_add_u32 s32, s35, 23268352
    buffer_load_dwordx4 v[232:235], v7, s[24:27], s32 offen offset:0 sc1
    v_mfma_f32_16x16x32_bf16 v[160:163], a[132:135], v[92:95], 0
    v_mfma_f32_16x16x32_bf16 v[144:147], a[136:139], v[80:83], 0
    v_mfma_f32_16x16x32_bf16 v[164:167], a[136:139], v[92:95], 0
    buffer_load_dwordx4 v[236:239], v7, s[24:27], s32 offen offset:1024 sc1
    s_waitcnt vmcnt(16)
    v_mfma_f32_16x16x32_bf16 v[128:131], a[140:143], v[84:87], v[128:131]
    v_mfma_f32_16x16x32_bf16 v[148:151], a[140:143], v[96:99], v[148:151]
    v_mfma_f32_16x16x32_bf16 v[132:135], a[144:147], v[84:87], v[132:135]
    buffer_load_dwordx4 v[240:243], v7, s[24:27], s32 offen offset:2048 sc1
    v_mfma_f32_16x16x32_bf16 v[152:155], a[144:147], v[96:99], v[152:155]
    v_mfma_f32_16x16x32_bf16 v[136:139], a[148:151], v[84:87], v[136:139]
    v_mfma_f32_16x16x32_bf16 v[156:159], a[148:151], v[96:99], v[156:159]
    s_add_u32 s32, s35, 23317504
    buffer_load_dwordx4 v[244:247], v7, s[24:27], s32 offen offset:0 sc1
    v_mfma_f32_16x16x32_bf16 v[140:143], a[152:155], v[84:87], v[140:143]
    v_mfma_f32_16x16x32_bf16 v[160:163], a[152:155], v[96:99], v[160:163]
    v_mfma_f32_16x16x32_bf16 v[144:147], a[156:159], v[84:87], v[144:147]
    buffer_load_dwordx4 v[248:251], v7, s[24:27], s32 offen offset:1024 sc1
    v_mfma_f32_16x16x32_bf16 v[164:167], a[156:159], v[96:99], v[164:167]
    s_waitcnt vmcnt(18)
    v_mfma_f32_16x16x32_bf16 v[128:131], a[160:163], v[88:91], v[128:131]
    v_mfma_f32_16x16x32_bf16 v[148:151], a[160:163], v[100:103], v[148:151]
    buffer_load_dwordx4 v[252:255], v7, s[24:27], s32 offen offset:2048 sc1
    v_mfma_f32_16x16x32_bf16 v[132:135], a[164:167], v[88:91], v[132:135]
    v_mfma_f32_16x16x32_bf16 v[152:155], a[164:167], v[100:103], v[152:155]
    v_mfma_f32_16x16x32_bf16 v[136:139], a[168:171], v[88:91], v[136:139]
    v_mfma_f32_16x16x32_bf16 v[156:159], a[168:171], v[100:103], v[156:159]
    v_mfma_f32_16x16x32_bf16 v[140:143], a[172:175], v[88:91], v[140:143]
    v_mfma_f32_16x16x32_bf16 v[160:163], a[172:175], v[100:103], v[160:163]
    v_mfma_f32_16x16x32_bf16 v[144:147], a[176:179], v[88:91], v[144:147]
    v_mfma_f32_16x16x32_bf16 v[164:167], a[176:179], v[100:103], v[164:167]
    s_waitcnt vmcnt(15)
    v_mfma_f32_16x16x32_bf16 v[128:131], a[180:183], v[104:107], v[128:131]
    v_mfma_f32_16x16x32_bf16 v[148:151], a[180:183], v[116:119], v[148:151]
    v_mfma_f32_16x16x32_bf16 v[132:135], a[184:187], v[104:107], v[132:135]
    v_mfma_f32_16x16x32_bf16 v[152:155], a[184:187], v[116:119], v[152:155]
    v_mfma_f32_16x16x32_bf16 v[136:139], a[188:191], v[104:107], v[136:139]
    v_mfma_f32_16x16x32_bf16 v[156:159], a[188:191], v[116:119], v[156:159]
    v_mfma_f32_16x16x32_bf16 v[140:143], a[192:195], v[104:107], v[140:143]
    v_mfma_f32_16x16x32_bf16 v[160:163], a[192:195], v[116:119], v[160:163]
    v_mfma_f32_16x16x32_bf16 v[144:147], a[196:199], v[104:107], v[144:147]
    v_mfma_f32_16x16x32_bf16 v[164:167], a[196:199], v[116:119], v[164:167]
    s_waitcnt vmcnt(14)
    v_mfma_f32_16x16x32_bf16 v[128:131], a[200:203], v[108:111], v[128:131]
    v_mfma_f32_16x16x32_bf16 v[148:151], a[200:203], v[120:123], v[148:151]
    v_mfma_f32_16x16x32_bf16 v[132:135], a[204:207], v[108:111], v[132:135]
    v_mfma_f32_16x16x32_bf16 v[152:155], a[204:207], v[120:123], v[152:155]
    v_mfma_f32_16x16x32_bf16 v[136:139], a[208:211], v[108:111], v[136:139]
    v_mfma_f32_16x16x32_bf16 v[156:159], a[208:211], v[120:123], v[156:159]
    v_mfma_f32_16x16x32_bf16 v[140:143], a[212:215], v[108:111], v[140:143]
    v_mfma_f32_16x16x32_bf16 v[160:163], a[212:215], v[120:123], v[160:163]
    v_mfma_f32_16x16x32_bf16 v[144:147], a[216:219], v[108:111], v[144:147]
    v_mfma_f32_16x16x32_bf16 v[164:167], a[216:219], v[120:123], v[164:167]
    s_waitcnt vmcnt(13)
    v_mfma_f32_16x16x32_bf16 v[128:131], a[220:223], v[112:115], v[128:131]
    v_mfma_f32_16x16x32_bf16 v[148:151], a[220:223], v[124:127], v[148:151]
    v_mfma_f32_16x16x32_bf16 v[132:135], a[224:227], v[112:115], v[132:135]
    v_mfma_f32_16x16x32_bf16 v[152:155], a[224:227], v[124:127], v[152:155]
    v_mfma_f32_16x16x32_bf16 v[136:139], a[228:231], v[112:115], v[136:139]
    s_add_u32 s31, s39, 35651584
    buffer_load_dwordx4 v[56:59], v19, s[24:27], s31 offen offset:0 sc1
    buffer_load_dwordx4 v[60:63], v19, s[24:27], s31 offen offset:256 sc1
    buffer_load_dwordx4 v[64:67], v19, s[24:27], s31 offen offset:512 sc1
    buffer_load_dwordx4 v[68:71], v19, s[24:27], s31 offen offset:768 sc1
    v_mfma_f32_16x16x32_bf16 v[156:159], a[228:231], v[124:127], v[156:159]
    v_mfma_f32_16x16x32_bf16 v[140:143], a[232:235], v[112:115], v[140:143]
    v_mfma_f32_16x16x32_bf16 v[160:163], a[232:235], v[124:127], v[160:163]
    v_mfma_f32_16x16x32_bf16 v[144:147], a[236:239], v[112:115], v[144:147]
    v_mfma_f32_16x16x32_bf16 v[164:167], a[236:239], v[124:127], v[164:167]
    s_waitcnt vmcnt(13)
    s_waitcnt lgkmcnt(5)
    v_mfma_f32_16x16x32_bf16 v[128:131], v[176:179], v[208:211], v[128:131]
    ds_read_b128 v[200:203], v4 offset:6144
    v_mfma_f32_16x16x32_bf16 v[148:151], v[176:179], v[220:223], v[148:151]
    s_waitcnt lgkmcnt(5)
    v_mfma_f32_16x16x32_bf16 v[132:135], v[180:183], v[208:211], v[132:135]
    ds_read_b128 v[204:207], v4 offset:7168
    v_mfma_f32_16x16x32_bf16 v[152:155], v[180:183], v[220:223], v[152:155]
    s_waitcnt lgkmcnt(5)
    v_mfma_f32_16x16x32_bf16 v[136:139], v[184:187], v[208:211], v[136:139]
    ds_read_b128 v[176:179], v4 offset:8192
    v_mfma_f32_16x16x32_bf16 v[156:159], v[184:187], v[220:223], v[156:159]
    s_waitcnt lgkmcnt(5)
    v_mfma_f32_16x16x32_bf16 v[140:143], v[188:191], v[208:211], v[140:143]
    ds_read_b128 v[180:183], v4 offset:9216
    v_mfma_f32_16x16x32_bf16 v[160:163], v[188:191], v[220:223], v[160:163]
    s_waitcnt lgkmcnt(5)
    v_mfma_f32_16x16x32_bf16 v[144:147], v[192:195], v[208:211], v[144:147]
    ds_read_b128 v[184:187], v4 offset:10240
    v_mfma_f32_16x16x32_bf16 v[164:167], v[192:195], v[220:223], v[164:167]
    s_waitcnt vmcnt(11)
    s_waitcnt lgkmcnt(5)
    v_mfma_f32_16x16x32_bf16 v[128:131], v[196:199], v[212:215], v[128:131]
    ds_read_b128 v[188:191], v4 offset:11264
    v_mfma_f32_16x16x32_bf16 v[148:151], v[196:199], v[224:227], v[148:151]
    s_waitcnt lgkmcnt(5)
    v_mfma_f32_16x16x32_bf16 v[132:135], v[200:203], v[212:215], v[132:135]
    ds_read_b128 v[192:195], v4 offset:12288
    v_mfma_f32_16x16x32_bf16 v[152:155], v[200:203], v[224:227], v[152:155]
    s_waitcnt lgkmcnt(5)
    v_mfma_f32_16x16x32_bf16 v[136:139], v[204:207], v[212:215], v[136:139]
    ds_read_b128 v[196:199], v4 offset:13312
    v_mfma_f32_16x16x32_bf16 v[156:159], v[204:207], v[224:227], v[156:159]
    s_waitcnt lgkmcnt(5)
    v_mfma_f32_16x16x32_bf16 v[140:143], v[176:179], v[212:215], v[140:143]
    ds_read_b128 v[200:203], v4 offset:14336
    v_mfma_f32_16x16x32_bf16 v[160:163], v[176:179], v[224:227], v[160:163]
    s_waitcnt lgkmcnt(5)
    v_mfma_f32_16x16x32_bf16 v[144:147], v[180:183], v[212:215], v[144:147]
    ds_read_b128 v[204:207], v4 offset:15360
    v_mfma_f32_16x16x32_bf16 v[164:167], v[180:183], v[224:227], v[164:167]
    s_waitcnt vmcnt(10)
    s_waitcnt lgkmcnt(5)
    v_mfma_f32_16x16x32_bf16 v[128:131], v[184:187], v[216:219], v[128:131]
    ds_read_b128 v[176:179], v4 offset:16384
    v_mfma_f32_16x16x32_bf16 v[148:151], v[184:187], v[228:231], v[148:151]
    s_waitcnt lgkmcnt(5)
    v_mfma_f32_16x16x32_bf16 v[132:135], v[188:191], v[216:219], v[132:135]
    ds_read_b128 v[180:183], v4 offset:17408
    v_mfma_f32_16x16x32_bf16 v[152:155], v[188:191], v[228:231], v[152:155]
    s_waitcnt lgkmcnt(5)
    v_mfma_f32_16x16x32_bf16 v[136:139], v[192:195], v[216:219], v[136:139]
    ds_read_b128 v[184:187], v4 offset:18432
    v_mfma_f32_16x16x32_bf16 v[156:159], v[192:195], v[228:231], v[156:159]
    s_waitcnt lgkmcnt(5)
    v_mfma_f32_16x16x32_bf16 v[140:143], v[196:199], v[216:219], v[140:143]
    ds_read_b128 v[188:191], v4 offset:19456
    v_mfma_f32_16x16x32_bf16 v[160:163], v[196:199], v[228:231], v[160:163]
    s_waitcnt lgkmcnt(5)
    v_mfma_f32_16x16x32_bf16 v[144:147], v[200:203], v[216:219], v[144:147]
    ds_read_b128 v[192:195], v4 offset:20480
    v_mfma_f32_16x16x32_bf16 v[164:167], v[200:203], v[228:231], v[164:167]
    s_waitcnt vmcnt(0)
    s_branch Lso_interleave_layers__ssm_conv_h3__swiglu_ffn__prompt_kernel_43
Lst_interleave_layers__ssm_conv_h3__swiglu_ffn__prompt_kernel_42:
    s_sleep 1
    buffer_load_dwordx4 v[56:59], v19, s[24:27], s31 offen offset:0 sc1
    buffer_load_dwordx4 v[60:63], v19, s[24:27], s31 offen offset:256 sc1
    buffer_load_dwordx4 v[64:67], v19, s[24:27], s31 offen offset:512 sc1
    buffer_load_dwordx4 v[68:71], v19, s[24:27], s31 offen offset:768 sc1
    s_waitcnt vmcnt(0)
    s_sub_u32 s58, s58, 1
    s_cbranch_scc1 Lk2_end
Lso_interleave_layers__ssm_conv_h3__swiglu_ffn__prompt_kernel_43:
    v_cmp_ne_u64 s[68:69], v[2:3], v[58:59]
    v_cmp_ne_u64 s[70:71], v[2:3], v[62:63]
    v_cmp_ne_u64 s[72:73], v[2:3], v[66:67]
    v_cmp_ne_u64 vcc, v[2:3], v[70:71]
    s_or_b64 s[68:69], s[68:69], s[70:71]
    s_or_b64 vcc, vcc, s[72:73]
    s_or_b64 vcc, vcc, s[68:69]
    s_cbranch_vccnz Lst_interleave_layers__ssm_conv_h3__swiglu_ffn__prompt_kernel_42
    v_add_f32 v56, v56, v60
    v_add_f32 v57, v57, v61
    v_add_f32 v64, v64, v68
    v_add_f32 v65, v65, v69
    v_add_f32 v56, v56, v64
    v_add_f32 v57, v57, v65
    v_mov_b32 v58, v56
    v_mov_b32 v59, v57
    s_nop 0
    v_permlane16_swap_b32 v56, v58
    v_permlane16_swap_b32 v57, v59
    v_add_f32 v56, v56, v58
    v_add_f32 v57, v57, v59
    v_mov_b32 v58, v56
    v_mov_b32 v59, v57
    s_nop 0
    v_permlane32_swap_b32 v56, v58
    v_permlane32_swap_b32 v57, v59
    v_add_f32 v56, v56, v58
    v_add_f32 v57, v57, v59
    v_mul_f32 v56, 0x3acccccd, v56
    v_mul_f32 v57, 0x3acccccd, v57
    v_fma_f32 v57, -v56, v56, v57
    v_max_f32 v57, 0, v57
    v_cvt_pk_bf16_f32 v58, v56, v57
    v_lshlrev_b32 v56, 16, v58
    v_and_b32 v57, 0xffff0000, v58
    v_add_f32 v57, 0x3727c5ac, v57
    v_cvt_pk_bf16_f32 v58, v57, v57
    v_lshlrev_b32 v57, 16, v58
    v_sqrt_f32 v57, v57
    s_nop 0
    v_cvt_pk_bf16_f32 v58, v57, v57
    v_lshlrev_b32 v57, 16, v58
    v_rcp_f32 v57, v57
    s_nop 0
    v_mul_f32 v56, v56, v57
    s_mov_b32 s30, 19922944
    v_accvgpr_read_b32 v58, a240
    v_lshlrev_b32 v60, 16, v32
    v_and_b32 v61, 0xffff0000, v32
    v_lshlrev_b32 v62, 16, v58
    v_and_b32 v63, 0xffff0000, v58
    v_pk_fma_f32 v[64:65], v[60:61], v[56:57], v[56:57] op_sel:[0,1,0] op_sel_hi:[1,1,0] neg_lo:[0,0,1] neg_hi:[0,0,1]
    v_pk_fma_f32 v[64:65], v[64:65], v[62:63], v[60:61]
    v_cvt_pk_bf16_f32 v32, v64, v65
    v_accvgpr_read_b32 v59, a241
    v_lshlrev_b32 v66, 16, v33
    v_and_b32 v67, 0xffff0000, v33
    v_lshlrev_b32 v68, 16, v59
    v_and_b32 v69, 0xffff0000, v59
    v_pk_fma_f32 v[70:71], v[66:67], v[56:57], v[56:57] op_sel:[0,1,0] op_sel_hi:[1,1,0] neg_lo:[0,0,1] neg_hi:[0,0,1]
    v_pk_fma_f32 v[70:71], v[70:71], v[68:69], v[66:67]
    v_cvt_pk_bf16_f32 v33, v70, v71
    v_accvgpr_read_b32 v58, a242
    v_lshlrev_b32 v60, 16, v34
    v_and_b32 v61, 0xffff0000, v34
    v_lshlrev_b32 v62, 16, v58
    v_and_b32 v63, 0xffff0000, v58
    v_pk_fma_f32 v[64:65], v[60:61], v[56:57], v[56:57] op_sel:[0,1,0] op_sel_hi:[1,1,0] neg_lo:[0,0,1] neg_hi:[0,0,1]
    v_pk_fma_f32 v[64:65], v[64:65], v[62:63], v[60:61]
    v_cvt_pk_bf16_f32 v34, v64, v65
    v_accvgpr_read_b32 v59, a243
    v_lshlrev_b32 v66, 16, v35
    v_and_b32 v67, 0xffff0000, v35
    v_lshlrev_b32 v68, 16, v59
    v_and_b32 v69, 0xffff0000, v59
    v_pk_fma_f32 v[70:71], v[66:67], v[56:57], v[56:57] op_sel:[0,1,0] op_sel_hi:[1,1,0] neg_lo:[0,0,1] neg_hi:[0,0,1]
    v_pk_fma_f32 v[70:71], v[70:71], v[68:69], v[66:67]
    v_cvt_pk_bf16_f32 v35, v70, v71
    buffer_store_dwordx4 v[32:35], v12, s[24:27], s30 offen sc1
    v_accvgpr_read_b32 v58, a244
    v_lshlrev_b32 v60, 16, v36
    v_and_b32 v61, 0xffff0000, v36
    v_lshlrev_b32 v62, 16, v58
    v_and_b32 v63, 0xffff0000, v58
    v_pk_fma_f32 v[64:65], v[60:61], v[56:57], v[56:57] op_sel:[0,1,0] op_sel_hi:[1,1,0] neg_lo:[0,0,1] neg_hi:[0,0,1]
    v_pk_fma_f32 v[64:65], v[64:65], v[62:63], v[60:61]
    v_cvt_pk_bf16_f32 v36, v64, v65
    v_accvgpr_read_b32 v59, a245
    v_lshlrev_b32 v66, 16, v37
    v_and_b32 v67, 0xffff0000, v37
    v_lshlrev_b32 v68, 16, v59
    v_and_b32 v69, 0xffff0000, v59
    v_pk_fma_f32 v[70:71], v[66:67], v[56:57], v[56:57] op_sel:[0,1,0] op_sel_hi:[1,1,0] neg_lo:[0,0,1] neg_hi:[0,0,1]
    v_pk_fma_f32 v[70:71], v[70:71], v[68:69], v[66:67]
    v_cvt_pk_bf16_f32 v37, v70, v71
    buffer_store_dwordx2 v[36:37], v13, s[24:27], s30 offen sc1
    s_waitcnt lgkmcnt(5)
    v_mfma_f32_16x16x32_bf16 v[128:131], v[204:207], v[232:235], v[128:131]
    ds_read_b128 v[196:199], v4 offset:21504
    v_mfma_f32_16x16x32_bf16 v[148:151], v[204:207], v[244:247], v[148:151]
    s_waitcnt lgkmcnt(5)
    v_mfma_f32_16x16x32_bf16 v[132:135], v[176:179], v[232:235], v[132:135]
    ds_read_b128 v[200:203], v4 offset:22528
    v_mfma_f32_16x16x32_bf16 v[152:155], v[176:179], v[244:247], v[152:155]
    s_waitcnt lgkmcnt(5)
    v_mfma_f32_16x16x32_bf16 v[136:139], v[180:183], v[232:235], v[136:139]
    ds_read_b128 v[204:207], v4 offset:23552
    v_mfma_f32_16x16x32_bf16 v[156:159], v[180:183], v[244:247], v[156:159]
    s_waitcnt lgkmcnt(5)
    v_mfma_f32_16x16x32_bf16 v[140:143], v[184:187], v[232:235], v[140:143]
    ds_read_b128 v[176:179], v4 offset:24576
    v_mfma_f32_16x16x32_bf16 v[160:163], v[184:187], v[244:247], v[160:163]
    s_waitcnt lgkmcnt(5)
    v_mfma_f32_16x16x32_bf16 v[144:147], v[188:191], v[232:235], v[144:147]
    ds_read_b128 v[180:183], v4 offset:25600
    v_mfma_f32_16x16x32_bf16 v[164:167], v[188:191], v[244:247], v[164:167]
    s_waitcnt lgkmcnt(5)
    v_mfma_f32_16x16x32_bf16 v[128:131], v[192:195], v[236:239], v[128:131]
    ds_read_b128 v[184:187], v4 offset:26624
    v_mfma_f32_16x16x32_bf16 v[148:151], v[192:195], v[248:251], v[148:151]
    s_waitcnt lgkmcnt(5)
    v_mfma_f32_16x16x32_bf16 v[132:135], v[196:199], v[236:239], v[132:135]
    v_mfma_f32_16x16x32_bf16 v[152:155], v[196:199], v[248:251], v[152:155]
    s_waitcnt lgkmcnt(4)
    v_mfma_f32_16x16x32_bf16 v[136:139], v[200:203], v[236:239], v[136:139]
    v_mfma_f32_16x16x32_bf16 v[156:159], v[200:203], v[248:251], v[156:159]
    s_waitcnt lgkmcnt(3)
    v_mfma_f32_16x16x32_bf16 v[140:143], v[204:207], v[236:239], v[140:143]
    v_mfma_f32_16x16x32_bf16 v[160:163], v[204:207], v[248:251], v[160:163]
    s_waitcnt lgkmcnt(2)
    v_mfma_f32_16x16x32_bf16 v[144:147], v[176:179], v[236:239], v[144:147]
    v_mfma_f32_16x16x32_bf16 v[164:167], v[176:179], v[248:251], v[164:167]
    s_waitcnt lgkmcnt(1)
    v_mfma_f32_16x16x32_bf16 v[128:131], v[180:183], v[240:243], v[128:131]
    v_mfma_f32_16x16x32_bf16 v[148:151], v[180:183], v[252:255], v[148:151]
    s_waitcnt lgkmcnt(0)
    v_mfma_f32_16x16x32_bf16 v[132:135], v[184:187], v[240:243], v[132:135]
    v_mfma_f32_16x16x32_bf16 v[152:155], v[184:187], v[252:255], v[152:155]
    v_mfma_f32_16x16x32_bf16 v[136:139], a[108:111], v[240:243], v[136:139]
    v_mfma_f32_16x16x32_bf16 v[156:159], a[108:111], v[252:255], v[156:159]
    v_mfma_f32_16x16x32_bf16 v[140:143], a[112:115], v[240:243], v[140:143]
    v_mfma_f32_16x16x32_bf16 v[160:163], a[112:115], v[252:255], v[160:163]
    v_mfma_f32_16x16x32_bf16 v[144:147], a[116:119], v[240:243], v[144:147]
    v_mfma_f32_16x16x32_bf16 v[164:167], a[116:119], v[252:255], v[164:167]
    s_waitcnt vmcnt(0)
    s_barrier
    s_cmp_lg_u32 s40, 0
    s_cbranch_scc1 Lsg_interleave_layers__ssm_conv_h3__swiglu_ffn__prompt_kernel_44
    s_lshl_b32 s3, s45, 8
    s_add_u32 s3, s3, 13762560
    s_mov_b64 exec, 1
    buffer_store_dwordx2 v[2:3], off, s[24:27], s3 sc1
    s_mov_b64 exec, -1
Lsg_interleave_layers__ssm_conv_h3__swiglu_ffn__prompt_kernel_44:
    s_mul_i32 s3, s40, 10240
    v_add_u32 v72, s3, v7
    ds_write_b128 v72, v[128:131] offset:0
    ds_write_b128 v72, v[132:135] offset:1024
    ds_write_b128 v72, v[136:139] offset:2048
    ds_write_b128 v72, v[140:143] offset:3072
    ds_write_b128 v72, v[144:147] offset:4096
    ds_write_b128 v72, v[148:151] offset:5120
    ds_write_b128 v72, v[152:155] offset:6144
    ds_write_b128 v72, v[156:159] offset:7168
    ds_write_b128 v72, v[160:163] offset:8192
    ds_write_b128 v72, v[164:167] offset:9216
    v_lshlrev_b32 v56, 16, v38
    v_and_b32 v57, 0xffff0000, v38
    v_lshlrev_b32 v58, 16, v39
    v_and_b32 v59, 0xffff0000, v39
    v_lshlrev_b32 v60, 16, v40
    v_and_b32 v61, 0xffff0000, v40
    v_lshlrev_b32 v62, 16, v41
    v_and_b32 v63, 0xffff0000, v41
    v_lshlrev_b32 v64, 16, v42
    v_and_b32 v65, 0xffff0000, v42
    v_lshlrev_b32 v66, 16, v43
    v_and_b32 v67, 0xffff0000, v43
    s_waitcnt lgkmcnt(0)
    s_barrier
    ds_read_b128 v[128:131], v14 offset:0
    ds_read_b128 v[132:135], v14 offset:10240
    ds_read_b128 v[136:139], v14 offset:20480
    ds_read_b128 v[140:143], v14 offset:30720
    ds_read_b128 v[144:147], v14 offset:1024
    ds_read_b128 v[148:151], v14 offset:11264
    ds_read_b128 v[152:155], v14 offset:21504
    ds_read_b128 v[156:159], v14 offset:31744
    ds_read_b128 v[160:163], v15 offset:0
    ds_read_b128 v[164:167], v15 offset:10240
    ds_read_b128 v[168:171], v15 offset:20480
    ds_read_b128 v[172:175], v15 offset:30720
    s_waitcnt lgkmcnt(8)
    v_pk_add_f32 v[128:129], v[128:129], v[132:133]
    v_pk_add_f32 v[130:131], v[130:131], v[134:135]
    v_pk_add_f32 v[136:137], v[136:137], v[140:141]
    v_pk_add_f32 v[138:139], v[138:139], v[142:143]
    s_waitcnt lgkmcnt(4)
    v_pk_add_f32 v[144:145], v[144:145], v[148:149]
    v_pk_add_f32 v[146:147], v[146:147], v[150:151]
    v_pk_add_f32 v[152:153], v[152:153], v[156:157]
    v_pk_add_f32 v[154:155], v[154:155], v[158:159]
    s_waitcnt lgkmcnt(0)
    v_pk_add_f32 v[160:161], v[160:161], v[164:165]
    v_pk_add_f32 v[162:163], v[162:163], v[166:167]
    v_pk_add_f32 v[168:169], v[168:169], v[172:173]
    v_pk_add_f32 v[170:171], v[170:171], v[174:175]
    v_pk_add_f32 v[128:129], v[128:129], v[136:137]
    v_pk_add_f32 v[130:131], v[130:131], v[138:139]
    v_pk_add_f32 v[144:145], v[144:145], v[152:153]
    v_pk_add_f32 v[146:147], v[146:147], v[154:155]
    v_pk_add_f32 v[160:161], v[160:161], v[168:169]
    v_pk_add_f32 v[162:163], v[162:163], v[170:171]
    v_cvt_pk_bf16_f32 v132, v128, v129
    v_cvt_pk_bf16_f32 v133, v130, v131
    v_cvt_pk_bf16_f32 v148, v144, v145
    v_cvt_pk_bf16_f32 v149, v146, v147
    v_cvt_pk_bf16_f32 v164, v160, v161
    v_cvt_pk_bf16_f32 v165, v162, v163
    v_lshlrev_b32 v128, 16, v132
    v_and_b32 v129, 0xffff0000, v132
    v_lshlrev_b32 v130, 16, v133
    v_and_b32 v131, 0xffff0000, v133
    v_lshlrev_b32 v144, 16, v148
    v_and_b32 v145, 0xffff0000, v148
    v_lshlrev_b32 v146, 16, v149
    v_and_b32 v147, 0xffff0000, v149
    v_lshlrev_b32 v160, 16, v164
    v_and_b32 v161, 0xffff0000, v164
    v_lshlrev_b32 v162, 16, v165
    v_and_b32 v163, 0xffff0000, v165
    v_pk_add_f32 v[128:129], v[128:129], v[56:57]
    v_pk_add_f32 v[130:131], v[130:131], v[58:59]
    v_pk_add_f32 v[144:145], v[144:145], v[60:61]
    v_pk_add_f32 v[146:147], v[146:147], v[62:63]
    v_pk_add_f32 v[160:161], v[160:161], v[64:65]
    v_pk_add_f32 v[162:163], v[162:163], v[66:67]
    v_cvt_pk_bf16_f32 v38, v128, v129
    v_cvt_pk_bf16_f32 v39, v130, v131
    v_cvt_pk_bf16_f32 v40, v144, v145
    v_cvt_pk_bf16_f32 v41, v146, v147
    v_cvt_pk_bf16_f32 v42, v160, v161
    v_cvt_pk_bf16_f32 v43, v162, v163
    s_lshl_b32 s33, s41, 1
    s_add_u32 s33, s33, s54
    s_lshl_b32 s33, s33, 11
    s_add_u32 s33, s33, 13762560
    s_mov_b64 exec, 0xff
    buffer_load_dwordx2 v[10:11], v9, s[24:27], s33 offen sc1
    s_mov_b64 exec, -1
    v_dot2_f32_bf16 v72, v38, s55, 0
    v_dot2_f32_bf16 v73, v38, v38, 0
    v_dot2_f32_bf16 v74, v40, s55, 0
    v_dot2_f32_bf16 v75, v40, v40, 0
    v_dot2_f32_bf16 v76, v42, s55, 0
    v_dot2_f32_bf16 v77, v42, v42, 0
    v_dot2_f32_bf16 v72, v39, s55, v72
    v_dot2_f32_bf16 v73, v39, v39, v73
    v_dot2_f32_bf16 v74, v41, s55, v74
    v_dot2_f32_bf16 v75, v41, v41, v75
    v_dot2_f32_bf16 v76, v43, s55, v76
    v_dot2_f32_bf16 v77, v43, v43, v77
    v_add_f32 v72, v72, v74
    v_add_f32 v73, v73, v75
    v_fma_f32 v72, v76, s34, v72
    v_fma_f32 v73, v77, s34, v73
    v_mov_b32 v76, v72
    v_mov_b32 v77, v73
    s_nop 0
    v_permlane16_swap_b32 v72, v76
    v_permlane16_swap_b32 v73, v77
    v_add_f32 v72, v72, v76
    v_add_f32 v73, v73, v77
    v_mov_b32 v76, v72
    v_mov_b32 v77, v73
    s_nop 0
    v_permlane32_swap_b32 v72, v76
    v_permlane32_swap_b32 v73, v77
    v_add_f32 v72, v72, v76
    v_add_f32 v73, v73, v77
    v_mov_b32 v74, v2
    v_mov_b32 v75, v3
    s_mov_b32 s7, 35667968
    s_mov_b64 exec, 0xffff
    buffer_store_dwordx4 v[72:75], v18, s[24:27], s7 offen sc1
    s_mov_b64 exec, -1
    s_nop 0
    v_dot2_f32_bf16 v72, v32, s55, 0
    v_dot2_f32_bf16 v73, v32, v32, 0
    v_dot2_f32_bf16 v74, v34, s55, 0
    v_dot2_f32_bf16 v75, v34, v34, 0
    v_dot2_f32_bf16 v76, v36, s55, 0
    v_dot2_f32_bf16 v77, v36, v36, 0
    v_dot2_f32_bf16 v72, v33, s55, v72
    v_dot2_f32_bf16 v73, v33, v33, v73
    v_dot2_f32_bf16 v74, v35, s55, v74
    v_dot2_f32_bf16 v75, v35, v35, v75
    v_dot2_f32_bf16 v76, v37, s55, v76
    v_dot2_f32_bf16 v77, v37, v37, v77
    v_add_f32 v72, v72, v74
    v_add_f32 v73, v73, v75
    v_fma_f32 v72, v76, s34, v72
    v_fma_f32 v73, v77, s34, v73
    v_mov_b32 v76, v72
    v_mov_b32 v77, v73
    s_nop 0
    v_permlane16_swap_b32 v72, v76
    v_permlane16_swap_b32 v73, v77
    v_add_f32 v72, v72, v76
    v_add_f32 v73, v73, v77
    v_mov_b32 v76, v72
    v_mov_b32 v77, v73
    s_nop 0
    v_permlane32_swap_b32 v72, v76
    v_permlane32_swap_b32 v73, v77
    v_add_f32 v72, v72, v76
    v_add_f32 v73, v73, v77
    v_mov_b32 v74, v2
    v_mov_b32 v75, v3
    s_mov_b32 s7, 36700160
    s_mov_b64 exec, 0xffff
    buffer_store_dwordx4 v[72:75], v18, s[24:27], s7 offen sc1
    s_mov_b64 exec, -1
    v_mfma_f32_16x16x32_bf16 v[20:23], a[0:3], a[252:255], v[20:23]
    v_mfma_f32_16x16x32_bf16 v[24:27], a[4:7], a[252:255], v[24:27]
    v_mfma_f32_16x16x32_bf16 v[28:31], a[8:11], a[252:255], v[28:31]
    v_mfma_f32_16x16x32_bf16 v[20:23], a[12:15], a[252:255], v[20:23]
    v_mfma_f32_16x16x32_bf16 v[24:27], a[16:19], a[252:255], v[24:27]
    v_mfma_f32_16x16x32_bf16 v[28:31], a[20:23], a[252:255], v[28:31]
    s_waitcnt vmcnt(2)
    s_mov_b64 exec, 0xff
    s_branch Lpo_interleave_layers__ssm_conv_h3__swiglu_ffn__prompt_kernel_46
Lpr_interleave_layers__ssm_conv_h3__swiglu_ffn__prompt_kernel_45:
    s_sleep 2
    buffer_load_dwordx2 v[10:11], v9, s[24:27], s33 offen sc1
    s_waitcnt vmcnt(0)
    s_sub_u32 s58, s58, 1
    s_cbranch_scc1 Lk2_end
Lpo_interleave_layers__ssm_conv_h3__swiglu_ffn__prompt_kernel_46:
    v_cmp_ne_u64 vcc, v[2:3], v[10:11]
    s_cbranch_vccnz Lpr_interleave_layers__ssm_conv_h3__swiglu_ffn__prompt_kernel_45
    s_mov_b64 exec, -1
    s_barrier
    s_add_u32 m0, s49, 0
    s_add_u32 s38, s48, 19922944
    buffer_load_dwordx4 v7, s[24:27], s38 offen offset:0 sc1 lds
    buffer_load_dwordx4 v7, s[24:27], s38 offen offset:1024 sc1 lds
    buffer_load_dwordx4 v7, s[24:27], s38 offen offset:2048 sc1 lds
    buffer_load_dwordx4 v7, s[24:27], s38 offen offset:3072 sc1 lds
    s_add_u32 m0, s49, 4096
    s_add_u32 s38, s48, 19927040
    buffer_load_dwordx4 v7, s[24:27], s38 offen offset:0 sc1 lds
    buffer_load_dwordx4 v7, s[24:27], s38 offen offset:1024 sc1 lds
    s_add_u32 s31, s39, 35667968
    buffer_load_dwordx4 v[56:59], v19, s[24:27], s31 offen offset:0 sc1
    buffer_load_dwordx4 v[60:63], v19, s[24:27], s31 offen offset:256 sc1
    buffer_load_dwordx4 v[64:67], v19, s[24:27], s31 offen offset:512 sc1
    buffer_load_dwordx4 v[68:71], v19, s[24:27], s31 offen offset:768 sc1
    buffer_load_dwordx4 v7, s[24:27], s38 offen offset:2048 sc1 lds
    buffer_load_dwordx4 v7, s[24:27], s38 offen offset:3072 sc1 lds
    s_add_u32 m0, s49, 8192
    s_add_u32 s38, s48, 19931136
    buffer_load_dwordx4 v7, s[24:27], s38 offen offset:0 sc1 lds
    buffer_load_dwordx4 v7, s[24:27], s38 offen offset:1024 sc1 lds
    v_mfma_f32_16x16x32_bf16 v[20:23], a[24:27], a[252:255], v[20:23]
    v_mfma_f32_16x16x32_bf16 v[24:27], a[28:31], a[252:255], v[24:27]
    v_mfma_f32_16x16x32_bf16 v[28:31], a[32:35], a[252:255], v[28:31]
    v_mfma_f32_16x16x32_bf16 v[20:23], a[36:39], a[252:255], v[20:23]
    v_mfma_f32_16x16x32_bf16 v[24:27], a[40:43], a[252:255], v[24:27]
    v_mfma_f32_16x16x32_bf16 v[28:31], a[44:47], a[252:255], v[28:31]
    v_mfma_f32_16x16x32_bf16 v[20:23], a[48:51], a[252:255], v[20:23]
    v_mfma_f32_16x16x32_bf16 v[24:27], a[52:55], a[252:255], v[24:27]
    v_mfma_f32_16x16x32_bf16 v[28:31], a[56:59], a[252:255], v[28:31]
    v_mfma_f32_16x16x32_bf16 v[20:23], a[60:63], a[252:255], v[20:23]
    v_mfma_f32_16x16x32_bf16 v[24:27], a[64:67], a[252:255], v[24:27]
    v_mfma_f32_16x16x32_bf16 v[28:31], a[68:71], a[252:255], v[28:31]
    v_mfma_f32_16x16x32_bf16 v[20:23], a[72:75], a[252:255], v[20:23]
    v_mfma_f32_16x16x32_bf16 v[24:27], a[76:79], a[252:255], v[24:27]
    v_mfma_f32_16x16x32_bf16 v[28:31], a[80:83], a[252:255], v[28:31]
    v_mfma_f32_16x16x32_bf16 v[20:23], a[84:87], a[252:255], v[20:23]
    v_mfma_f32_16x16x32_bf16 v[24:27], a[88:91], a[252:255], v[24:27]
    v_mfma_f32_16x16x32_bf16 v[28:31], a[92:95], a[252:255], v[28:31]
    s_waitcnt vmcnt(4)
    s_branch Lso_interleave_layers__ssm_conv_h3__swiglu_ffn__prompt_kernel_48
Lst_interleave_layers__ssm_conv_h3__swiglu_ffn__prompt_kernel_47:
    s_sleep 1
    buffer_load_dwordx4 v[56:59], v19, s[24:27], s31 offen offset:0 sc1
    buffer_load_dwordx4 v[60:63], v19, s[24:27], s31 offen offset:256 sc1
    buffer_load_dwordx4 v[64:67], v19, s[24:27], s31 offen offset:512 sc1
    buffer_load_dwordx4 v[68:71], v19, s[24:27], s31 offen offset:768 sc1
    s_waitcnt vmcnt(0)
    s_sub_u32 s58, s58, 1
    s_cbranch_scc1 Lk2_end
Lso_interleave_layers__ssm_conv_h3__swiglu_ffn__prompt_kernel_48:
    v_cmp_ne_u64 s[68:69], v[2:3], v[58:59]
    v_cmp_ne_u64 s[70:71], v[2:3], v[62:63]
    v_cmp_ne_u64 s[72:73], v[2:3], v[66:67]
    v_cmp_ne_u64 vcc, v[2:3], v[70:71]
    s_or_b64 s[68:69], s[68:69], s[70:71]
    s_or_b64 vcc, vcc, s[72:73]
    s_or_b64 vcc, vcc, s[68:69]
    s_cbranch_vccnz Lst_interleave_layers__ssm_conv_h3__swiglu_ffn__prompt_kernel_47
    v_add_f32 v56, v56, v60
    v_add_f32 v57, v57, v61
    v_add_f32 v64, v64, v68
    v_add_f32 v65, v65, v69
    v_add_f32 v56, v56, v64
    v_add_f32 v57, v57, v65
    v_mov_b32 v58, v56
    v_mov_b32 v59, v57
    s_nop 0
    v_permlane16_swap_b32 v56, v58
    v_permlane16_swap_b32 v57, v59
    v_add_f32 v56, v56, v58
    v_add_f32 v57, v57, v59
    v_mov_b32 v58, v56
    v_mov_b32 v59, v57
    s_nop 0
    v_permlane32_swap_b32 v56, v58
    v_permlane32_swap_b32 v57, v59
    v_add_f32 v56, v56, v58
    v_add_f32 v57, v57, v59
    v_mul_f32 v56, 0x3acccccd, v56
    v_mul_f32 v57, 0x3acccccd, v57
    v_fma_f32 v57, -v56, v56, v57
    v_max_f32 v57, 0, v57
    v_cvt_pk_bf16_f32 v58, v56, v57
    v_lshlrev_b32 v56, 16, v58
    v_and_b32 v57, 0xffff0000, v58
    v_add_f32 v57, 0x3727c5ac, v57
    v_cvt_pk_bf16_f32 v58, v57, v57
    v_lshlrev_b32 v57, 16, v58
    v_sqrt_f32 v57, v57
    s_nop 0
    v_cvt_pk_bf16_f32 v58, v57, v57
    v_lshlrev_b32 v57, 16, v58
    v_rcp_f32 v57, v57
    s_nop 0
    v_mul_f32 v56, v56, v57
    s_mov_b32 s30, 20004864
    v_accvgpr_read_b32 v58, a246
    v_lshlrev_b32 v60, 16, v38
    v_and_b32 v61, 0xffff0000, v38
    v_lshlrev_b32 v62, 16, v58
    v_and_b32 v63, 0xffff0000, v58
    v_pk_fma_f32 v[64:65], v[60:61], v[56:57], v[56:57] op_sel:[0,1,0] op_sel_hi:[1,1,0] neg_lo:[0,0,1] neg_hi:[0,0,1]
    v_pk_fma_f32 v[64:65], v[64:65], v[62:63], v[60:61]
    v_cvt_pk_bf16_f32 v38, v64, v65
    v_accvgpr_read_b32 v59, a247
    v_lshlrev_b32 v66, 16, v39
    v_and_b32 v67, 0xffff0000, v39
    v_lshlrev_b32 v68, 16, v59
    v_and_b32 v69, 0xffff0000, v59
    v_pk_fma_f32 v[70:71], v[66:67], v[56:57], v[56:57] op_sel:[0,1,0] op_sel_hi:[1,1,0] neg_lo:[0,0,1] neg_hi:[0,0,1]
    v_pk_fma_f32 v[70:71], v[70:71], v[68:69], v[66:67]
    v_cvt_pk_bf16_f32 v39, v70, v71
    v_accvgpr_read_b32 v58, a248
    v_lshlrev_b32 v60, 16, v40
    v_and_b32 v61, 0xffff0000, v40
    v_lshlrev_b32 v62, 16, v58
    v_and_b32 v63, 0xffff0000, v58
    v_pk_fma_f32 v[64:65], v[60:61], v[56:57], v[56:57] op_sel:[0,1,0] op_sel_hi:[1,1,0] neg_lo:[0,0,1] neg_hi:[0,0,1]
    v_pk_fma_f32 v[64:65], v[64:65], v[62:63], v[60:61]
    v_cvt_pk_bf16_f32 v40, v64, v65
    v_accvgpr_read_b32 v59, a249
    v_lshlrev_b32 v66, 16, v41
    v_and_b32 v67, 0xffff0000, v41
    v_lshlrev_b32 v68, 16, v59
    v_and_b32 v69, 0xffff0000, v59
    v_pk_fma_f32 v[70:71], v[66:67], v[56:57], v[56:57] op_sel:[0,1,0] op_sel_hi:[1,1,0] neg_lo:[0,0,1] neg_hi:[0,0,1]
    v_pk_fma_f32 v[70:71], v[70:71], v[68:69], v[66:67]
    v_cvt_pk_bf16_f32 v41, v70, v71
    buffer_store_dwordx4 v[38:41], v12, s[24:27], s30 offen sc1
    v_accvgpr_read_b32 v58, a250
    v_lshlrev_b32 v60, 16, v42
    v_and_b32 v61, 0xffff0000, v42
    v_lshlrev_b32 v62, 16, v58
    v_and_b32 v63, 0xffff0000, v58
    v_pk_fma_f32 v[64:65], v[60:61], v[56:57], v[56:57] op_sel:[0,1,0] op_sel_hi:[1,1,0] neg_lo:[0,0,1] neg_hi:[0,0,1]
    v_pk_fma_f32 v[64:65], v[64:65], v[62:63], v[60:61]
    v_cvt_pk_bf16_f32 v42, v64, v65
    v_accvgpr_read_b32 v59, a251
    v_lshlrev_b32 v66, 16, v43
    v_and_b32 v67, 0xffff0000, v43
    v_lshlrev_b32 v68, 16, v59
    v_and_b32 v69, 0xffff0000, v59
    v_pk_fma_f32 v[70:71], v[66:67], v[56:57], v[56:57] op_sel:[0,1,0] op_sel_hi:[1,1,0] neg_lo:[0,0,1] neg_hi:[0,0,1]
    v_pk_fma_f32 v[70:71], v[70:71], v[68:69], v[66:67]
    v_cvt_pk_bf16_f32 v43, v70, v71
    buffer_store_dwordx2 v[42:43], v13, s[24:27], s30 offen sc1
    buffer_load_dwordx4 v7, s[24:27], s38 offen offset:2048 sc1 lds
    buffer_load_dwordx4 v7, s[24:27], s38 offen offset:3072 sc1 lds
    s_add_u32 s62, s46, 24576
    buffer_load_dwordx4 a[108:111], v7, s[24:27], s62 offen offset:3072 sc1
    s_add_u32 s62, s46, 28672
    buffer_load_dwordx4 a[112:115], v7, s[24:27], s62 offen offset:0 sc1
    v_dot2_f32_bf16 v72, v38, s55, 0
    v_dot2_f32_bf16 v73, v38, v38, 0
    v_dot2_f32_bf16 v74, v40, s55, 0
    v_dot2_f32_bf16 v75, v40, v40, 0
    v_dot2_f32_bf16 v76, v42, s55, 0
    v_dot2_f32_bf16 v77, v42, v42, 0
    v_dot2_f32_bf16 v72, v39, s55, v72
    v_dot2_f32_bf16 v73, v39, v39, v73
    v_dot2_f32_bf16 v74, v41, s55, v74
    v_dot2_f32_bf16 v75, v41, v41, v75
    buffer_load_dwordx4 a[116:119], v7, s[24:27], s62 offen offset:1024 sc1
    v_dot2_f32_bf16 v76, v43, s55, v76
    v_dot2_f32_bf16 v77, v43, v43, v77
    v_add_f32 v72, v72, v74
    v_add_f32 v73, v73, v75
    v_fma_f32 v72, v76, s34, v72
    v_fma_f32 v73, v77, s34, v73
    v_mov_b32 v76, v72
    v_mov_b32 v77, v73
    s_nop 0
    v_permlane16_swap_b32 v72, v76
    v_permlane16_swap_b32 v73, v77
    v_add_f32 v72, v72, v76
    v_add_f32 v73, v73, v77
    v_mov_b32 v76, v72
    v_mov_b32 v77, v73
    s_nop 0
    v_permlane32_swap_b32 v72, v76
    v_permlane32_swap_b32 v73, v77
    v_add_f32 v72, v72, v76
    v_add_f32 v73, v73, v77
    buffer_load_dwordx4 a[120:123], v7, s[24:27], s62 offen offset:2048 sc1
    v_mov_b32 v74, v2
    v_mov_b32 v75, v3
    s_mov_b32 s7, 36716544
    s_mov_b64 exec, 0xffff
    buffer_store_dwordx4 v[72:75], v18, s[24:27], s7 offen sc1
    s_mov_b64 exec, -1
    s_barrier
    ds_read_b128 v[176:179], v7 offset:0
    ds_read_b128 v[180:183], v7 offset:12288
    ds_read_b128 v[184:187], v7 offset:24576
    ds_read_b128 v[188:191], v7 offset:36864
    s_waitcnt lgkmcnt(0)
    v_mfma_f32_16x16x32_bf16 v[80:83], a[0:3], v[176:179], 0
    ds_read_b128 v[192:195], v7 offset:1024
    ds_read_b128 v[196:199], v7 offset:13312
    v_mfma_f32_16x16x32_bf16 v[84:87], a[4:7], v[176:179], 0
    v_mfma_f32_16x16x32_bf16 v[88:91], a[8:11], v[176:179], 0
    ds_read_b128 v[200:203], v7 offset:25600
    ds_read_b128 v[204:207], v7 offset:37888
    v_mfma_f32_16x16x32_bf16 v[92:95], a[0:3], v[180:183], 0
    v_mfma_f32_16x16x32_bf16 v[96:99], a[4:7], v[180:183], 0
    buffer_load_dwordx4 a[124:127], v7, s[24:27], s62 offen offset:3072 sc1
    v_mfma_f32_16x16x32_bf16 v[100:103], a[8:11], v[180:183], 0
    v_mfma_f32_16x16x32_bf16 v[104:107], a[0:3], v[184:187], 0
    v_mfma_f32_16x16x32_bf16 v[108:111], a[4:7], v[184:187], 0
    v_mfma_f32_16x16x32_bf16 v[112:115], a[8:11], v[184:187], 0
    v_mfma_f32_16x16x32_bf16 v[116:119], a[0:3], v[188:191], 0
    s_add_u32 s62, s46, 32768
    buffer_load_dwordx4 a[128:131], v7, s[24:27], s62 offen offset:0 sc1
    v_mfma_f32_16x16x32_bf16 v[120:123], a[4:7], v[188:191], 0
    v_mfma_f32_16x16x32_bf16 v[124:127], a[8:11], v[188:191], 0
    s_waitcnt lgkmcnt(0)
    v_mfma_f32_16x16x32_bf16 v[80:83], a[12:15], v[192:195], v[80:83]
    ds_read_b128 v[176:179], v7 offset:2048
    ds_read_b128 v[180:183], v7 offset:14336
    v_mfma_f32_16x16x32_bf16 v[84:87], a[16:19], v[192:195], v[84:87]
    v_mfma_f32_16x16x32_bf16 v[88:91], a[20:23], v[192:195], v[88:91]
    ds_read_b128 v[184:187], v7 offset:26624
    ds_read_b128 v[188:191], v7 offset:38912
    buffer_load_dwordx4 a[132:135], v7, s[24:27], s62 offen offset:1024 sc1
    v_mfma_f32_16x16x32_bf16 v[92:95], a[12:15], v[196:199], v[92:95]
    v_mfma_f32_16x16x32_bf16 v[96:99], a[16:19], v[196:199], v[96:99]
    v_mfma_f32_16x16x32_bf16 v[100:103], a[20:23], v[196:199], v[100:103]
    v_mfma_f32_16x16x32_bf16 v[104:107], a[12:15], v[200:203], v[104:107]
    v_mfma_f32_16x16x32_bf16 v[108:111], a[16:19], v[200:203], v[108:111]
    buffer_load_dwordx4 a[136:139], v7, s[24:27], s62 offen offset:2048 sc1
    v_mfma_f32_16x16x32_bf16 v[112:115], a[20:23], v[200:203], v[112:115]
    v_mfma_f32_16x16x32_bf16 v[116:119], a[12:15], v[204:207], v[116:119]
    v_mfma_f32_16x16x32_bf16 v[120:123], a[16:19], v[204:207], v[120:123]
    v_mfma_f32_16x16x32_bf16 v[124:127], a[20:23], v[204:207], v[124:127]
    s_waitcnt vmcnt(11)
    s_waitcnt lgkmcnt(0)
    v_mfma_f32_16x16x32_bf16 v[80:83], a[24:27], v[176:179], v[80:83]
    ds_read_b128 v[192:195], v7 offset:3072
    ds_read_b128 v[196:199], v7 offset:15360
    buffer_load_dwordx4 a[140:143], v7, s[24:27], s62 offen offset:3072 sc1
    v_mfma_f32_16x16x32_bf16 v[84:87], a[28:31], v[176:179], v[84:87]
    s_barrier
    s_cmp_lg_u32 s40, 0
    s_cbranch_scc1 Lsg_interleave_layers__ssm_conv_h3__swiglu_ffn__prompt_kernel_49
    s_lshl_b32 s3, s45, 8
    s_add_u32 s3, s3, 13828096
    s_mov_b64 exec, 1
    buffer_store_dwordx2 v[2:3], off, s[24:27], s3 sc1
    s_mov_b64 exec, -1
Lsg_interleave_layers__ssm_conv_h3__swiglu_ffn__prompt_kernel_49:
    v_mfma_f32_16x16x32_bf16 v[88:91], a[32:35], v[176:179], v[88:91]
    ds_read_b128 v[200:203], v7 offset:27648
    ds_read_b128 v[204:207], v7 offset:39936
    v_mfma_f32_16x16x32_bf16 v[92:95], a[24:27], v[180:183], v[92:95]
    s_lshl_b32 s31, s37, 12
    s_add_u32 s31, s31, 36700160
    buffer_load_dwordx4 v[56:59], v19, s[24:27], s31 offen offset:0 sc1
    buffer_load_dwordx4 v[60:63], v19, s[24:27], s31 offen offset:256 sc1
    buffer_load_dwordx4 v[64:67], v19, s[24:27], s31 offen offset:512 sc1
    buffer_load_dwordx4 v[68:71], v19, s[24:27], s31 offen offset:768 sc1
    v_mfma_f32_16x16x32_bf16 v[96:99], a[28:31], v[180:183], v[96:99]
    v_mfma_f32_16x16x32_bf16 v[100:103], a[32:35], v[180:183], v[100:103]
    s_add_u32 s62, s46, 36864
    buffer_load_dwordx4 a[144:147], v7, s[24:27], s62 offen offset:0 sc1
    v_mfma_f32_16x16x32_bf16 v[104:107], a[24:27], v[184:187], v[104:107]
    v_mfma_f32_16x16x32_bf16 v[108:111], a[28:31], v[184:187], v[108:111]
    v_mfma_f32_16x16x32_bf16 v[112:115], a[32:35], v[184:187], v[112:115]
    v_mfma_f32_16x16x32_bf16 v[116:119], a[24:27], v[188:191], v[116:119]
    v_mfma_f32_16x16x32_bf16 v[120:123], a[28:31], v[188:191], v[120:123]
    buffer_load_dwordx4 a[148:151], v7, s[24:27], s62 offen offset:1024 sc1
    v_mfma_f32_16x16x32_bf16 v[124:127], a[32:35], v[188:191], v[124:127]
    s_waitcnt lgkmcnt(0)
    s_barrier
    v_mfma_f32_16x16x32_bf16 v[80:83], a[36:39], v[192:195], v[80:83]
    ds_read_b128 v[176:179], v7 offset:4096
    ds_read_b128 v[180:183], v7 offset:16384
    v_mfma_f32_16x16x32_bf16 v[84:87], a[40:43], v[192:195], v[84:87]
    v_mfma_f32_16x16x32_bf16 v[88:91], a[44:47], v[192:195], v[88:91]
    ds_read_b128 v[184:187], v7 offset:28672
    ds_read_b128 v[188:191], v7 offset:40960
    v_mfma_f32_16x16x32_bf16 v[92:95], a[36:39], v[196:199], v[92:95]
    s_add_u32 m0, s49, 0
    s_add_u32 s38, s48, 19935232
    buffer_load_dwordx4 v7, s[24:27], s38 offen offset:0 sc1 lds
    v_mfma_f32_16x16x32_bf16 v[96:99], a[40:43], v[196:199], v[96:99]
    v_mfma_f32_16x16x32_bf16 v[100:103], a[44:47], v[196:199], v[100:103]
    v_mfma_f32_16x16x32_bf16 v[104:107], a[36:39], v[200:203], v[104:107]
    v_mfma_f32_16x16x32_bf16 v[108:111], a[40:43], v[200:203], v[108:111]
    v_mfma_f32_16x16x32_bf16 v[112:115], a[44:47], v[200:203], v[112:115]
    buffer_load_dwordx4 v7, s[24:27], s38 offen offset:1024 sc1 lds
    v_mfma_f32_16x16x32_bf16 v[116:119], a[36:39], v[204:207], v[116:119]
    v_mfma_f32_16x16x32_bf16 v[120:123], a[40:43], v[204:207], v[120:123]
    v_mfma_f32_16x16x32_bf16 v[124:127], a[44:47], v[204:207], v[124:127]
    s_waitcnt lgkmcnt(0)
    v_mfma_f32_16x16x32_bf16 v[80:83], a[48:51], v[176:179], v[80:83]
    ds_read_b128 v[192:195], v7 offset:5120
    ds_read_b128 v[196:199], v7 offset:17408
    v_mfma_f32_16x16x32_bf16 v[84:87], a[52:55], v[176:179], v[84:87]
    buffer_load_dwordx4 v7, s[24:27], s38 offen offset:2048 sc1 lds
    v_mfma_f32_16x16x32_bf16 v[88:91], a[56:59], v[176:179], v[88:91]
    ds_read_b128 v[200:203], v7 offset:29696
    ds_read_b128 v[204:207], v7 offset:41984
    v_mfma_f32_16x16x32_bf16 v[92:95], a[48:51], v[180:183], v[92:95]
    v_mfma_f32_16x16x32_bf16 v[96:99], a[52:55], v[180:183], v[96:99]
    v_mfma_f32_16x16x32_bf16 v[100:103], a[56:59], v[180:183], v[100:103]
    v_mfma_f32_16x16x32_bf16 v[104:107], a[48:51], v[184:187], v[104:107]
    buffer_load_dwordx4 v7, s[24:27], s38 offen offset:3072 sc1 lds
    v_mfma_f32_16x16x32_bf16 v[108:111], a[52:55], v[184:187], v[108:111]
    v_mfma_f32_16x16x32_bf16 v[112:115], a[56:59], v[184:187], v[112:115]
    v_mfma_f32_16x16x32_bf16 v[116:119], a[48:51], v[188:191], v[116:119]
    v_mfma_f32_16x16x32_bf16 v[120:123], a[52:55], v[188:191], v[120:123]
    v_mfma_f32_16x16x32_bf16 v[124:127], a[56:59], v[188:191], v[124:127]
    buffer_load_dwordx4 a[152:155], v7, s[24:27], s62 offen offset:2048 sc1
    s_waitcnt lgkmcnt(0)
    v_mfma_f32_16x16x32_bf16 v[80:83], a[60:63], v[192:195], v[80:83]
    ds_read_b128 v[176:179], v7 offset:6144
    ds_read_b128 v[180:183], v7 offset:18432
    v_mfma_f32_16x16x32_bf16 v[84:87], a[64:67], v[192:195], v[84:87]
    v_mfma_f32_16x16x32_bf16 v[88:91], a[68:71], v[192:195], v[88:91]
    ds_read_b128 v[184:187], v7 offset:30720
    ds_read_b128 v[188:191], v7 offset:43008
    v_mfma_f32_16x16x32_bf16 v[92:95], a[60:63], v[196:199], v[92:95]
    v_mfma_f32_16x16x32_bf16 v[96:99], a[64:67], v[196:199], v[96:99]
    buffer_load_dwordx4 a[156:159], v7, s[24:27], s62 offen offset:3072 sc1
    v_mfma_f32_16x16x32_bf16 v[100:103], a[68:71], v[196:199], v[100:103]
    v_mfma_f32_16x16x32_bf16 v[104:107], a[60:63], v[200:203], v[104:107]
    v_mfma_f32_16x16x32_bf16 v[108:111], a[64:67], v[200:203], v[108:111]
    v_mfma_f32_16x16x32_bf16 v[112:115], a[68:71], v[200:203], v[112:115]
    v_mfma_f32_16x16x32_bf16 v[116:119], a[60:63], v[204:207], v[116:119]
    s_add_u32 s62, s46, 40960
    buffer_load_dwordx4 a[160:163], v7, s[24:27], s62 offen offset:0 sc1
    v_mfma_f32_16x16x32_bf16 v[120:123], a[64:67], v[204:207], v[120:123]
    v_mfma_f32_16x16x32_bf16 v[124:127], a[68:71], v[204:207], v[124:127]
    s_waitcnt lgkmcnt(0)
    v_mfma_f32_16x16x32_bf16 v[80:83], a[72:75], v[176:179], v[80:83]
    ds_read_b128 v[192:195], v7 offset:7168
    ds_read_b128 v[196:199], v7 offset:19456
    v_mfma_f32_16x16x32_bf16 v[84:87], a[76:79], v[176:179], v[84:87]
    v_mfma_f32_16x16x32_bf16 v[88:91], a[80:83], v[176:179], v[88:91]
    ds_read_b128 v[200:203], v7 offset:31744
    ds_read_b128 v[204:207], v7 offset:44032
    buffer_load_dwordx4 a[164:167], v7, s[24:27], s62 offen offset:1024 sc1
    v_mfma_f32_16x16x32_bf16 v[92:95], a[72:75], v[180:183], v[92:95]
    v_mfma_f32_16x16x32_bf16 v[96:99], a[76:79], v[180:183], v[96:99]
    s_lshl_b32 s33, s41, 1
    s_add_u32 s33, s33, s54
    s_lshl_b32 s33, s33, 11
    s_add_u32 s33, s33, 13828096
    s_mov_b64 exec, 0xff
    buffer_load_dwordx2 v[10:11], v9, s[24:27], s33 offen sc1
    s_mov_b64 exec, -1
    v_mfma_f32_16x16x32_bf16 v[100:103], a[80:83], v[180:183], v[100:103]
    v_mfma_f32_16x16x32_bf16 v[104:107], a[72:75], v[184:187], v[104:107]
    v_mfma_f32_16x16x32_bf16 v[108:111], a[76:79], v[184:187], v[108:111]
    buffer_load_dwordx4 a[168:171], v7, s[24:27], s62 offen offset:2048 sc1
    v_mfma_f32_16x16x32_bf16 v[112:115], a[80:83], v[184:187], v[112:115]
    v_mfma_f32_16x16x32_bf16 v[116:119], a[72:75], v[188:191], v[116:119]
    s_waitcnt vmcnt(12)
    s_branch Lso_interleave_layers__ssm_conv_h3__swiglu_ffn__prompt_kernel_51
Lst_interleave_layers__ssm_conv_h3__swiglu_ffn__prompt_kernel_50:
    s_sleep 1
    buffer_load_dwordx4 v[56:59], v19, s[24:27], s31 offen offset:0 sc1
    buffer_load_dwordx4 v[60:63], v19, s[24:27], s31 offen offset:256 sc1
    buffer_load_dwordx4 v[64:67], v19, s[24:27], s31 offen offset:512 sc1
    buffer_load_dwordx4 v[68:71], v19, s[24:27], s31 offen offset:768 sc1
    s_waitcnt vmcnt(0)
    s_sub_u32 s58, s58, 1
    s_cbranch_scc1 Lk2_end
Lso_interleave_layers__ssm_conv_h3__swiglu_ffn__prompt_kernel_51:
    v_cmp_ne_u64 s[68:69], v[2:3], v[58:59]
    v_cmp_ne_u64 s[70:71], v[2:3], v[62:63]
    v_cmp_ne_u64 s[72:73], v[2:3], v[66:67]
    v_cmp_ne_u64 vcc, v[2:3], v[70:71]
    s_or_b64 s[68:69], s[68:69], s[70:71]
    s_or_b64 vcc, vcc, s[72:73]
    s_or_b64 vcc, vcc, s[68:69]
    s_cbranch_vccnz Lst_interleave_layers__ssm_conv_h3__swiglu_ffn__prompt_kernel_50
    v_mfma_f32_16x16x32_bf16 v[120:123], a[76:79], v[188:191], v[120:123]
    v_add_f32 v56, v56, v60
    v_add_f32 v57, v57, v61
    v_mfma_f32_16x16x32_bf16 v[124:127], a[80:83], v[188:191], v[124:127]
    v_add_f32 v64, v64, v68
    s_waitcnt lgkmcnt(0)
    s_barrier
    v_mfma_f32_16x16x32_bf16 v[80:83], a[84:87], v[192:195], v[80:83]
    ds_read_b128 v[176:179], v7 offset:8192
    ds_read_b128 v[180:183], v7 offset:20480
    s_add_u32 m0, s49, 4096
    s_add_u32 s38, s48, 19939328
    buffer_load_dwordx4 v7, s[24:27], s38 offen offset:0 sc1 lds
    v_mfma_f32_16x16x32_bf16 v[84:87], a[88:91], v[192:195], v[84:87]
    v_add_f32 v65, v65, v69
    v_add_f32 v72, v56, v64
    v_mfma_f32_16x16x32_bf16 v[88:91], a[92:95], v[192:195], v[88:91]
    ds_read_b128 v[184:187], v7 offset:32768
    ds_read_b128 v[188:191], v7 offset:45056
    v_mfma_f32_16x16x32_bf16 v[92:95], a[84:87], v[196:199], v[92:95]
    v_add_f32 v73, v57, v65
    v_mov_b32 v74, v72
    v_mfma_f32_16x16x32_bf16 v[96:99], a[88:91], v[196:199], v[96:99]
    v_mov_b32 v75, v73
    v_permlane16_swap_b32 v72, v74
    v_mfma_f32_16x16x32_bf16 v[100:103], a[92:95], v[196:199], v[100:103]
    buffer_load_dwordx4 v7, s[24:27], s38 offen offset:1024 sc1 lds
    v_permlane16_swap_b32 v73, v75
    v_mfma_f32_16x16x32_bf16 v[104:107], a[84:87], v[200:203], v[104:107]
    v_add_f32 v72, v72, v74
    v_add_f32 v73, v73, v75
    v_mfma_f32_16x16x32_bf16 v[108:111], a[88:91], v[200:203], v[108:111]
    v_mov_b32 v74, v72
    v_mov_b32 v75, v73
    v_mfma_f32_16x16x32_bf16 v[112:115], a[92:95], v[200:203], v[112:115]
    v_permlane32_swap_b32 v72, v74
    v_permlane32_swap_b32 v73, v75
    v_mfma_f32_16x16x32_bf16 v[116:119], a[84:87], v[204:207], v[116:119]
    v_add_f32 v72, v72, v74
    v_add_f32 v73, v73, v75
    v_mfma_f32_16x16x32_bf16 v[120:123], a[88:91], v[204:207], v[120:123]
    buffer_load_dwordx4 v7, s[24:27], s38 offen offset:2048 sc1 lds
    v_mul_f32 v72, 0x3acccccd, v72
    v_mfma_f32_16x16x32_bf16 v[124:127], a[92:95], v[204:207], v[124:127]
    v_mul_f32 v73, 0x3acccccd, v73
    s_waitcnt lgkmcnt(0)
    v_mfma_f32_16x16x32_bf16 v[80:83], a[96:99], v[176:179], v[80:83]
    ds_read_b128 v[192:195], v7 offset:9216
    ds_read_b128 v[196:199], v7 offset:21504
    v_mfma_f32_16x16x32_bf16 v[84:87], a[100:103], v[176:179], v[84:87]
    v_fma_f32 v73, -v72, v72, v73
    v_max_f32 v73, 0, v73
    v_mfma_f32_16x16x32_bf16 v[88:91], a[104:107], v[176:179], v[88:91]
    ds_read_b128 v[200:203], v7 offset:33792
    ds_read_b128 v[204:207], v7 offset:46080
    v_mfma_f32_16x16x32_bf16 v[92:95], a[96:99], v[180:183], v[92:95]
    buffer_load_dwordx4 v7, s[24:27], s38 offen offset:3072 sc1 lds
    v_cvt_pk_bf16_f32 v74, v72, v73
    v_mfma_f32_16x16x32_bf16 v[96:99], a[100:103], v[180:183], v[96:99]
    v_lshlrev_b32 v72, 16, v74
    v_and_b32 v73, 0xffff0000, v74
    v_mfma_f32_16x16x32_bf16 v[100:103], a[104:107], v[180:183], v[100:103]
    v_add_f32 v73, 0x3727c5ac, v73
    v_cvt_pk_bf16_f32 v74, v73, v73
    v_mfma_f32_16x16x32_bf16 v[104:107], a[96:99], v[184:187], v[104:107]
    v_lshlrev_b32 v73, 16, v74
    v_mfma_f32_16x16x32_bf16 v[108:111], a[100:103], v[184:187], v[108:111]
    v_sqrt_f32 v73, v73
    v_mfma_f32_16x16x32_bf16 v[112:115], a[104:107], v[184:187], v[112:115]
    buffer_load_dwordx4 a[172:175], v7, s[24:27], s62 offen offset:3072 sc1
    v_cvt_pk_bf16_f32 v74, v73, v73
    v_mfma_f32_16x16x32_bf16 v[116:119], a[96:99], v[188:191], v[116:119]
    v_lshlrev_b32 v73, 16, v74
    v_mfma_f32_16x16x32_bf16 v[120:123], a[100:103], v[188:191], v[120:123]
    v_rcp_f32 v73, v73
    v_mfma_f32_16x16x32_bf16 v[124:127], a[104:107], v[188:191], v[124:127]
    v_bfe_u32 v75, v7, 1, 7
    s_waitcnt lgkmcnt(0)
    v_mfma_f32_16x16x32_bf16 v[80:83], a[108:111], v[192:195], v[80:83]
    ds_read_b128 v[176:179], v7 offset:10240
    ds_read_b128 v[180:183], v7 offset:22528
    v_mfma_f32_16x16x32_bf16 v[84:87], a[112:115], v[192:195], v[84:87]
    s_add_u32 s62, s46, 45056
    buffer_load_dwordx4 a[176:179], v7, s[24:27], s62 offen offset:0 sc1
    v_mfma_f32_16x16x32_bf16 v[88:91], a[116:119], v[192:195], v[88:91]
    ds_read_b128 v[184:187], v7 offset:34816
    ds_read_b128 v[188:191], v7 offset:47104
    v_mfma_f32_16x16x32_bf16 v[92:95], a[108:111], v[196:199], v[92:95]
    s_lshl_b32 s7, s40, 7
    v_add_u32 v75, 159744, v75
    v_mfma_f32_16x16x32_bf16 v[96:99], a[112:115], v[196:199], v[96:99]
    v_add_u32 v74, s7, v75
    ds_write_b64 v74, v[72:73]
    v_mfma_f32_16x16x32_bf16 v[100:103], a[116:119], v[196:199], v[100:103]
    v_mfma_f32_16x16x32_bf16 v[104:107], a[108:111], v[200:203], v[104:107]
    buffer_load_dwordx4 a[180:183], v7, s[24:27], s62 offen offset:1024 sc1
    v_mfma_f32_16x16x32_bf16 v[108:111], a[112:115], v[200:203], v[108:111]
    s_waitcnt vmcnt(8)
    s_mov_b64 exec, 0xff
    s_branch Lpo_interleave_layers__ssm_conv_h3__swiglu_ffn__prompt_kernel_53
Lpr_interleave_layers__ssm_conv_h3__swiglu_ffn__prompt_kernel_52:
    s_sleep 2
    buffer_load_dwordx2 v[10:11], v9, s[24:27], s33 offen sc1
    s_waitcnt vmcnt(0)
    s_sub_u32 s58, s58, 1
    s_cbranch_scc1 Lk2_end
Lpo_interleave_layers__ssm_conv_h3__swiglu_ffn__prompt_kernel_53:
    v_cmp_ne_u64 vcc, v[2:3], v[10:11]
    s_cbranch_vccnz Lpr_interleave_layers__ssm_conv_h3__swiglu_ffn__prompt_kernel_52
    s_mov_b64 exec, -1
    buffer_load_dwordx4 a[184:187], v7, s[24:27], s62 offen offset:2048 sc1
    buffer_load_dwordx4 a[188:191], v7, s[24:27], s62 offen offset:3072 sc1
    s_add_u32 s62, s46, 49152
    buffer_load_dwordx4 a[192:195], v7, s[24:27], s62 offen offset:0 sc1
    buffer_load_dwordx4 a[196:199], v7, s[24:27], s62 offen offset:1024 sc1
    v_mfma_f32_16x16x32_bf16 v[112:115], a[116:119], v[200:203], v[112:115]
    s_waitcnt lgkmcnt(0)
    s_barrier
    v_mfma_f32_16x16x32_bf16 v[116:119], a[108:111], v[204:207], v[116:119]
    ds_read_b64 v[56:57], v75 offset:0
    ds_read_b64 v[58:59], v75 offset:128
    v_mfma_f32_16x16x32_bf16 v[120:123], a[112:115], v[204:207], v[120:123]
    ds_read_b64 v[60:61], v75 offset:256
    ds_read_b64 v[62:63], v75 offset:384
    v_mfma_f32_16x16x32_bf16 v[124:127], a[116:119], v[204:207], v[124:127]
    v_mfma_f32_16x16x32_bf16 v[80:83], a[120:123], v[176:179], v[80:83]
    ds_read_b128 v[192:195], v7 offset:11264
    ds_read_b128 v[196:199], v7 offset:23552
    buffer_load_dwordx4 a[200:203], v7, s[24:27], s62 offen offset:2048 sc1
    v_mfma_f32_16x16x32_bf16 v[84:87], a[124:127], v[176:179], v[84:87]
    v_mfma_f32_16x16x32_bf16 v[88:91], a[128:131], v[176:179], v[88:91]
    ds_read_b128 v[200:203], v7 offset:35840
    ds_read_b128 v[204:207], v7 offset:48128
    v_mfma_f32_16x16x32_bf16 v[92:95], a[120:123], v[180:183], v[92:95]
    v_mfma_f32_16x16x32_bf16 v[96:99], a[124:127], v[180:183], v[96:99]
    s_waitcnt lgkmcnt(4)
    v_sub_f32 v44, 0, v56
    v_mfma_f32_16x16x32_bf16 v[100:103], a[128:131], v[180:183], v[100:103]
    buffer_load_dwordx4 a[204:207], v7, s[24:27], s62 offen offset:3072 sc1
    v_mul_f32 v45, 0xbfb8aa3b, v57
    v_mfma_f32_16x16x32_bf16 v[104:107], a[120:123], v[184:187], v[104:107]
    v_mul_f32 v46, v57, v57
    v_mfma_f32_16x16x32_bf16 v[108:111], a[124:127], v[184:187], v[108:111]
    v_rcp_f32 v46, v46
    v_mfma_f32_16x16x32_bf16 v[112:115], a[128:131], v[184:187], v[112:115]
    v_sub_f32 v47, 0, v58
    v_mul_f32 v48, 0xbfb8aa3b, v59
    v_mfma_f32_16x16x32_bf16 v[116:119], a[120:123], v[188:191], v[116:119]
    v_mul_f32 v49, v59, v59
    v_mfma_f32_16x16x32_bf16 v[120:123], a[124:127], v[188:191], v[120:123]
    s_add_u32 s62, s46, 53248
    buffer_load_dwordx4 a[208:211], v7, s[24:27], s62 offen offset:0 sc1
    v_mfma_f32_16x16x32_bf16 v[124:127], a[128:131], v[188:191], v[124:127]
    s_waitcnt lgkmcnt(0)
    s_barrier
    v_mfma_f32_16x16x32_bf16 v[80:83], a[132:135], v[192:195], v[80:83]
    ds_read_b128 v[176:179], v7 offset:0
    ds_read_b128 v[180:183], v7 offset:12288
    v_mfma_f32_16x16x32_bf16 v[84:87], a[136:139], v[192:195], v[84:87]
    v_rcp_f32 v49, v49
    v_mfma_f32_16x16x32_bf16 v[88:91], a[140:143], v[192:195], v[88:91]
    ds_read_b128 v[184:187], v7 offset:24576
    ds_read_b128 v[188:191], v7 offset:36864
    v_mfma_f32_16x16x32_bf16 v[92:95], a[132:135], v[196:199], v[92:95]
    s_add_u32 m0, s49, 8192
    s_add_u32 s38, s48, 20013056
    buffer_load_dwordx4 v7, s[24:27], s38 offen offset:0 sc1 lds
    v_mfma_f32_16x16x32_bf16 v[96:99], a[136:139], v[196:199], v[96:99]
    v_sub_f32 v50, 0, v60
    v_mul_f32 v51, 0xbfb8aa3b, v61
    v_mfma_f32_16x16x32_bf16 v[100:103], a[140:143], v[196:199], v[100:103]
    v_mul_f32 v52, v61, v61
    v_mfma_f32_16x16x32_bf16 v[104:107], a[132:135], v[200:203], v[104:107]
    v_rcp_f32 v52, v52
    v_mfma_f32_16x16x32_bf16 v[108:111], a[136:139], v[200:203], v[108:111]
    v_sub_f32 v53, 0, v62
    v_mul_f32 v54, 0xbfb8aa3b, v63
    v_mfma_f32_16x16x32_bf16 v[112:115], a[140:143], v[200:203], v[112:115]
    buffer_load_dwordx4 v7, s[24:27], s38 offen offset:1024 sc1 lds
    v_mul_f32 v55, v63, v63
    v_mfma_f32_16x16x32_bf16 v[116:119], a[132:135], v[204:207], v[116:119]
    v_rcp_f32 v55, v55
    v_mfma_f32_16x16x32_bf16 v[120:123], a[136:139], v[204:207], v[120:123]
    v_mfma_f32_16x16x32_bf16 v[124:127], a[140:143], v[204:207], v[124:127]
    s_waitcnt lgkmcnt(0)
    v_mfma_f32_16x16x32_bf16 v[80:83], a[144:147], v[176:179], v[80:83]
    ds_read_b128 v[192:195], v7 offset:1024
    ds_read_b128 v[196:199], v7 offset:13312
    v_mfma_f32_16x16x32_bf16 v[84:87], a[148:151], v[176:179], v[84:87]
    buffer_load_dwordx4 v7, s[24:27], s38 offen offset:2048 sc1 lds
    v_mfma_f32_16x16x32_bf16 v[88:91], a[152:155], v[176:179], v[88:91]
    ds_read_b128 v[200:203], v7 offset:25600
    ds_read_b128 v[204:207], v7 offset:37888
    v_mfma_f32_16x16x32_bf16 v[92:95], a[144:147], v[180:183], v[92:95]
    v_mfma_f32_16x16x32_bf16 v[96:99], a[148:151], v[180:183], v[96:99]
    v_mfma_f32_16x16x32_bf16 v[100:103], a[152:155], v[180:183], v[100:103]
    v_mfma_f32_16x16x32_bf16 v[104:107], a[144:147], v[184:187], v[104:107]
    buffer_load_dwordx4 v7, s[24:27], s38 offen offset:3072 sc1 lds
    v_mfma_f32_16x16x32_bf16 v[108:111], a[148:151], v[184:187], v[108:111]
    v_mfma_f32_16x16x32_bf16 v[112:115], a[152:155], v[184:187], v[112:115]
    v_mfma_f32_16x16x32_bf16 v[116:119], a[144:147], v[188:191], v[116:119]
    v_mfma_f32_16x16x32_bf16 v[120:123], a[148:151], v[188:191], v[120:123]
    v_mfma_f32_16x16x32_bf16 v[124:127], a[152:155], v[188:191], v[124:127]
    buffer_load_dwordx4 a[212:215], v7, s[24:27], s62 offen offset:1024 sc1
    s_waitcnt lgkmcnt(0)
    v_mfma_f32_16x16x32_bf16 v[80:83], a[156:159], v[192:195], v[80:83]
    ds_read_b128 v[176:179], v7 offset:2048
    ds_read_b128 v[180:183], v7 offset:14336
    v_mfma_f32_16x16x32_bf16 v[84:87], a[160:163], v[192:195], v[84:87]
    v_mfma_f32_16x16x32_bf16 v[88:91], a[164:167], v[192:195], v[88:91]
    ds_read_b128 v[184:187], v7 offset:26624
    ds_read_b128 v[188:191], v7 offset:38912
    v_mfma_f32_16x16x32_bf16 v[92:95], a[156:159], v[196:199], v[92:95]
    v_mfma_f32_16x16x32_bf16 v[96:99], a[160:163], v[196:199], v[96:99]
    buffer_load_dwordx4 a[216:219], v7, s[24:27], s62 offen offset:2048 sc1
    v_mfma_f32_16x16x32_bf16 v[100:103], a[164:167], v[196:199], v[100:103]
    v_mfma_f32_16x16x32_bf16 v[104:107], a[156:159], v[200:203], v[104:107]
    v_mfma_f32_16x16x32_bf16 v[108:111], a[160:163], v[200:203], v[108:111]
    v_mfma_f32_16x16x32_bf16 v[112:115], a[164:167], v[200:203], v[112:115]
    v_mfma_f32_16x16x32_bf16 v[116:119], a[156:159], v[204:207], v[116:119]
    buffer_load_dwordx4 a[220:223], v7, s[24:27], s62 offen offset:3072 sc1
    v_mfma_f32_16x16x32_bf16 v[120:123], a[160:163], v[204:207], v[120:123]
    v_mfma_f32_16x16x32_bf16 v[124:127], a[164:167], v[204:207], v[124:127]
    s_waitcnt vmcnt(15)
    s_waitcnt lgkmcnt(0)
    v_mfma_f32_16x16x32_bf16 v[80:83], a[168:171], v[176:179], v[80:83]
    ds_read_b128 v[192:195], v7 offset:3072
    ds_read_b128 v[196:199], v7 offset:15360
    v_mfma_f32_16x16x32_bf16 v[84:87], a[172:175], v[176:179], v[84:87]
    v_mfma_f32_16x16x32_bf16 v[88:91], a[176:179], v[176:179], v[88:91]
    ds_read_b128 v[200:203], v7 offset:27648
    ds_read_b128 v[204:207], v7 offset:39936
    s_add_u32 s62, s46, 57344
    buffer_load_dwordx4 a[224:227], v7, s[24:27], s62 offen offset:0 sc1
    v_mfma_f32_16x16x32_bf16 v[92:95], a[168:171], v[180:183], v[92:95]
    v_mfma_f32_16x16x32_bf16 v[96:99], a[172:175], v[180:183], v[96:99]
    v_mfma_f32_16x16x32_bf16 v[100:103], a[176:179], v[180:183], v[100:103]
    v_mfma_f32_16x16x32_bf16 v[104:107], a[168:171], v[184:187], v[104:107]
    v_mfma_f32_16x16x32_bf16 v[108:111], a[172:175], v[184:187], v[108:111]
    buffer_load_dwordx4 a[228:231], v7, s[24:27], s62 offen offset:1024 sc1
    v_mfma_f32_16x16x32_bf16 v[112:115], a[176:179], v[184:187], v[112:115]
    v_mfma_f32_16x16x32_bf16 v[116:119], a[168:171], v[188:191], v[116:119]
    v_mfma_f32_16x16x32_bf16 v[120:123], a[172:175], v[188:191], v[120:123]
    v_mfma_f32_16x16x32_bf16 v[124:127], a[176:179], v[188:191], v[124:127]
    s_waitcnt vmcnt(14)
    s_waitcnt lgkmcnt(0)
    s_barrier
    v_mfma_f32_16x16x32_bf16 v[80:83], a[180:183], v[192:195], v[80:83]
    ds_read_b128 v[176:179], v7 offset:4096
    ds_read_b128 v[180:183], v7 offset:16384
    buffer_load_dwordx4 a[232:235], v7, s[24:27], s62 offen offset:2048 sc1
    v_mfma_f32_16x16x32_bf16 v[84:87], a[184:187], v[192:195], v[84:87]
    v_mfma_f32_16x16x32_bf16 v[88:91], a[188:191], v[192:195], v[88:91]
    ds_read_b128 v[184:187], v7 offset:28672
    ds_read_b128 v[188:191], v7 offset:40960
    v_mfma_f32_16x16x32_bf16 v[92:95], a[180:183], v[196:199], v[92:95]
    v_mfma_f32_16x16x32_bf16 v[96:99], a[184:187], v[196:199], v[96:99]
    v_mfma_f32_16x16x32_bf16 v[100:103], a[188:191], v[196:199], v[100:103]
    buffer_load_dwordx4 a[236:239], v7, s[24:27], s62 offen offset:3072 sc1
    v_mfma_f32_16x16x32_bf16 v[104:107], a[180:183], v[200:203], v[104:107]
    v_mfma_f32_16x16x32_bf16 v[108:111], a[184:187], v[200:203], v[108:111]
    v_mfma_f32_16x16x32_bf16 v[112:115], a[188:191], v[200:203], v[112:115]
    v_mfma_f32_16x16x32_bf16 v[116:119], a[180:183], v[204:207], v[116:119]
    v_mfma_f32_16x16x32_bf16 v[120:123], a[184:187], v[204:207], v[120:123]
    s_add_u32 m0, s49, 0
    s_add_u32 s38, s48, 20017152
    buffer_load_dwordx4 v7, s[24:27], s38 offen offset:0 sc1 lds
    v_mfma_f32_16x16x32_bf16 v[124:127], a[188:191], v[204:207], v[124:127]
    s_waitcnt vmcnt(14)
    s_waitcnt lgkmcnt(0)
    v_mfma_f32_16x16x32_bf16 v[80:83], a[192:195], v[176:179], v[80:83]
    ds_read_b128 v[192:195], v7 offset:5120
    ds_read_b128 v[196:199], v7 offset:17408
    v_mfma_f32_16x16x32_bf16 v[84:87], a[196:199], v[176:179], v[84:87]
    v_mfma_f32_16x16x32_bf16 v[88:91], a[200:203], v[176:179], v[88:91]
    ds_read_b128 v[200:203], v7 offset:29696
    ds_read_b128 v[204:207], v7 offset:41984
    v_mfma_f32_16x16x32_bf16 v[92:95], a[192:195], v[180:183], v[92:95]
    buffer_load_dwordx4 v7, s[24:27], s38 offen offset:1024 sc1 lds
    v_mfma_f32_16x16x32_bf16 v[96:99], a[196:199], v[180:183], v[96:99]
    v_mfma_f32_16x16x32_bf16 v[100:103], a[200:203], v[180:183], v[100:103]
    v_mfma_f32_16x16x32_bf16 v[104:107], a[192:195], v[184:187], v[104:107]
    v_mfma_f32_16x16x32_bf16 v[108:111], a[196:199], v[184:187], v[108:111]
    v_mfma_f32_16x16x32_bf16 v[112:115], a[200:203], v[184:187], v[112:115]
    buffer_load_dwordx4 v7, s[24:27], s38 offen offset:2048 sc1 lds
    v_mfma_f32_16x16x32_bf16 v[116:119], a[192:195], v[188:191], v[116:119]
    v_mfma_f32_16x16x32_bf16 v[120:123], a[196:199], v[188:191], v[120:123]
    v_mfma_f32_16x16x32_bf16 v[124:127], a[200:203], v[188:191], v[124:127]
    s_waitcnt vmcnt(9)
    s_waitcnt lgkmcnt(0)
    v_mfma_f32_16x16x32_bf16 v[80:83], a[204:207], v[192:195], v[80:83]
    ds_read_b128 v[176:179], v7 offset:6144
    ds_read_b128 v[180:183], v7 offset:18432
    v_mfma_f32_16x16x32_bf16 v[84:87], a[208:211], v[192:195], v[84:87]
    buffer_load_dwordx4 v7, s[24:27], s38 offen offset:3072 sc1 lds
    v_mfma_f32_16x16x32_bf16 v[88:91], a[212:215], v[192:195], v[88:91]
    ds_read_b128 v[184:187], v7 offset:30720
    ds_read_b128 v[188:191], v7 offset:43008
    v_mfma_f32_16x16x32_bf16 v[92:95], a[204:207], v[196:199], v[92:95]
    v_mfma_f32_16x16x32_bf16 v[96:99], a[208:211], v[196:199], v[96:99]
    v_mfma_f32_16x16x32_bf16 v[100:103], a[212:215], v[196:199], v[100:103]
    v_mfma_f32_16x16x32_bf16 v[104:107], a[204:207], v[200:203], v[104:107]
    v_mfma_f32_16x16x32_bf16 v[108:111], a[208:211], v[200:203], v[108:111]
    v_mfma_f32_16x16x32_bf16 v[112:115], a[212:215], v[200:203], v[112:115]
    v_mfma_f32_16x16x32_bf16 v[116:119], a[204:207], v[204:207], v[116:119]
    v_mfma_f32_16x16x32_bf16 v[120:123], a[208:211], v[204:207], v[120:123]
    v_mfma_f32_16x16x32_bf16 v[124:127], a[212:215], v[204:207], v[124:127]
    s_waitcnt vmcnt(7)
    s_waitcnt lgkmcnt(0)
    v_mfma_f32_16x16x32_bf16 v[80:83], a[216:219], v[176:179], v[80:83]
    ds_read_b128 v[192:195], v7 offset:7168
    ds_read_b128 v[196:199], v7 offset:19456
    v_mfma_f32_16x16x32_bf16 v[84:87], a[220:223], v[176:179], v[84:87]
    v_mfma_f32_16x16x32_bf16 v[88:91], a[224:227], v[176:179], v[88:91]
    ds_read_b128 v[200:203], v7 offset:31744
    ds_read_b128 v[204:207], v7 offset:44032
    v_mfma_f32_16x16x32_bf16 v[92:95], a[216:219], v[180:183], v[92:95]
    v_mfma_f32_16x16x32_bf16 v[96:99], a[220:223], v[180:183], v[96:99]
    v_mfma_f32_16x16x32_bf16 v[100:103], a[224:227], v[180:183], v[100:103]
    v_mfma_f32_16x16x32_bf16 v[104:107], a[216:219], v[184:187], v[104:107]
    v_mfma_f32_16x16x32_bf16 v[108:111], a[220:223], v[184:187], v[108:111]
    v_mfma_f32_16x16x32_bf16 v[112:115], a[224:227], v[184:187], v[112:115]
    v_mfma_f32_16x16x32_bf16 v[116:119], a[216:219], v[188:191], v[116:119]
    v_mfma_f32_16x16x32_bf16 v[120:123], a[220:223], v[188:191], v[120:123]
    v_mfma_f32_16x16x32_bf16 v[124:127], a[224:227], v[188:191], v[124:127]
    s_waitcnt vmcnt(4)
    s_waitcnt lgkmcnt(0)
    s_barrier
    v_mfma_f32_16x16x32_bf16 v[80:83], a[228:231], v[192:195], v[80:83]
    ds_read_b128 v[176:179], v7 offset:8192
    ds_read_b128 v[180:183], v7 offset:20480
    s_add_u32 m0, s49, 4096
    s_add_u32 s38, s48, 20021248
    buffer_load_dwordx4 v7, s[24:27], s38 offen offset:0 sc1 lds
    v_mfma_f32_16x16x32_bf16 v[84:87], a[232:235], v[192:195], v[84:87]
    v_mfma_f32_16x16x32_bf16 v[88:91], a[236:239], v[192:195], v[88:91]
    ds_read_b128 v[184:187], v7 offset:32768
    ds_read_b128 v[188:191], v7 offset:45056
    v_mfma_f32_16x16x32_bf16 v[92:95], a[228:231], v[196:199], v[92:95]
    v_mfma_f32_16x16x32_bf16 v[96:99], a[232:235], v[196:199], v[96:99]
    v_mfma_f32_16x16x32_bf16 v[100:103], a[236:239], v[196:199], v[100:103]
    buffer_load_dwordx4 v7, s[24:27], s38 offen offset:1024 sc1 lds
    v_mfma_f32_16x16x32_bf16 v[104:107], a[228:231], v[200:203], v[104:107]
    v_mfma_f32_16x16x32_bf16 v[108:111], a[232:235], v[200:203], v[108:111]
    v_mfma_f32_16x16x32_bf16 v[112:115], a[236:239], v[200:203], v[112:115]
    v_mfma_f32_16x16x32_bf16 v[116:119], a[228:231], v[204:207], v[116:119]
    v_mfma_f32_16x16x32_bf16 v[120:123], a[232:235], v[204:207], v[120:123]
    buffer_load_dwordx4 v7, s[24:27], s38 offen offset:2048 sc1 lds
    v_mfma_f32_16x16x32_bf16 v[124:127], a[236:239], v[204:207], v[124:127]
    v_pk_fma_f32 v[80:81], v[44:45], v[20:21], v[80:81] op_sel:[0,0,0] op_sel_hi:[0,1,1]
    v_pk_fma_f32 v[84:85], v[44:45], v[24:25], v[84:85] op_sel:[0,0,0] op_sel_hi:[0,1,1]
    v_pk_fma_f32 v[88:89], v[44:45], v[28:29], v[88:89] op_sel:[0,0,0] op_sel_hi:[0,1,1]
    v_pk_fma_f32 v[92:93], v[46:47], v[20:21], v[92:93] op_sel:[1,0,0] op_sel_hi:[1,1,1]
    v_pk_fma_f32 v[96:97], v[46:47], v[24:25], v[96:97] op_sel:[1,0,0] op_sel_hi:[1,1,1]
    v_pk_fma_f32 v[100:101], v[46:47], v[28:29], v[100:101] op_sel:[1,0,0] op_sel_hi:[1,1,1]
    v_pk_mul_f32 v[56:57], v[80:81], v[44:45] op_sel:[0,1] op_sel_hi:[1,1]
    v_pk_mul_f32 v[58:59], v[84:85], v[44:45] op_sel:[0,1] op_sel_hi:[1,1]
    v_pk_mul_f32 v[60:61], v[88:89], v[44:45] op_sel:[0,1] op_sel_hi:[1,1]
    v_pk_mul_f32 v[62:63], v[92:93], v[48:49] op_sel:[0,0] op_sel_hi:[1,0]
    v_pk_mul_f32 v[64:65], v[96:97], v[48:49] op_sel:[0,0] op_sel_hi:[1,0]
    v_pk_mul_f32 v[66:67], v[100:101], v[48:49] op_sel:[0,0] op_sel_hi:[1,0]
    v_pk_fma_f32 v[82:83], v[44:45], v[22:23], v[82:83] op_sel:[0,0,0] op_sel_hi:[0,1,1]
    v_pk_fma_f32 v[86:87], v[44:45], v[26:27], v[86:87] op_sel:[0,0,0] op_sel_hi:[0,1,1]
    v_pk_fma_f32 v[90:91], v[44:45], v[30:31], v[90:91] op_sel:[0,0,0] op_sel_hi:[0,1,1]
    v_pk_fma_f32 v[94:95], v[46:47], v[22:23], v[94:95] op_sel:[1,0,0] op_sel_hi:[1,1,1]
    buffer_load_dwordx4 v7, s[24:27], s38 offen offset:3072 sc1 lds
    v_pk_fma_f32 v[98:99], v[46:47], v[26:27], v[98:99] op_sel:[1,0,0] op_sel_hi:[1,1,1]
    v_pk_fma_f32 v[102:103], v[46:47], v[30:31], v[102:103] op_sel:[1,0,0] op_sel_hi:[1,1,1]
    v_exp_f32 v56, v56
    v_exp_f32 v57, v57
    v_exp_f32 v58, v58
    v_exp_f32 v59, v59
    v_exp_f32 v60, v60
    v_exp_f32 v61, v61
    v_exp_f32 v62, v62
    v_exp_f32 v63, v63
    v_exp_f32 v64, v64
    v_exp_f32 v65, v65
    v_exp_f32 v66, v66
    v_exp_f32 v67, v67
    v_pk_mul_f32 v[80:81], v[80:81], v[82:83]
    v_pk_mul_f32 v[84:85], v[84:85], v[86:87]
    v_pk_mul_f32 v[88:89], v[88:89], v[90:91]
    v_pk_mul_f32 v[92:93], v[92:93], v[94:95]
    v_pk_mul_f32 v[96:97], v[96:97], v[98:99]
    v_pk_mul_f32 v[100:101], v[100:101], v[102:103]
    v_pk_fma_f32 v[56:57], v[56:57], v[46:47], v[46:47] op_sel:[0,0,0] op_sel_hi:[1,0,0]
    v_pk_fma_f32 v[58:59], v[58:59], v[46:47], v[46:47] op_sel:[0,0,0] op_sel_hi:[1,0,0]
    v_pk_fma_f32 v[60:61], v[60:61], v[46:47], v[46:47] op_sel:[0,0,0] op_sel_hi:[1,0,0]
    v_pk_fma_f32 v[62:63], v[62:63], v[48:49], v[48:49] op_sel:[0,1,1] op_sel_hi:[1,1,1]
    v_pk_fma_f32 v[64:65], v[64:65], v[48:49], v[48:49] op_sel:[0,1,1] op_sel_hi:[1,1,1]
    v_pk_fma_f32 v[66:67], v[66:67], v[48:49], v[48:49] op_sel:[0,1,1] op_sel_hi:[1,1,1]
    v_rcp_f32 v56, v56
    v_rcp_f32 v57, v57
    v_rcp_f32 v58, v58
    v_rcp_f32 v59, v59
    v_rcp_f32 v60, v60
    v_rcp_f32 v61, v61
    v_rcp_f32 v62, v62
    v_rcp_f32 v63, v63
    v_rcp_f32 v64, v64
    v_rcp_f32 v65, v65
    v_rcp_f32 v66, v66
    v_rcp_f32 v67, v67
    v_pk_mul_f32 v[80:81], v[80:81], v[56:57]
    v_pk_mul_f32 v[84:85], v[84:85], v[58:59]
    v_pk_mul_f32 v[88:89], v[88:89], v[60:61]
    v_pk_mul_f32 v[92:93], v[92:93], v[62:63]
    v_pk_mul_f32 v[96:97], v[96:97], v[64:65]
    v_pk_mul_f32 v[100:101], v[100:101], v[66:67]
    v_cvt_pk_bf16_f32 v76, v80, v81
    v_cvt_pk_bf16_f32 v77, v84, v85
    v_cvt_pk_bf16_f32 v78, v88, v89
    v_cvt_pk_bf16_f32 v71, v88, v89
    v_cvt_pk_bf16_f32 v68, v80, v81
    v_permlane16_swap_b32 v76, v77
    v_cvt_pk_bf16_f32 v69, v84, v85
    v_permlane16_swap_b32 v78, v71
    v_cvt_pk_bf16_f32 v70, v88, v89
    s_add_u32 s6, s36, 29360128
    v_permlane32_swap_b32 v77, v71
    s_mov_b64 exec, s[64:65]
    buffer_store_dwordx4 v[68:71], v7, s[24:27], s6 offen sc1
    s_mov_b64 exec, -1
    v_cvt_pk_bf16_f32 v76, v92, v93
    v_cvt_pk_bf16_f32 v77, v96, v97
    v_cvt_pk_bf16_f32 v78, v100, v101
    v_cvt_pk_bf16_f32 v75, v100, v101
    v_cvt_pk_bf16_f32 v72, v92, v93
    v_permlane16_swap_b32 v76, v77
    v_cvt_pk_bf16_f32 v73, v96, v97
    v_permlane16_swap_b32 v78, v75
    v_cvt_pk_bf16_f32 v74, v100, v101
    s_add_u32 s6, s36, 29409280
    v_permlane32_swap_b32 v77, v75
    s_mov_b64 exec, s[64:65]
    buffer_store_dwordx4 v[72:75], v7, s[24:27], s6 offen sc1
    s_mov_b64 exec, -1
    v_pk_fma_f32 v[104:105], v[50:51], v[20:21], v[104:105] op_sel:[0,0,0] op_sel_hi:[0,1,1]
    v_pk_fma_f32 v[108:109], v[50:51], v[24:25], v[108:109] op_sel:[0,0,0] op_sel_hi:[0,1,1]
    v_pk_fma_f32 v[112:113], v[50:51], v[28:29], v[112:113] op_sel:[0,0,0] op_sel_hi:[0,1,1]
    v_pk_fma_f32 v[116:117], v[52:53], v[20:21], v[116:117] op_sel:[1,0,0] op_sel_hi:[1,1,1]
    v_pk_fma_f32 v[120:121], v[52:53], v[24:25], v[120:121] op_sel:[1,0,0] op_sel_hi:[1,1,1]
    v_pk_fma_f32 v[124:125], v[52:53], v[28:29], v[124:125] op_sel:[1,0,0] op_sel_hi:[1,1,1]
    v_pk_mul_f32 v[56:57], v[104:105], v[50:51] op_sel:[0,1] op_sel_hi:[1,1]
    v_pk_mul_f32 v[58:59], v[108:109], v[50:51] op_sel:[0,1] op_sel_hi:[1,1]
    v_pk_mul_f32 v[60:61], v[112:113], v[50:51] op_sel:[0,1] op_sel_hi:[1,1]
    v_pk_mul_f32 v[62:63], v[116:117], v[54:55] op_sel:[0,0] op_sel_hi:[1,0]
    v_pk_mul_f32 v[64:65], v[120:121], v[54:55] op_sel:[0,0] op_sel_hi:[1,0]
    v_pk_mul_f32 v[66:67], v[124:125], v[54:55] op_sel:[0,0] op_sel_hi:[1,0]
    v_pk_fma_f32 v[106:107], v[50:51], v[22:23], v[106:107] op_sel:[0,0,0] op_sel_hi:[0,1,1]
    v_pk_fma_f32 v[110:111], v[50:51], v[26:27], v[110:111] op_sel:[0,0,0] op_sel_hi:[0,1,1]
    v_pk_fma_f32 v[114:115], v[50:51], v[30:31], v[114:115] op_sel:[0,0,0] op_sel_hi:[0,1,1]
    v_pk_fma_f32 v[118:119], v[52:53], v[22:23], v[118:119] op_sel:[1,0,0] op_sel_hi:[1,1,1]
    v_pk_fma_f32 v[122:123], v[52:53], v[26:27], v[122:123] op_sel:[1,0,0] op_sel_hi:[1,1,1]
    v_pk_fma_f32 v[126:127], v[52:53], v[30:31], v[126:127] op_sel:[1,0,0] op_sel_hi:[1,1,1]
    v_exp_f32 v56, v56
    v_exp_f32 v57, v57
    v_exp_f32 v58, v58
    v_exp_f32 v59, v59
    v_exp_f32 v60, v60
    v_exp_f32 v61, v61
    v_exp_f32 v62, v62
    v_exp_f32 v63, v63
    v_exp_f32 v64, v64
    v_exp_f32 v65, v65
    v_exp_f32 v66, v66
    v_exp_f32 v67, v67
    v_pk_mul_f32 v[104:105], v[104:105], v[106:107]
    v_pk_mul_f32 v[108:109], v[108:109], v[110:111]
    v_pk_mul_f32 v[112:113], v[112:113], v[114:115]
    v_pk_mul_f32 v[116:117], v[116:117], v[118:119]
    v_pk_mul_f32 v[120:121], v[120:121], v[122:123]
    v_pk_mul_f32 v[124:125], v[124:125], v[126:127]
    v_pk_fma_f32 v[56:57], v[56:57], v[52:53], v[52:53] op_sel:[0,0,0] op_sel_hi:[1,0,0]
    v_pk_fma_f32 v[58:59], v[58:59], v[52:53], v[52:53] op_sel:[0,0,0] op_sel_hi:[1,0,0]
    v_pk_fma_f32 v[60:61], v[60:61], v[52:53], v[52:53] op_sel:[0,0,0] op_sel_hi:[1,0,0]
    v_pk_fma_f32 v[62:63], v[62:63], v[54:55], v[54:55] op_sel:[0,1,1] op_sel_hi:[1,1,1]
    v_pk_fma_f32 v[64:65], v[64:65], v[54:55], v[54:55] op_sel:[0,1,1] op_sel_hi:[1,1,1]
    v_pk_fma_f32 v[66:67], v[66:67], v[54:55], v[54:55] op_sel:[0,1,1] op_sel_hi:[1,1,1]
    v_rcp_f32 v56, v56
    v_rcp_f32 v57, v57
    v_rcp_f32 v58, v58
    v_rcp_f32 v59, v59
    v_rcp_f32 v60, v60
    v_rcp_f32 v61, v61
    v_rcp_f32 v62, v62
    v_rcp_f32 v63, v63
    v_rcp_f32 v64, v64
    v_rcp_f32 v65, v65
    v_rcp_f32 v66, v66
    v_rcp_f32 v67, v67
    v_pk_mul_f32 v[104:105], v[104:105], v[56:57]
    v_pk_mul_f32 v[108:109], v[108:109], v[58:59]
    v_pk_mul_f32 v[112:113], v[112:113], v[60:61]
    v_pk_mul_f32 v[116:117], v[116:117], v[62:63]
    v_pk_mul_f32 v[120:121], v[120:121], v[64:65]
    v_pk_mul_f32 v[124:125], v[124:125], v[66:67]
    v_cvt_pk_bf16_f32 v76, v104, v105
    v_cvt_pk_bf16_f32 v77, v108, v109
    v_cvt_pk_bf16_f32 v78, v112, v113
    v_cvt_pk_bf16_f32 v71, v112, v113
    v_cvt_pk_bf16_f32 v68, v104, v105
    v_permlane16_swap_b32 v76, v77
    v_cvt_pk_bf16_f32 v69, v108, v109
    v_permlane16_swap_b32 v78, v71
    v_cvt_pk_bf16_f32 v70, v112, v113
    s_add_u32 s6, s36, 29458432
    v_permlane32_swap_b32 v77, v71
    s_mov_b64 exec, s[64:65]
    buffer_store_dwordx4 v[68:71], v7, s[24:27], s6 offen sc1
    s_mov_b64 exec, -1
    v_cvt_pk_bf16_f32 v76, v116, v117
    v_cvt_pk_bf16_f32 v77, v120, v121
    v_cvt_pk_bf16_f32 v78, v124, v125
    v_cvt_pk_bf16_f32 v75, v124, v125
    v_cvt_pk_bf16_f32 v72, v116, v117
    v_permlane16_swap_b32 v76, v77
    v_cvt_pk_bf16_f32 v73, v120, v121
    v_permlane16_swap_b32 v78, v75
    v_cvt_pk_bf16_f32 v74, v124, v125
    s_add_u32 s6, s36, 29507584
    v_permlane32_swap_b32 v77, v75
    s_mov_b64 exec, s[64:65]
    buffer_store_dwordx4 v[72:75], v7, s[24:27], s6 offen sc1
    s_mov_b64 exec, -1
    s_waitcnt lgkmcnt(0)
    v_mfma_f32_16x16x32_bf16 v[128:131], a[96:99], v[176:179], 0
    ds_read_b128 v[192:195], v7 offset:9216
    ds_read_b128 v[196:199], v7 offset:21504
    v_mfma_f32_16x16x32_bf16 v[132:135], a[100:103], v[176:179], 0
    s_lshl_b32 s31, s37, 12
    s_add_u32 s31, s31, 36716544
    buffer_load_dwordx4 v[56:59], v19, s[24:27], s31 offen offset:0 sc1
    buffer_load_dwordx4 v[60:63], v19, s[24:27], s31 offen offset:256 sc1
    buffer_load_dwordx4 v[64:67], v19, s[24:27], s31 offen offset:512 sc1
    buffer_load_dwordx4 v[68:71], v19, s[24:27], s31 offen offset:768 sc1
    v_mfma_f32_16x16x32_bf16 v[136:139], a[104:107], v[176:179], 0
    ds_read_b128 v[200:203], v7 offset:33792
    ds_read_b128 v[204:207], v7 offset:46080
    v_mfma_f32_16x16x32_bf16 v[140:143], a[96:99], v[180:183], 0
    v_mfma_f32_16x16x32_bf16 v[144:147], a[100:103], v[180:183], 0
    v_mfma_f32_16x16x32_bf16 v[148:151], a[104:107], v[180:183], 0
    v_mfma_f32_16x16x32_bf16 v[152:155], a[96:99], v[184:187], 0
    v_mfma_f32_16x16x32_bf16 v[156:159], a[100:103], v[184:187], 0
    v_mfma_f32_16x16x32_bf16 v[160:163], a[104:107], v[184:187], 0
    v_mfma_f32_16x16x32_bf16 v[164:167], a[96:99], v[188:191], 0
    v_mfma_f32_16x16x32_bf16 v[168:171], a[100:103], v[188:191], 0
    v_mfma_f32_16x16x32_bf16 v[172:175], a[104:107], v[188:191], 0
    s_waitcnt lgkmcnt(0)
    v_mfma_f32_16x16x32_bf16 v[128:131], a[108:111], v[192:195], v[128:131]
    ds_read_b128 v[176:179], v7 offset:10240
    ds_read_b128 v[180:183], v7 offset:22528
    v_mfma_f32_16x16x32_bf16 v[132:135], a[112:115], v[192:195], v[132:135]
    v_mfma_f32_16x16x32_bf16 v[136:139], a[116:119], v[192:195], v[136:139]
    ds_read_b128 v[184:187], v7 offset:34816
    ds_read_b128 v[188:191], v7 offset:47104
    v_mfma_f32_16x16x32_bf16 v[140:143], a[108:111], v[196:199], v[140:143]
    v_mfma_f32_16x16x32_bf16 v[144:147], a[112:115], v[196:199], v[144:147]
    v_mfma_f32_16x16x32_bf16 v[148:151], a[116:119], v[196:199], v[148:151]
    v_mfma_f32_16x16x32_bf16 v[152:155], a[108:111], v[200:203], v[152:155]
    v_mfma_f32_16x16x32_bf16 v[156:159], a[112:115], v[200:203], v[156:159]
    v_mfma_f32_16x16x32_bf16 v[160:163], a[116:119], v[200:203], v[160:163]
    v_mfma_f32_16x16x32_bf16 v[164:167], a[108:111], v[204:207], v[164:167]
    v_mfma_f32_16x16x32_bf16 v[168:171], a[112:115], v[204:207], v[168:171]
    v_mfma_f32_16x16x32_bf16 v[172:175], a[116:119], v[204:207], v[172:175]
    s_add_u32 s62, s47, 24576
    buffer_load_dwordx4 a[108:111], v7, s[24:27], s62 offen offset:3072 sc1
    s_waitcnt lgkmcnt(0)
    v_mfma_f32_16x16x32_bf16 v[128:131], a[120:123], v[176:179], v[128:131]
    ds_read_b128 v[192:195], v7 offset:11264
    ds_read_b128 v[196:199], v7 offset:23552
    v_mfma_f32_16x16x32_bf16 v[132:135], a[124:127], v[176:179], v[132:135]
    v_mfma_f32_16x16x32_bf16 v[136:139], a[128:131], v[176:179], v[136:139]
    ds_read_b128 v[200:203], v7 offset:35840
    ds_read_b128 v[204:207], v7 offset:48128
    v_mfma_f32_16x16x32_bf16 v[140:143], a[120:123], v[180:183], v[140:143]
    v_mfma_f32_16x16x32_bf16 v[144:147], a[124:127], v[180:183], v[144:147]
    s_add_u32 s62, s47, 28672
    buffer_load_dwordx4 a[112:115], v7, s[24:27], s62 offen offset:0 sc1
    v_mfma_f32_16x16x32_bf16 v[148:151], a[128:131], v[180:183], v[148:151]
    v_mfma_f32_16x16x32_bf16 v[152:155], a[120:123], v[184:187], v[152:155]
    v_mfma_f32_16x16x32_bf16 v[156:159], a[124:127], v[184:187], v[156:159]
    v_mfma_f32_16x16x32_bf16 v[160:163], a[128:131], v[184:187], v[160:163]
    v_mfma_f32_16x16x32_bf16 v[164:167], a[120:123], v[188:191], v[164:167]
    buffer_load_dwordx4 a[116:119], v7, s[24:27], s62 offen offset:1024 sc1
    v_mfma_f32_16x16x32_bf16 v[168:171], a[124:127], v[188:191], v[168:171]
    v_mfma_f32_16x16x32_bf16 v[172:175], a[128:131], v[188:191], v[172:175]
    s_waitcnt lgkmcnt(0)
    s_waitcnt vmcnt(15)
    s_barrier
    v_mfma_f32_16x16x32_bf16 v[128:131], a[132:135], v[192:195], v[128:131]
    ds_read_b128 v[176:179], v7 offset:0
    ds_read_b128 v[180:183], v7 offset:12288
    v_mfma_f32_16x16x32_bf16 v[132:135], a[136:139], v[192:195], v[132:135]
    s_waitcnt vmcnt(7)
    s_add_u32 s3, s66, 15204352
    s_mov_b64 exec, 1
    buffer_store_dwordx2 v[2:3], off, s[24:27], s3 sc1
    s_mov_b64 exec, -1
    v_mfma_f32_16x16x32_bf16 v[136:139], a[140:143], v[192:195], v[136:139]
    ds_read_b128 v[184:187], v7 offset:24576
    ds_read_b128 v[188:191], v7 offset:36864
    s_add_u32 m0, s49, 8192
    s_add_u32 s38, s48, 20004864
    buffer_load_dwordx4 v7, s[24:27], s38 offen offset:0 sc1 lds
    v_mfma_f32_16x16x32_bf16 v[140:143], a[132:135], v[196:199], v[140:143]
    v_mfma_f32_16x16x32_bf16 v[144:147], a[136:139], v[196:199], v[144:147]
    v_mfma_f32_16x16x32_bf16 v[148:151], a[140:143], v[196:199], v[148:151]
    v_mfma_f32_16x16x32_bf16 v[152:155], a[132:135], v[200:203], v[152:155]
    v_mfma_f32_16x16x32_bf16 v[156:159], a[136:139], v[200:203], v[156:159]
    buffer_load_dwordx4 v7, s[24:27], s38 offen offset:1024 sc1 lds
    v_mfma_f32_16x16x32_bf16 v[160:163], a[140:143], v[200:203], v[160:163]
    v_mfma_f32_16x16x32_bf16 v[164:167], a[132:135], v[204:207], v[164:167]
    v_mfma_f32_16x16x32_bf16 v[168:171], a[136:139], v[204:207], v[168:171]
    v_mfma_f32_16x16x32_bf16 v[172:175], a[140:143], v[204:207], v[172:175]
    s_waitcnt lgkmcnt(0)
    v_mfma_f32_16x16x32_bf16 v[128:131], a[144:147], v[176:179], v[128:131]
    ds_read_b128 v[192:195], v7 offset:1024
    ds_read_b128 v[196:199], v7 offset:13312
    buffer_load_dwordx4 v7, s[24:27], s38 offen offset:2048 sc1 lds
    v_mfma_f32_16x16x32_bf16 v[132:135], a[148:151], v[176:179], v[132:135]
    v_mfma_f32_16x16x32_bf16 v[136:139], a[152:155], v[176:179], v[136:139]
    ds_read_b128 v[200:203], v7 offset:25600
    ds_read_b128 v[204:207], v7 offset:37888
    v_mfma_f32_16x16x32_bf16 v[140:143], a[144:147], v[180:183], v[140:143]
    v_mfma_f32_16x16x32_bf16 v[144:147], a[148:151], v[180:183], v[144:147]
    v_mfma_f32_16x16x32_bf16 v[148:151], a[152:155], v[180:183], v[148:151]
    buffer_load_dwordx4 v7, s[24:27], s38 offen offset:3072 sc1 lds
    v_mfma_f32_16x16x32_bf16 v[152:155], a[144:147], v[184:187], v[152:155]
    s_waitcnt vmcnt(8)
    s_branch Lso_interleave_layers__ssm_conv_h3__swiglu_ffn__prompt_kernel_55
Lst_interleave_layers__ssm_conv_h3__swiglu_ffn__prompt_kernel_54:
    s_sleep 1
    buffer_load_dwordx4 v[56:59], v19, s[24:27], s31 offen offset:0 sc1
    buffer_load_dwordx4 v[60:63], v19, s[24:27], s31 offen offset:256 sc1
    buffer_load_dwordx4 v[64:67], v19, s[24:27], s31 offen offset:512 sc1
    buffer_load_dwordx4 v[68:71], v19, s[24:27], s31 offen offset:768 sc1
    s_waitcnt vmcnt(0)
    s_sub_u32 s58, s58, 1
    s_cbranch_scc1 Lk2_end
Lso_interleave_layers__ssm_conv_h3__swiglu_ffn__prompt_kernel_55:
    v_cmp_ne_u64 s[68:69], v[2:3], v[58:59]
    v_cmp_ne_u64 s[70:71], v[2:3], v[62:63]
    v_cmp_ne_u64 s[72:73], v[2:3], v[66:67]
    v_cmp_ne_u64 vcc, v[2:3], v[70:71]
    s_or_b64 s[68:69], s[68:69], s[70:71]
    s_or_b64 vcc, vcc, s[72:73]
    s_or_b64 vcc, vcc, s[68:69]
    s_cbranch_vccnz Lst_interleave_layers__ssm_conv_h3__swiglu_ffn__prompt_kernel_54
    v_mfma_f32_16x16x32_bf16 v[156:159], a[148:151], v[184:187], v[156:159]
    v_add_f32 v56, v56, v60
    v_add_f32 v57, v57, v61
    v_mfma_f32_16x16x32_bf16 v[160:163], a[152:155], v[184:187], v[160:163]
    v_add_f32 v64, v64, v68
    v_add_f32 v65, v65, v69
    v_mfma_f32_16x16x32_bf16 v[164:167], a[144:147], v[188:191], v[164:167]
    v_add_f32 v72, v56, v64
    v_add_f32 v73, v57, v65
    v_mfma_f32_16x16x32_bf16 v[168:171], a[148:151], v[188:191], v[168:171]
    buffer_load_dwordx4 a[120:123], v7, s[24:27], s62 offen offset:2048 sc1
    v_mov_b32 v74, v72
    v_mfma_f32_16x16x32_bf16 v[172:175], a[152:155], v[188:191], v[172:175]
    v_mov_b32 v75, v73
    s_waitcnt lgkmcnt(0)
    v_mfma_f32_16x16x32_bf16 v[128:131], a[156:159], v[192:195], v[128:131]
    ds_read_b128 v[176:179], v7 offset:2048
    ds_read_b128 v[180:183], v7 offset:14336
    v_mfma_f32_16x16x32_bf16 v[132:135], a[160:163], v[192:195], v[132:135]
    v_permlane16_swap_b32 v72, v74
    v_permlane16_swap_b32 v73, v75
    v_mfma_f32_16x16x32_bf16 v[136:139], a[164:167], v[192:195], v[136:139]
    ds_read_b128 v[184:187], v7 offset:26624
    ds_read_b128 v[188:191], v7 offset:38912
    v_mfma_f32_16x16x32_bf16 v[140:143], a[156:159], v[196:199], v[140:143]
    buffer_load_dwordx4 a[124:127], v7, s[24:27], s62 offen offset:3072 sc1
    v_add_f32 v72, v72, v74
    v_mfma_f32_16x16x32_bf16 v[144:147], a[160:163], v[196:199], v[144:147]
    v_add_f32 v73, v73, v75
    v_mov_b32 v74, v72
    v_mfma_f32_16x16x32_bf16 v[148:151], a[164:167], v[196:199], v[148:151]
    v_mov_b32 v75, v73
    v_permlane32_swap_b32 v72, v74
    v_mfma_f32_16x16x32_bf16 v[152:155], a[156:159], v[200:203], v[152:155]
    v_permlane32_swap_b32 v73, v75
    v_add_f32 v72, v72, v74
    v_mfma_f32_16x16x32_bf16 v[156:159], a[160:163], v[200:203], v[156:159]
    v_add_f32 v73, v73, v75
    v_mul_f32 v72, 0x3acccccd, v72
    v_mfma_f32_16x16x32_bf16 v[160:163], a[164:167], v[200:203], v[160:163]
    s_add_u32 s62, s47, 32768
    buffer_load_dwordx4 a[128:131], v7, s[24:27], s62 offen offset:0 sc1
    v_mfma_f32_16x16x32_bf16 v[164:167], a[156:159], v[204:207], v[164:167]
    v_mul_f32 v73, 0x3acccccd, v73
    v_fma_f32 v73, -v72, v72, v73
    v_mfma_f32_16x16x32_bf16 v[168:171], a[160:163], v[204:207], v[168:171]
    v_max_f32 v73, 0, v73
    v_cvt_pk_bf16_f32 v74, v72, v73
    v_mfma_f32_16x16x32_bf16 v[172:175], a[164:167], v[204:207], v[172:175]
    v_lshlrev_b32 v72, 16, v74
    s_waitcnt lgkmcnt(0)
    v_mfma_f32_16x16x32_bf16 v[128:131], a[168:171], v[176:179], v[128:131]
    ds_read_b128 v[192:195], v7 offset:3072
    ds_read_b128 v[196:199], v7 offset:15360
    v_mfma_f32_16x16x32_bf16 v[132:135], a[172:175], v[176:179], v[132:135]
    buffer_load_dwordx4 a[132:135], v7, s[24:27], s62 offen offset:1024 sc1
    v_and_b32 v73, 0xffff0000, v74
    v_mfma_f32_16x16x32_bf16 v[136:139], a[176:179], v[176:179], v[136:139]
    ds_read_b128 v[200:203], v7 offset:27648
    ds_read_b128 v[204:207], v7 offset:39936
    v_mfma_f32_16x16x32_bf16 v[140:143], a[168:171], v[180:183], v[140:143]
    v_add_f32 v73, 0x3727c5ac, v73
    v_cvt_pk_bf16_f32 v74, v73, v73
    v_mfma_f32_16x16x32_bf16 v[144:147], a[172:175], v[180:183], v[144:147]
    v_lshlrev_b32 v73, 16, v74
    v_mfma_f32_16x16x32_bf16 v[148:151], a[176:179], v[180:183], v[148:151]
    v_sqrt_f32 v73, v73
    v_mfma_f32_16x16x32_bf16 v[152:155], a[168:171], v[184:187], v[152:155]
    buffer_load_dwordx4 a[136:139], v7, s[24:27], s62 offen offset:2048 sc1
    v_cvt_pk_bf16_f32 v74, v73, v73
    v_mfma_f32_16x16x32_bf16 v[156:159], a[172:175], v[184:187], v[156:159]
    v_lshlrev_b32 v73, 16, v74
    v_mfma_f32_16x16x32_bf16 v[160:163], a[176:179], v[184:187], v[160:163]
    v_rcp_f32 v73, v73
    v_mfma_f32_16x16x32_bf16 v[164:167], a[168:171], v[188:191], v[164:167]
    v_bfe_u32 v75, v7, 1, 7
    s_lshl_b32 s7, s40, 7
    v_mfma_f32_16x16x32_bf16 v[168:171], a[172:175], v[188:191], v[168:171]
    v_add_u32 v75, 160768, v75
    v_add_u32 v74, s7, v75
    v_mfma_f32_16x16x32_bf16 v[172:175], a[176:179], v[188:191], v[172:175]
    buffer_load_dwordx4 a[140:143], v7, s[24:27], s62 offen offset:3072 sc1
    s_waitcnt lgkmcnt(0)
    s_barrier
    v_mfma_f32_16x16x32_bf16 v[128:131], a[180:183], v[192:195], v[128:131]
    ds_read_b128 v[176:179], v7 offset:4096
    ds_read_b128 v[180:183], v7 offset:16384
    v_mfma_f32_16x16x32_bf16 v[132:135], a[184:187], v[192:195], v[132:135]
    s_add_u32 s33, s67, 15204352
    s_mov_b64 exec, 0xffff
    buffer_load_dwordx2 v[10:11], v9, s[24:27], s33 offen sc1
    s_mov_b64 exec, -1
    v_mfma_f32_16x16x32_bf16 v[136:139], a[188:191], v[192:195], v[136:139]
    ds_read_b128 v[184:187], v7 offset:28672
    ds_read_b128 v[188:191], v7 offset:40960
    v_mfma_f32_16x16x32_bf16 v[140:143], a[180:183], v[196:199], v[140:143]
    ds_write_b64 v74, v[72:73]
    v_mfma_f32_16x16x32_bf16 v[144:147], a[184:187], v[196:199], v[144:147]
    s_add_u32 m0, s49, 0
    s_add_u32 s38, s48, 20008960
    buffer_load_dwordx4 v7, s[24:27], s38 offen offset:0 sc1 lds
    v_mfma_f32_16x16x32_bf16 v[148:151], a[188:191], v[196:199], v[148:151]
    v_mfma_f32_16x16x32_bf16 v[152:155], a[180:183], v[200:203], v[152:155]
    s_waitcnt lgkmcnt(0)
    s_barrier
    v_mfma_f32_16x16x32_bf16 v[156:159], a[184:187], v[200:203], v[156:159]
    ds_read_b64 v[56:57], v75 offset:0
    ds_read_b64 v[58:59], v75 offset:128
    v_mfma_f32_16x16x32_bf16 v[160:163], a[188:191], v[200:203], v[160:163]
    ds_read_b64 v[60:61], v75 offset:256
    ds_read_b64 v[62:63], v75 offset:384
    v_mfma_f32_16x16x32_bf16 v[164:167], a[180:183], v[204:207], v[164:167]
    buffer_load_dwordx4 v7, s[24:27], s38 offen offset:1024 sc1 lds
    v_mfma_f32_16x16x32_bf16 v[168:171], a[184:187], v[204:207], v[168:171]
    v_mfma_f32_16x16x32_bf16 v[172:175], a[188:191], v[204:207], v[172:175]
    v_mfma_f32_16x16x32_bf16 v[128:131], a[192:195], v[176:179], v[128:131]
    ds_read_b128 v[192:195], v7 offset:5120
    ds_read_b128 v[196:199], v7 offset:17408
    v_mfma_f32_16x16x32_bf16 v[132:135], a[196:199], v[176:179], v[132:135]
    s_waitcnt lgkmcnt(2)
    v_sub_f32 v44, 0, v56
    v_mfma_f32_16x16x32_bf16 v[136:139], a[200:203], v[176:179], v[136:139]
    ds_read_b128 v[200:203], v7 offset:29696
    ds_read_b128 v[204:207], v7 offset:41984
    buffer_load_dwordx4 v7, s[24:27], s38 offen offset:2048 sc1 lds
    v_mfma_f32_16x16x32_bf16 v[140:143], a[192:195], v[180:183], v[140:143]
    v_mul_f32 v45, 0xbfb8aa3b, v57
    v_mul_f32 v46, v57, v57
    v_mfma_f32_16x16x32_bf16 v[144:147], a[196:199], v[180:183], v[144:147]
    v_rcp_f32 v46, v46
    v_mfma_f32_16x16x32_bf16 v[148:151], a[200:203], v[180:183], v[148:151]
    v_sub_f32 v47, 0, v58
    v_mul_f32 v48, 0xbfb8aa3b, v59
    v_mfma_f32_16x16x32_bf16 v[152:155], a[192:195], v[184:187], v[152:155]
    v_mul_f32 v49, v59, v59
    v_mfma_f32_16x16x32_bf16 v[156:159], a[196:199], v[184:187], v[156:159]
    buffer_load_dwordx4 v7, s[24:27], s38 offen offset:3072 sc1 lds
    v_mfma_f32_16x16x32_bf16 v[160:163], a[200:203], v[184:187], v[160:163]
    v_rcp_f32 v49, v49
    v_mfma_f32_16x16x32_bf16 v[164:167], a[192:195], v[188:191], v[164:167]
    v_sub_f32 v50, 0, v60
    v_mul_f32 v51, 0xbfb8aa3b, v61
    v_mfma_f32_16x16x32_bf16 v[168:171], a[196:199], v[188:191], v[168:171]
    v_mul_f32 v52, v61, v61
    v_mfma_f32_16x16x32_bf16 v[172:175], a[200:203], v[188:191], v[172:175]
    s_waitcnt lgkmcnt(0)
    v_mfma_f32_16x16x32_bf16 v[128:131], a[204:207], v[192:195], v[128:131]
    ds_read_b128 v[176:179], v7 offset:6144
    ds_read_b128 v[180:183], v7 offset:18432
    s_add_u32 s62, s47, 36864
    buffer_load_dwordx4 a[144:147], v7, s[24:27], s62 offen offset:0 sc1
    v_mfma_f32_16x16x32_bf16 v[132:135], a[208:211], v[192:195], v[132:135]
    v_rcp_f32 v52, v52
    v_mfma_f32_16x16x32_bf16 v[136:139], a[212:215], v[192:195], v[136:139]
    ds_read_b128 v[184:187], v7 offset:30720
    ds_read_b128 v[188:191], v7 offset:43008
    v_mfma_f32_16x16x32_bf16 v[140:143], a[204:207], v[196:199], v[140:143]
    v_sub_f32 v53, 0, v62
    v_mul_f32 v54, 0xbfb8aa3b, v63
    v_mfma_f32_16x16x32_bf16 v[144:147], a[208:211], v[196:199], v[144:147]
    v_mul_f32 v55, v63, v63
    v_mfma_f32_16x16x32_bf16 v[148:151], a[212:215], v[196:199], v[148:151]
    buffer_load_dwordx4 a[148:151], v7, s[24:27], s62 offen offset:1024 sc1
    v_mfma_f32_16x16x32_bf16 v[152:155], a[204:207], v[200:203], v[152:155]
    v_rcp_f32 v55, v55
    v_mfma_f32_16x16x32_bf16 v[156:159], a[208:211], v[200:203], v[156:159]
    v_mfma_f32_16x16x32_bf16 v[160:163], a[212:215], v[200:203], v[160:163]
    v_mfma_f32_16x16x32_bf16 v[164:167], a[204:207], v[204:207], v[164:167]
    v_mfma_f32_16x16x32_bf16 v[168:171], a[208:211], v[204:207], v[168:171]
    buffer_load_dwordx4 a[152:155], v7, s[24:27], s62 offen offset:2048 sc1
    v_mfma_f32_16x16x32_bf16 v[172:175], a[212:215], v[204:207], v[172:175]
    s_waitcnt lgkmcnt(0)
    v_mfma_f32_16x16x32_bf16 v[128:131], a[216:219], v[176:179], v[128:131]
    ds_read_b128 v[192:195], v7 offset:7168
    ds_read_b128 v[196:199], v7 offset:19456
    v_mfma_f32_16x16x32_bf16 v[132:135], a[220:223], v[176:179], v[132:135]
    s_waitcnt vmcnt(7)
    s_mov_b64 exec, 0xffff
    s_branch Lpo_interleave_layers__ssm_conv_h3__swiglu_ffn__prompt_kernel_57
Lpr_interleave_layers__ssm_conv_h3__swiglu_ffn__prompt_kernel_56:
    s_sleep 2
    buffer_load_dwordx2 v[10:11], v9, s[24:27], s33 offen sc1
    s_waitcnt vmcnt(0)
    s_sub_u32 s58, s58, 1
    s_cbranch_scc1 Lk2_end
Lpo_interleave_layers__ssm_conv_h3__swiglu_ffn__prompt_kernel_57:
    v_cmp_ne_u64 vcc, v[2:3], v[10:11]
    s_cbranch_vccnz Lpr_interleave_layers__ssm_conv_h3__swiglu_ffn__prompt_kernel_56
    s_mov_b64 exec, -1
    v_mfma_f32_16x16x32_bf16 v[136:139], a[224:227], v[176:179], v[136:139]
    ds_read_b128 v[200:203], v7 offset:31744
    ds_read_b128 v[204:207], v7 offset:44032
    v_mfma_f32_16x16x32_bf16 v[140:143], a[216:219], v[180:183], v[140:143]
    s_add_u32 s32, s35, 29360128
    buffer_load_dwordx4 v[80:83], v7, s[24:27], s32 offen offset:0 sc1
    v_mfma_f32_16x16x32_bf16 v[144:147], a[220:223], v[180:183], v[144:147]
    v_mfma_f32_16x16x32_bf16 v[148:151], a[224:227], v[180:183], v[148:151]
    v_mfma_f32_16x16x32_bf16 v[152:155], a[216:219], v[184:187], v[152:155]
    v_mfma_f32_16x16x32_bf16 v[156:159], a[220:223], v[184:187], v[156:159]
    v_mfma_f32_16x16x32_bf16 v[160:163], a[224:227], v[184:187], v[160:163]
    buffer_load_dwordx4 v[84:87], v7, s[24:27], s32 offen offset:1024 sc1
    v_mfma_f32_16x16x32_bf16 v[164:167], a[216:219], v[188:191], v[164:167]
    v_mfma_f32_16x16x32_bf16 v[168:171], a[220:223], v[188:191], v[168:171]
    v_mfma_f32_16x16x32_bf16 v[172:175], a[224:227], v[188:191], v[172:175]
    s_waitcnt lgkmcnt(0)
    s_barrier
    v_mfma_f32_16x16x32_bf16 v[128:131], a[228:231], v[192:195], v[128:131]
    ds_read_b128 v[176:179], v7 offset:8192
    ds_read_b128 v[180:183], v7 offset:20480
    v_mfma_f32_16x16x32_bf16 v[132:135], a[232:235], v[192:195], v[132:135]
    buffer_load_dwordx4 v[88:91], v7, s[24:27], s32 offen offset:2048 sc1
    v_mfma_f32_16x16x32_bf16 v[136:139], a[236:239], v[192:195], v[136:139]
    ds_read_b128 v[184:187], v7 offset:32768
    ds_read_b128 v[188:191], v7 offset:45056
    v_mfma_f32_16x16x32_bf16 v[140:143], a[228:231], v[196:199], v[140:143]
    v_mfma_f32_16x16x32_bf16 v[144:147], a[232:235], v[196:199], v[144:147]
    v_mfma_f32_16x16x32_bf16 v[148:151], a[236:239], v[196:199], v[148:151]
    v_mfma_f32_16x16x32_bf16 v[152:155], a[228:231], v[200:203], v[152:155]
    s_add_u32 s32, s35, 29409280
    buffer_load_dwordx4 v[92:95], v7, s[24:27], s32 offen offset:0 sc1
    v_mfma_f32_16x16x32_bf16 v[156:159], a[232:235], v[200:203], v[156:159]
    v_mfma_f32_16x16x32_bf16 v[160:163], a[236:239], v[200:203], v[160:163]
    v_mfma_f32_16x16x32_bf16 v[164:167], a[228:231], v[204:207], v[164:167]
    v_mfma_f32_16x16x32_bf16 v[168:171], a[232:235], v[204:207], v[168:171]
    v_mfma_f32_16x16x32_bf16 v[172:175], a[236:239], v[204:207], v[172:175]
    buffer_load_dwordx4 v[96:99], v7, s[24:27], s32 offen offset:1024 sc1
    s_waitcnt lgkmcnt(0)
    v_mfma_f32_16x16x32_bf16 v[128:131], a[0:3], v[176:179], v[128:131]
    ds_read_b128 v[192:195], v7 offset:9216
    ds_read_b128 v[196:199], v7 offset:21504
    v_mfma_f32_16x16x32_bf16 v[132:135], a[4:7], v[176:179], v[132:135]
    v_mfma_f32_16x16x32_bf16 v[136:139], a[8:11], v[176:179], v[136:139]
    ds_read_b128 v[200:203], v7 offset:33792
    ds_read_b128 v[204:207], v7 offset:46080
    v_mfma_f32_16x16x32_bf16 v[140:143], a[0:3], v[180:183], v[140:143]
    v_mfma_f32_16x16x32_bf16 v[144:147], a[4:7], v[180:183], v[144:147]
    buffer_load_dwordx4 v[100:103], v7, s[24:27], s32 offen offset:2048 sc1
    v_mfma_f32_16x16x32_bf16 v[148:151], a[8:11], v[180:183], v[148:151]
    v_mfma_f32_16x16x32_bf16 v[152:155], a[0:3], v[184:187], v[152:155]
    v_mfma_f32_16x16x32_bf16 v[156:159], a[4:7], v[184:187], v[156:159]
    v_mfma_f32_16x16x32_bf16 v[160:163], a[8:11], v[184:187], v[160:163]
    v_mfma_f32_16x16x32_bf16 v[164:167], a[0:3], v[188:191], v[164:167]
    s_add_u32 s32, s35, 29363200
    buffer_load_dwordx4 v[104:107], v7, s[24:27], s32 offen offset:0 sc1
    v_mfma_f32_16x16x32_bf16 v[168:171], a[4:7], v[188:191], v[168:171]
    v_mfma_f32_16x16x32_bf16 v[172:175], a[8:11], v[188:191], v[172:175]
    s_waitcnt lgkmcnt(0)
    v_mfma_f32_16x16x32_bf16 v[128:131], a[12:15], v[192:195], v[128:131]
    ds_read_b128 v[176:179], v7 offset:10240
    ds_read_b128 v[180:183], v7 offset:22528
    v_mfma_f32_16x16x32_bf16 v[132:135], a[16:19], v[192:195], v[132:135]
    v_mfma_f32_16x16x32_bf16 v[136:139], a[20:23], v[192:195], v[136:139]
    ds_read_b128 v[184:187], v7 offset:34816
    ds_read_b128 v[188:191], v7 offset:47104
    buffer_load_dwordx4 v[108:111], v7, s[24:27], s32 offen offset:1024 sc1
    v_mfma_f32_16x16x32_bf16 v[140:143], a[12:15], v[196:199], v[140:143]
    v_mfma_f32_16x16x32_bf16 v[144:147], a[16:19], v[196:199], v[144:147]
    v_mfma_f32_16x16x32_bf16 v[148:151], a[20:23], v[196:199], v[148:151]
    v_mfma_f32_16x16x32_bf16 v[152:155], a[12:15], v[200:203], v[152:155]
    v_mfma_f32_16x16x32_bf16 v[156:159], a[16:19], v[200:203], v[156:159]
    buffer_load_dwordx4 v[112:115], v7, s[24:27], s32 offen offset:2048 sc1
    v_mfma_f32_16x16x32_bf16 v[160:163], a[20:23], v[200:203], v[160:163]
    v_mfma_f32_16x16x32_bf16 v[164:167], a[12:15], v[204:207], v[164:167]
    v_mfma_f32_16x16x32_bf16 v[168:171], a[16:19], v[204:207], v[168:171]
    v_mfma_f32_16x16x32_bf16 v[172:175], a[20:23], v[204:207], v[172:175]
    s_waitcnt lgkmcnt(0)
    v_mfma_f32_16x16x32_bf16 v[128:131], a[24:27], v[176:179], v[128:131]
    ds_read_b128 v[192:195], v7 offset:11264
    ds_read_b128 v[196:199], v7 offset:23552
    s_add_u32 s32, s35, 29412352
    buffer_load_dwordx4 v[116:119], v7, s[24:27], s32 offen offset:0 sc1
    v_mfma_f32_16x16x32_bf16 v[132:135], a[28:31], v[176:179], v[132:135]
    v_mfma_f32_16x16x32_bf16 v[136:139], a[32:35], v[176:179], v[136:139]
    ds_read_b128 v[200:203], v7 offset:35840
    ds_read_b128 v[204:207], v7 offset:48128
    v_mfma_f32_16x16x32_bf16 v[140:143], a[24:27], v[180:183], v[140:143]
    v_mfma_f32_16x16x32_bf16 v[144:147], a[28:31], v[180:183], v[144:147]
    v_mfma_f32_16x16x32_bf16 v[148:151], a[32:35], v[180:183], v[148:151]
    buffer_load_dwordx4 v[120:123], v7, s[24:27], s32 offen offset:1024 sc1
    v_mfma_f32_16x16x32_bf16 v[152:155], a[24:27], v[184:187], v[152:155]
    v_mfma_f32_16x16x32_bf16 v[156:159], a[28:31], v[184:187], v[156:159]
    v_mfma_f32_16x16x32_bf16 v[160:163], a[32:35], v[184:187], v[160:163]
    v_mfma_f32_16x16x32_bf16 v[164:167], a[24:27], v[188:191], v[164:167]
    v_mfma_f32_16x16x32_bf16 v[168:171], a[28:31], v[188:191], v[168:171]
    buffer_load_dwordx4 v[124:127], v7, s[24:27], s32 offen offset:2048 sc1
    v_mfma_f32_16x16x32_bf16 v[172:175], a[32:35], v[188:191], v[172:175]
    s_waitcnt lgkmcnt(0)
    s_waitcnt vmcnt(15)
    s_barrier
    v_mfma_f32_16x16x32_bf16 v[128:131], a[36:39], v[192:195], v[128:131]
    ds_read_b128 v[176:179], v7 offset:0
    ds_read_b128 v[180:183], v7 offset:12288
    v_mfma_f32_16x16x32_bf16 v[132:135], a[40:43], v[192:195], v[132:135]
    v_mfma_f32_16x16x32_bf16 v[136:139], a[44:47], v[192:195], v[136:139]
    ds_read_b128 v[184:187], v7 offset:24576
    ds_read_b128 v[188:191], v7 offset:36864
    v_mfma_f32_16x16x32_bf16 v[140:143], a[36:39], v[196:199], v[140:143]
    s_add_u32 s32, s35, 29366272
    buffer_load_dwordx4 v[208:211], v7, s[24:27], s32 offen offset:0 sc1
    v_mfma_f32_16x16x32_bf16 v[144:147], a[40:43], v[196:199], v[144:147]
    v_mfma_f32_16x16x32_bf16 v[148:151], a[44:47], v[196:199], v[148:151]
    v_mfma_f32_16x16x32_bf16 v[152:155], a[36:39], v[200:203], v[152:155]
    v_mfma_f32_16x16x32_bf16 v[156:159], a[40:43], v[200:203], v[156:159]
    v_mfma_f32_16x16x32_bf16 v[160:163], a[44:47], v[200:203], v[160:163]
    buffer_load_dwordx4 v[212:215], v7, s[24:27], s32 offen offset:1024 sc1
    v_mfma_f32_16x16x32_bf16 v[164:167], a[36:39], v[204:207], v[164:167]
    v_mfma_f32_16x16x32_bf16 v[168:171], a[40:43], v[204:207], v[168:171]
    v_mfma_f32_16x16x32_bf16 v[172:175], a[44:47], v[204:207], v[172:175]
    s_waitcnt lgkmcnt(0)
    v_mfma_f32_16x16x32_bf16 v[128:131], a[48:51], v[176:179], v[128:131]
    ds_read_b128 v[192:195], v7 offset:1024
    ds_read_b128 v[196:199], v7 offset:13312
    v_mfma_f32_16x16x32_bf16 v[132:135], a[52:55], v[176:179], v[132:135]
    buffer_load_dwordx4 v[216:219], v7, s[24:27], s32 offen offset:2048 sc1
    v_mfma_f32_16x16x32_bf16 v[136:139], a[56:59], v[176:179], v[136:139]
    ds_read_b128 v[200:203], v7 offset:25600
    ds_read_b128 v[204:207], v7 offset:37888
    v_mfma_f32_16x16x32_bf16 v[140:143], a[48:51], v[180:183], v[140:143]
    v_mfma_f32_16x16x32_bf16 v[144:147], a[52:55], v[180:183], v[144:147]
    v_mfma_f32_16x16x32_bf16 v[148:151], a[56:59], v[180:183], v[148:151]
    v_mfma_f32_16x16x32_bf16 v[152:155], a[48:51], v[184:187], v[152:155]
    s_add_u32 s32, s35, 29415424
    buffer_load_dwordx4 v[220:223], v7, s[24:27], s32 offen offset:0 sc1
    v_mfma_f32_16x16x32_bf16 v[156:159], a[52:55], v[184:187], v[156:159]
    v_mfma_f32_16x16x32_bf16 v[160:163], a[56:59], v[184:187], v[160:163]
    v_mfma_f32_16x16x32_bf16 v[164:167], a[48:51], v[188:191], v[164:167]
    v_mfma_f32_16x16x32_bf16 v[168:171], a[52:55], v[188:191], v[168:171]
    v_mfma_f32_16x16x32_bf16 v[172:175], a[56:59], v[188:191], v[172:175]
    buffer_load_dwordx4 v[224:227], v7, s[24:27], s32 offen offset:1024 sc1
    s_waitcnt lgkmcnt(0)
    v_mfma_f32_16x16x32_bf16 v[128:131], a[60:63], v[192:195], v[128:131]
    ds_read_b128 v[176:179], v7 offset:2048
    ds_read_b128 v[180:183], v7 offset:14336
    v_mfma_f32_16x16x32_bf16 v[132:135], a[64:67], v[192:195], v[132:135]
    v_mfma_f32_16x16x32_bf16 v[136:139], a[68:71], v[192:195], v[136:139]
    ds_read_b128 v[184:187], v7 offset:26624
    ds_read_b128 v[188:191], v7 offset:38912
    v_mfma_f32_16x16x32_bf16 v[140:143], a[60:63], v[196:199], v[140:143]
    v_mfma_f32_16x16x32_bf16 v[144:147], a[64:67], v[196:199], v[144:147]
    buffer_load_dwordx4 v[228:231], v7, s[24:27], s32 offen offset:2048 sc1
    v_mfma_f32_16x16x32_bf16 v[148:151], a[68:71], v[196:199], v[148:151]
    v_mfma_f32_16x16x32_bf16 v[152:155], a[60:63], v[200:203], v[152:155]
    v_mfma_f32_16x16x32_bf16 v[156:159], a[64:67], v[200:203], v[156:159]
    v_mfma_f32_16x16x32_bf16 v[160:163], a[68:71], v[200:203], v[160:163]
    v_mfma_f32_16x16x32_bf16 v[164:167], a[60:63], v[204:207], v[164:167]
    buffer_load_dwordx4 a[156:159], v7, s[24:27], s62 offen offset:3072 sc1
    v_mfma_f32_16x16x32_bf16 v[168:171], a[64:67], v[204:207], v[168:171]
    v_mfma_f32_16x16x32_bf16 v[172:175], a[68:71], v[204:207], v[172:175]
    s_waitcnt lgkmcnt(0)
    v_mfma_f32_16x16x32_bf16 v[128:131], a[72:75], v[176:179], v[128:131]
    ds_read_b128 v[192:195], v7 offset:3072
    ds_read_b128 v[196:199], v7 offset:15360
    v_mfma_f32_16x16x32_bf16 v[132:135], a[76:79], v[176:179], v[132:135]
    v_mfma_f32_16x16x32_bf16 v[136:139], a[80:83], v[176:179], v[136:139]
    ds_read_b128 v[200:203], v7 offset:27648
    ds_read_b128 v[204:207], v7 offset:39936
    s_add_u32 s62, s47, 40960
    buffer_load_dwordx4 a[160:163], v7, s[24:27], s62 offen offset:0 sc1
    v_mfma_f32_16x16x32_bf16 v[140:143], a[72:75], v[180:183], v[140:143]
    v_mfma_f32_16x16x32_bf16 v[144:147], a[76:79], v[180:183], v[144:147]
    v_mfma_f32_16x16x32_bf16 v[148:151], a[80:83], v[180:183], v[148:151]
    v_mfma_f32_16x16x32_bf16 v[152:155], a[72:75], v[184:187], v[152:155]
    v_mfma_f32_16x16x32_bf16 v[156:159], a[76:79], v[184:187], v[156:159]
    s_add_u32 s32, s35, 29369344
    buffer_load_dwordx4 v[232:235], v7, s[24:27], s32 offen offset:0 sc1
    v_mfma_f32_16x16x32_bf16 v[160:163], a[80:83], v[184:187], v[160:163]
    v_mfma_f32_16x16x32_bf16 v[164:167], a[72:75], v[188:191], v[164:167]
    v_mfma_f32_16x16x32_bf16 v[168:171], a[76:79], v[188:191], v[168:171]
    v_mfma_f32_16x16x32_bf16 v[172:175], a[80:83], v[188:191], v[172:175]
    s_waitcnt lgkmcnt(0)
    v_mfma_f32_16x16x32_bf16 v[128:131], a[84:87], v[192:195], v[128:131]
    buffer_load_dwordx4 v[236:239], v7, s[24:27], s32 offen offset:1024 sc1
    v_mfma_f32_16x16x32_bf16 v[132:135], a[88:91], v[192:195], v[132:135]
    v_mfma_f32_16x16x32_bf16 v[136:139], a[92:95], v[192:195], v[136:139]
    v_mfma_f32_16x16x32_bf16 v[140:143], a[84:87], v[196:199], v[140:143]
    v_mfma_f32_16x16x32_bf16 v[144:147], a[88:91], v[196:199], v[144:147]
    v_mfma_f32_16x16x32_bf16 v[148:151], a[92:95], v[196:199], v[148:151]
    buffer_load_dwordx4 a[164:167], v7, s[24:27], s62 offen offset:1024 sc1
    v_mfma_f32_16x16x32_bf16 v[152:155], a[84:87], v[200:203], v[152:155]
    v_mfma_f32_16x16x32_bf16 v[156:159], a[88:91], v[200:203], v[156:159]
    v_mfma_f32_16x16x32_bf16 v[160:163], a[92:95], v[200:203], v[160:163]
    v_mfma_f32_16x16x32_bf16 v[164:167], a[84:87], v[204:207], v[164:167]
    v_mfma_f32_16x16x32_bf16 v[168:171], a[88:91], v[204:207], v[168:171]
    buffer_load_dwordx4 v[240:243], v7, s[24:27], s32 offen offset:2048 sc1
    v_mfma_f32_16x16x32_bf16 v[172:175], a[92:95], v[204:207], v[172:175]
    v_pk_fma_f32 v[128:129], v[44:45], v[20:21], v[128:129] op_sel:[0,0,0] op_sel_hi:[0,1,1]
    v_pk_fma_f32 v[132:133], v[44:45], v[24:25], v[132:133] op_sel:[0,0,0] op_sel_hi:[0,1,1]
    v_pk_fma_f32 v[136:137], v[44:45], v[28:29], v[136:137] op_sel:[0,0,0] op_sel_hi:[0,1,1]
    v_pk_fma_f32 v[140:141], v[46:47], v[20:21], v[140:141] op_sel:[1,0,0] op_sel_hi:[1,1,1]
    v_pk_fma_f32 v[144:145], v[46:47], v[24:25], v[144:145] op_sel:[1,0,0] op_sel_hi:[1,1,1]
    v_pk_fma_f32 v[148:149], v[46:47], v[28:29], v[148:149] op_sel:[1,0,0] op_sel_hi:[1,1,1]
    v_pk_mul_f32 v[56:57], v[128:129], v[44:45] op_sel:[0,1] op_sel_hi:[1,1]
    v_pk_mul_f32 v[58:59], v[132:133], v[44:45] op_sel:[0,1] op_sel_hi:[1,1]
    s_add_u32 s32, s35, 29418496
    buffer_load_dwordx4 v[244:247], v7, s[24:27], s32 offen offset:0 sc1
    v_pk_mul_f32 v[60:61], v[136:137], v[44:45] op_sel:[0,1] op_sel_hi:[1,1]
    v_pk_mul_f32 v[62:63], v[140:141], v[48:49] op_sel:[0,0] op_sel_hi:[1,0]
    v_pk_mul_f32 v[64:65], v[144:145], v[48:49] op_sel:[0,0] op_sel_hi:[1,0]
    v_pk_mul_f32 v[66:67], v[148:149], v[48:49] op_sel:[0,0] op_sel_hi:[1,0]
    v_pk_fma_f32 v[130:131], v[44:45], v[22:23], v[130:131] op_sel:[0,0,0] op_sel_hi:[0,1,1]
    v_pk_fma_f32 v[134:135], v[44:45], v[26:27], v[134:135] op_sel:[0,0,0] op_sel_hi:[0,1,1]
    v_pk_fma_f32 v[138:139], v[44:45], v[30:31], v[138:139] op_sel:[0,0,0] op_sel_hi:[0,1,1]
    v_pk_fma_f32 v[142:143], v[46:47], v[22:23], v[142:143] op_sel:[1,0,0] op_sel_hi:[1,1,1]
    v_pk_fma_f32 v[146:147], v[46:47], v[26:27], v[146:147] op_sel:[1,0,0] op_sel_hi:[1,1,1]
    v_pk_fma_f32 v[150:151], v[46:47], v[30:31], v[150:151] op_sel:[1,0,0] op_sel_hi:[1,1,1]
    v_exp_f32 v56, v56
    buffer_load_dwordx4 v[248:251], v7, s[24:27], s32 offen offset:1024 sc1
    v_exp_f32 v57, v57
    v_exp_f32 v58, v58
    v_exp_f32 v59, v59
    v_exp_f32 v60, v60
    v_exp_f32 v61, v61
    v_exp_f32 v62, v62
    buffer_load_dwordx4 v[252:255], v7, s[24:27], s32 offen offset:2048 sc1
    v_exp_f32 v63, v63
    v_exp_f32 v64, v64
    v_exp_f32 v65, v65
    v_exp_f32 v66, v66
    v_exp_f32 v67, v67
    v_pk_mul_f32 v[128:129], v[128:129], v[130:131]
    v_pk_mul_f32 v[132:133], v[132:133], v[134:135]
    buffer_load_dwordx4 a[168:171], v7, s[24:27], s62 offen offset:2048 sc1
    v_pk_mul_f32 v[136:137], v[136:137], v[138:139]
    v_pk_mul_f32 v[140:141], v[140:141], v[142:143]
    v_pk_mul_f32 v[144:145], v[144:145], v[146:147]
    v_pk_mul_f32 v[148:149], v[148:149], v[150:151]
    v_pk_fma_f32 v[56:57], v[56:57], v[46:47], v[46:47] op_sel:[0,0,0] op_sel_hi:[1,0,0]
    v_pk_fma_f32 v[58:59], v[58:59], v[46:47], v[46:47] op_sel:[0,0,0] op_sel_hi:[1,0,0]
    v_pk_fma_f32 v[60:61], v[60:61], v[46:47], v[46:47] op_sel:[0,0,0] op_sel_hi:[1,0,0]
    v_pk_fma_f32 v[62:63], v[62:63], v[48:49], v[48:49] op_sel:[0,1,1] op_sel_hi:[1,1,1]
    v_pk_fma_f32 v[64:65], v[64:65], v[48:49], v[48:49] op_sel:[0,1,1] op_sel_hi:[1,1,1]
    v_pk_fma_f32 v[66:67], v[66:67], v[48:49], v[48:49] op_sel:[0,1,1] op_sel_hi:[1,1,1]
    v_rcp_f32 v56, v56
    buffer_load_dwordx4 a[172:175], v7, s[24:27], s62 offen offset:3072 sc1
    v_rcp_f32 v57, v57
    v_rcp_f32 v58, v58
    v_rcp_f32 v59, v59
    v_rcp_f32 v60, v60
    v_rcp_f32 v61, v61
    v_rcp_f32 v62, v62
    s_add_u32 s62, s47, 45056
    buffer_load_dwordx4 a[176:179], v7, s[24:27], s62 offen offset:0 sc1
    v_rcp_f32 v63, v63
    v_rcp_f32 v64, v64
    v_rcp_f32 v65, v65
    v_rcp_f32 v66, v66
    v_rcp_f32 v67, v67
    v_pk_mul_f32 v[128:129], v[128:129], v[56:57]
    v_pk_mul_f32 v[132:133], v[132:133], v[58:59]
    buffer_load_dwordx4 a[180:183], v7, s[24:27], s62 offen offset:1024 sc1
    v_pk_mul_f32 v[136:137], v[136:137], v[60:61]
    v_pk_mul_f32 v[140:141], v[140:141], v[62:63]
    v_pk_mul_f32 v[144:145], v[144:145], v[64:65]
    v_pk_mul_f32 v[148:149], v[148:149], v[66:67]
    v_cvt_pk_bf16_f32 v76, v128, v129
    v_cvt_pk_bf16_f32 v77, v132, v133
    v_cvt_pk_bf16_f32 v78, v136, v137
    v_cvt_pk_bf16_f32 v71, v136, v137
    v_cvt_pk_bf16_f32 v68, v128, v129
    v_permlane16_swap_b32 v76, v77
    v_cvt_pk_bf16_f32 v69, v132, v133
    v_permlane16_swap_b32 v78, v71
    buffer_load_dwordx4 a[184:187], v7, s[24:27], s62 offen offset:2048 sc1
    v_cvt_pk_bf16_f32 v70, v136, v137
    s_add_u32 s6, s36, 29556736
    v_permlane32_swap_b32 v77, v71
    s_mov_b64 exec, s[64:65]
    buffer_store_dwordx4 v[68:71], v7, s[24:27], s6 offen sc1
    s_mov_b64 exec, -1
    v_cvt_pk_bf16_f32 v76, v140, v141
    v_cvt_pk_bf16_f32 v77, v144, v145
    v_cvt_pk_bf16_f32 v78, v148, v149
    v_cvt_pk_bf16_f32 v75, v148, v149
    v_cvt_pk_bf16_f32 v72, v140, v141
    v_permlane16_swap_b32 v76, v77
    v_cvt_pk_bf16_f32 v73, v144, v145
    v_permlane16_swap_b32 v78, v75
    v_cvt_pk_bf16_f32 v74, v148, v149
    buffer_load_dwordx4 a[188:191], v7, s[24:27], s62 offen offset:3072 sc1
    s_add_u32 s6, s36, 29605888
    v_permlane32_swap_b32 v77, v75
    s_mov_b64 exec, s[64:65]
    buffer_store_dwordx4 v[72:75], v7, s[24:27], s6 offen sc1
    s_mov_b64 exec, -1
    v_pk_fma_f32 v[152:153], v[50:51], v[20:21], v[152:153] op_sel:[0,0,0] op_sel_hi:[0,1,1]
    v_pk_fma_f32 v[156:157], v[50:51], v[24:25], v[156:157] op_sel:[0,0,0] op_sel_hi:[0,1,1]
    v_pk_fma_f32 v[160:161], v[50:51], v[28:29], v[160:161] op_sel:[0,0,0] op_sel_hi:[0,1,1]
    v_pk_fma_f32 v[164:165], v[52:53], v[20:21], v[164:165] op_sel:[1,0,0] op_sel_hi:[1,1,1]
    v_pk_fma_f32 v[168:169], v[52:53], v[24:25], v[168:169] op_sel:[1,0,0] op_sel_hi:[1,1,1]
    v_pk_fma_f32 v[172:173], v[52:53], v[28:29], v[172:173] op_sel:[1,0,0] op_sel_hi:[1,1,1]
    v_pk_mul_f32 v[56:57], v[152:153], v[50:51] op_sel:[0,1] op_sel_hi:[1,1]
    v_pk_mul_f32 v[58:59], v[156:157], v[50:51] op_sel:[0,1] op_sel_hi:[1,1]
    v_pk_mul_f32 v[60:61], v[160:161], v[50:51] op_sel:[0,1] op_sel_hi:[1,1]
    v_pk_mul_f32 v[62:63], v[164:165], v[54:55] op_sel:[0,0] op_sel_hi:[1,0]
    s_add_u32 s62, s47, 49152
    buffer_load_dwordx4 a[192:195], v7, s[24:27], s62 offen offset:0 sc1
    v_pk_mul_f32 v[64:65], v[168:169], v[54:55] op_sel:[0,0] op_sel_hi:[1,0]
    v_pk_mul_f32 v[66:67], v[172:173], v[54:55] op_sel:[0,0] op_sel_hi:[1,0]
    v_pk_fma_f32 v[154:155], v[50:51], v[22:23], v[154:155] op_sel:[0,0,0] op_sel_hi:[0,1,1]
    v_pk_fma_f32 v[158:159], v[50:51], v[26:27], v[158:159] op_sel:[0,0,0] op_sel_hi:[0,1,1]
    v_pk_fma_f32 v[162:163], v[50:51], v[30:31], v[162:163] op_sel:[0,0,0] op_sel_hi:[0,1,1]
    v_pk_fma_f32 v[166:167], v[52:53], v[22:23], v[166:167] op_sel:[1,0,0] op_sel_hi:[1,1,1]
    v_pk_fma_f32 v[170:171], v[52:53], v[26:27], v[170:171] op_sel:[1,0,0] op_sel_hi:[1,1,1]
    v_pk_fma_f32 v[174:175], v[52:53], v[30:31], v[174:175] op_sel:[1,0,0] op_sel_hi:[1,1,1]
    v_exp_f32 v56, v56
    v_exp_f32 v57, v57
    buffer_load_dwordx4 a[196:199], v7, s[24:27], s62 offen offset:1024 sc1
    v_exp_f32 v58, v58
    v_exp_f32 v59, v59
    v_exp_f32 v60, v60
    v_exp_f32 v61, v61
    v_exp_f32 v62, v62
    v_exp_f32 v63, v63
    buffer_load_dwordx4 a[200:203], v7, s[24:27], s62 offen offset:2048 sc1
    v_exp_f32 v64, v64
    v_exp_f32 v65, v65
    v_exp_f32 v66, v66
    v_exp_f32 v67, v67
    v_pk_mul_f32 v[152:153], v[152:153], v[154:155]
    v_pk_mul_f32 v[156:157], v[156:157], v[158:159]
    v_pk_mul_f32 v[160:161], v[160:161], v[162:163]
    v_pk_mul_f32 v[164:165], v[164:165], v[166:167]
    buffer_load_dwordx4 a[204:207], v7, s[24:27], s62 offen offset:3072 sc1
    v_pk_mul_f32 v[168:169], v[168:169], v[170:171]
    v_pk_mul_f32 v[172:173], v[172:173], v[174:175]
    v_pk_fma_f32 v[56:57], v[56:57], v[52:53], v[52:53] op_sel:[0,0,0] op_sel_hi:[1,0,0]
    v_pk_fma_f32 v[58:59], v[58:59], v[52:53], v[52:53] op_sel:[0,0,0] op_sel_hi:[1,0,0]
    v_pk_fma_f32 v[60:61], v[60:61], v[52:53], v[52:53] op_sel:[0,0,0] op_sel_hi:[1,0,0]
    v_pk_fma_f32 v[62:63], v[62:63], v[54:55], v[54:55] op_sel:[0,1,1] op_sel_hi:[1,1,1]
    v_pk_fma_f32 v[64:65], v[64:65], v[54:55], v[54:55] op_sel:[0,1,1] op_sel_hi:[1,1,1]
    v_pk_fma_f32 v[66:67], v[66:67], v[54:55], v[54:55] op_sel:[0,1,1] op_sel_hi:[1,1,1]
    v_rcp_f32 v56, v56
    v_rcp_f32 v57, v57
    s_add_u32 s62, s47, 53248
    buffer_load_dwordx4 a[208:211], v7, s[24:27], s62 offen offset:0 sc1
    v_rcp_f32 v58, v58
    v_rcp_f32 v59, v59
    v_rcp_f32 v60, v60
    v_rcp_f32 v61, v61
    v_rcp_f32 v62, v62
    v_rcp_f32 v63, v63
    buffer_load_dwordx4 a[212:215], v7, s[24:27], s62 offen offset:1024 sc1
    v_rcp_f32 v64, v64
    v_rcp_f32 v65, v65
    v_rcp_f32 v66, v66
    v_rcp_f32 v67, v67
    v_pk_mul_f32 v[152:153], v[152:153], v[56:57]
    v_pk_mul_f32 v[156:157], v[156:157], v[58:59]
    v_pk_mul_f32 v[160:161], v[160:161], v[60:61]
    v_pk_mul_f32 v[164:165], v[164:165], v[62:63]
    buffer_load_dwordx4 a[216:219], v7, s[24:27], s62 offen offset:2048 sc1
    v_pk_mul_f32 v[168:169], v[168:169], v[64:65]
    v_pk_mul_f32 v[172:173], v[172:173], v[66:67]
    v_cvt_pk_bf16_f32 v76, v152, v153
    v_cvt_pk_bf16_f32 v77, v156, v157
    v_cvt_pk_bf16_f32 v78, v160, v161
    v_cvt_pk_bf16_f32 v71, v160, v161
    v_cvt_pk_bf16_f32 v68, v152, v153
    v_permlane16_swap_b32 v76, v77
    v_cvt_pk_bf16_f32 v69, v156, v157
    v_permlane16_swap_b32 v78, v71
    v_cvt_pk_bf16_f32 v70, v160, v161
    s_add_u32 s6, s36, 29655040
    buffer_load_dwordx4 a[220:223], v7, s[24:27], s62 offen offset:3072 sc1
    v_permlane32_swap_b32 v77, v71
    s_mov_b64 exec, s[64:65]
    buffer_store_dwordx4 v[68:71], v7, s[24:27], s6 offen sc1
    s_mov_b64 exec, -1
    v_cvt_pk_bf16_f32 v76, v164, v165
    v_cvt_pk_bf16_f32 v77, v168, v169
    v_cvt_pk_bf16_f32 v78, v172, v173
    v_cvt_pk_bf16_f32 v75, v172, v173
    v_cvt_pk_bf16_f32 v72, v164, v165
    v_permlane16_swap_b32 v76, v77
    v_cvt_pk_bf16_f32 v73, v168, v169
    v_permlane16_swap_b32 v78, v75
    v_cvt_pk_bf16_f32 v74, v172, v173
    s_add_u32 s6, s36, 29704192
    v_permlane32_swap_b32 v77, v75
    s_add_u32 s62, s47, 57344
    buffer_load_dwordx4 a[224:227], v7, s[24:27], s62 offen offset:0 sc1
    s_mov_b64 exec, s[64:65]
    buffer_store_dwordx4 v[72:75], v7, s[24:27], s6 offen sc1
    s_mov_b64 exec, -1
    s_barrier
    ds_read_b128 v[176:179], v4 offset:0
    ds_read_b128 v[180:183], v4 offset:1024
    ds_read_b128 v[184:187], v4 offset:2048
    ds_read_b128 v[188:191], v4 offset:3072
    ds_read_b128 v[192:195], v4 offset:4096
    ds_read_b128 v[196:199], v4 offset:5120
    s_waitcnt vmcnt(42)
    s_waitcnt lgkmcnt(5)
    v_mfma_f32_16x16x32_bf16 v[128:131], v[176:179], v[80:83], 0
    ds_read_b128 v[200:203], v4 offset:6144
    v_mfma_f32_16x16x32_bf16 v[148:151], v[176:179], v[92:95], 0
    s_waitcnt lgkmcnt(5)
    v_mfma_f32_16x16x32_bf16 v[132:135], v[180:183], v[80:83], 0
    ds_read_b128 v[204:207], v4 offset:7168
    buffer_load_dwordx4 a[228:231], v7, s[24:27], s62 offen offset:1024 sc1
    v_mfma_f32_16x16x32_bf16 v[152:155], v[180:183], v[92:95], 0
    s_waitcnt lgkmcnt(5)
    v_mfma_f32_16x16x32_bf16 v[136:139], v[184:187], v[80:83], 0
    ds_read_b128 v[176:179], v4 offset:8192
    v_mfma_f32_16x16x32_bf16 v[156:159], v[184:187], v[92:95], 0
    buffer_load_dwordx4 a[232:235], v7, s[24:27], s62 offen offset:2048 sc1
    s_waitcnt lgkmcnt(5)
    v_mfma_f32_16x16x32_bf16 v[140:143], v[188:191], v[80:83], 0
    ds_read_b128 v[180:183], v4 offset:9216
    v_mfma_f32_16x16x32_bf16 v[160:163], v[188:191], v[92:95], 0
    s_waitcnt lgkmcnt(5)
    v_mfma_f32_16x16x32_bf16 v[144:147], v[192:195], v[80:83], 0
    ds_read_b128 v[184:187], v4 offset:10240
    buffer_load_dwordx4 a[236:239], v7, s[24:27], s62 offen offset:3072 sc1
    v_mfma_f32_16x16x32_bf16 v[164:167], v[192:195], v[92:95], 0
    s_waitcnt vmcnt(44)
    s_waitcnt lgkmcnt(5)
    v_mfma_f32_16x16x32_bf16 v[128:131], v[196:199], v[84:87], v[128:131]
    ds_read_b128 v[188:191], v4 offset:11264
    v_mfma_f32_16x16x32_bf16 v[148:151], v[196:199], v[96:99], v[148:151]
    s_waitcnt lgkmcnt(5)
    v_mfma_f32_16x16x32_bf16 v[132:135], v[200:203], v[84:87], v[132:135]
    ds_read_b128 v[192:195], v4 offset:12288
    v_mfma_f32_16x16x32_bf16 v[152:155], v[200:203], v[96:99], v[152:155]
    s_waitcnt lgkmcnt(5)
    v_mfma_f32_16x16x32_bf16 v[136:139], v[204:207], v[84:87], v[136:139]
    ds_read_b128 v[196:199], v4 offset:13312
    v_mfma_f32_16x16x32_bf16 v[156:159], v[204:207], v[96:99], v[156:159]
    s_waitcnt lgkmcnt(5)
    v_mfma_f32_16x16x32_bf16 v[140:143], v[176:179], v[84:87], v[140:143]
    ds_read_b128 v[200:203], v4 offset:14336
    v_mfma_f32_16x16x32_bf16 v[160:163], v[176:179], v[96:99], v[160:163]
    s_waitcnt lgkmcnt(5)
    v_mfma_f32_16x16x32_bf16 v[144:147], v[180:183], v[84:87], v[144:147]
    ds_read_b128 v[204:207], v4 offset:15360
    v_mfma_f32_16x16x32_bf16 v[164:167], v[180:183], v[96:99], v[164:167]
    s_waitcnt vmcnt(43)
    s_waitcnt lgkmcnt(5)
    v_mfma_f32_16x16x32_bf16 v[128:131], v[184:187], v[88:91], v[128:131]
    ds_read_b128 v[176:179], v4 offset:16384
    v_mfma_f32_16x16x32_bf16 v[148:151], v[184:187], v[100:103], v[148:151]
    s_waitcnt lgkmcnt(5)
    v_mfma_f32_16x16x32_bf16 v[132:135], v[188:191], v[88:91], v[132:135]
    ds_read_b128 v[180:183], v4 offset:17408
    v_mfma_f32_16x16x32_bf16 v[152:155], v[188:191], v[100:103], v[152:155]
    s_waitcnt lgkmcnt(5)
    v_mfma_f32_16x16x32_bf16 v[136:139], v[192:195], v[88:91], v[136:139]
    ds_read_b128 v[184:187], v4 offset:18432
    v_mfma_f32_16x16x32_bf16 v[156:159], v[192:195], v[100:103], v[156:159]
    s_waitcnt lgkmcnt(5)
    v_mfma_f32_16x16x32_bf16 v[140:143], v[196:199], v[88:91], v[140:143]
    ds_read_b128 v[188:191], v4 offset:19456
    v_mfma_f32_16x16x32_bf16 v[160:163], v[196:199], v[100:103], v[160:163]
    s_waitcnt lgkmcnt(5)
    v_mfma_f32_16x16x32_bf16 v[144:147], v[200:203], v[88:91], v[144:147]
    ds_read_b128 v[192:195], v4 offset:20480
    v_mfma_f32_16x16x32_bf16 v[164:167], v[200:203], v[100:103], v[164:167]
    s_waitcnt vmcnt(39)
    s_waitcnt lgkmcnt(5)
    v_mfma_f32_16x16x32_bf16 v[128:131], v[204:207], v[104:107], v[128:131]
    ds_read_b128 v[196:199], v4 offset:21504
    v_mfma_f32_16x16x32_bf16 v[148:151], v[204:207], v[116:119], v[148:151]
    s_waitcnt lgkmcnt(5)
    v_mfma_f32_16x16x32_bf16 v[132:135], v[176:179], v[104:107], v[132:135]
    ds_read_b128 v[200:203], v4 offset:22528
    v_mfma_f32_16x16x32_bf16 v[152:155], v[176:179], v[116:119], v[152:155]
    s_waitcnt vmcnt(3)
    s_add_u32 s3, s66, 15466496
    s_mov_b64 exec, 1
    buffer_store_dwordx2 v[2:3], off, s[24:27], s3 sc1
    s_mov_b64 exec, -1
    s_waitcnt lgkmcnt(5)
    v_mfma_f32_16x16x32_bf16 v[136:139], v[180:183], v[104:107], v[136:139]
    ds_read_b128 v[204:207], v4 offset:23552
    v_mfma_f32_16x16x32_bf16 v[156:159], v[180:183], v[116:119], v[156:159]
    s_waitcnt lgkmcnt(5)
    v_mfma_f32_16x16x32_bf16 v[140:143], v[184:187], v[104:107], v[140:143]
    ds_read_b128 v[176:179], v4 offset:24576
    v_mfma_f32_16x16x32_bf16 v[160:163], v[184:187], v[116:119], v[160:163]
    s_waitcnt lgkmcnt(5)
    v_mfma_f32_16x16x32_bf16 v[144:147], v[188:191], v[104:107], v[144:147]
    ds_read_b128 v[180:183], v4 offset:25600
    v_mfma_f32_16x16x32_bf16 v[164:167], v[188:191], v[116:119], v[164:167]
    s_waitcnt lgkmcnt(5)
    v_mfma_f32_16x16x32_bf16 v[128:131], v[192:195], v[108:111], v[128:131]
    ds_read_b128 v[184:187], v4 offset:26624
    v_mfma_f32_16x16x32_bf16 v[148:151], v[192:195], v[120:123], v[148:151]
    s_waitcnt lgkmcnt(5)
    v_mfma_f32_16x16x32_bf16 v[132:135], v[196:199], v[108:111], v[132:135]
    v_mfma_f32_16x16x32_bf16 v[152:155], v[196:199], v[120:123], v[152:155]
    s_waitcnt lgkmcnt(4)
    v_mfma_f32_16x16x32_bf16 v[136:139], v[200:203], v[108:111], v[136:139]
    v_mfma_f32_16x16x32_bf16 v[156:159], v[200:203], v[120:123], v[156:159]
    s_waitcnt lgkmcnt(3)
    v_mfma_f32_16x16x32_bf16 v[140:143], v[204:207], v[108:111], v[140:143]
    v_mfma_f32_16x16x32_bf16 v[160:163], v[204:207], v[120:123], v[160:163]
    s_waitcnt lgkmcnt(2)
    v_mfma_f32_16x16x32_bf16 v[144:147], v[176:179], v[108:111], v[144:147]
    v_mfma_f32_16x16x32_bf16 v[164:167], v[176:179], v[120:123], v[164:167]
    s_waitcnt lgkmcnt(1)
    v_mfma_f32_16x16x32_bf16 v[128:131], v[180:183], v[112:115], v[128:131]
    v_mfma_f32_16x16x32_bf16 v[148:151], v[180:183], v[124:127], v[148:151]
    s_waitcnt lgkmcnt(0)
    v_mfma_f32_16x16x32_bf16 v[132:135], v[184:187], v[112:115], v[132:135]
    v_mfma_f32_16x16x32_bf16 v[152:155], v[184:187], v[124:127], v[152:155]
    v_mfma_f32_16x16x32_bf16 v[136:139], a[108:111], v[112:115], v[136:139]
    v_mfma_f32_16x16x32_bf16 v[156:159], a[108:111], v[124:127], v[156:159]
    v_mfma_f32_16x16x32_bf16 v[140:143], a[112:115], v[112:115], v[140:143]
    v_mfma_f32_16x16x32_bf16 v[160:163], a[112:115], v[124:127], v[160:163]
    v_mfma_f32_16x16x32_bf16 v[144:147], a[116:119], v[112:115], v[144:147]
    v_mfma_f32_16x16x32_bf16 v[164:167], a[116:119], v[124:127], v[164:167]
    v_mfma_f32_16x16x32_bf16 v[128:131], a[120:123], v[208:211], v[128:131]
    v_mfma_f32_16x16x32_bf16 v[148:151], a[120:123], v[220:223], v[148:151]
    v_mfma_f32_16x16x32_bf16 v[132:135], a[124:127], v[208:211], v[132:135]
    v_mfma_f32_16x16x32_bf16 v[152:155], a[124:127], v[220:223], v[152:155]
    v_mfma_f32_16x16x32_bf16 v[136:139], a[128:131], v[208:211], v[136:139]
    v_mfma_f32_16x16x32_bf16 v[156:159], a[128:131], v[220:223], v[156:159]
    v_mfma_f32_16x16x32_bf16 v[140:143], a[132:135], v[208:211], v[140:143]
    v_mfma_f32_16x16x32_bf16 v[160:163], a[132:135], v[220:223], v[160:163]
    v_mfma_f32_16x16x32_bf16 v[144:147], a[136:139], v[208:211], v[144:147]
    v_mfma_f32_16x16x32_bf16 v[164:167], a[136:139], v[220:223], v[164:167]
    v_mfma_f32_16x16x32_bf16 v[128:131], a[140:143], v[212:215], v[128:131]
    v_mfma_f32_16x16x32_bf16 v[148:151], a[140:143], v[224:227], v[148:151]
    v_mfma_f32_16x16x32_bf16 v[132:135], a[144:147], v[212:215], v[132:135]
    v_mfma_f32_16x16x32_bf16 v[152:155], a[144:147], v[224:227], v[152:155]
    v_mfma_f32_16x16x32_bf16 v[136:139], a[148:151], v[212:215], v[136:139]
    v_mfma_f32_16x16x32_bf16 v[156:159], a[148:151], v[224:227], v[156:159]
    v_mfma_f32_16x16x32_bf16 v[140:143], a[152:155], v[212:215], v[140:143]
    v_mfma_f32_16x16x32_bf16 v[160:163], a[152:155], v[224:227], v[160:163]
    v_mfma_f32_16x16x32_bf16 v[144:147], a[156:159], v[212:215], v[144:147]
    v_mfma_f32_16x16x32_bf16 v[164:167], a[156:159], v[224:227], v[164:167]
    v_mfma_f32_16x16x32_bf16 v[128:131], a[160:163], v[216:219], v[128:131]
    v_mfma_f32_16x16x32_bf16 v[148:151], a[160:163], v[228:231], v[148:151]
    v_mfma_f32_16x16x32_bf16 v[132:135], a[164:167], v[216:219], v[132:135]
    v_mfma_f32_16x16x32_bf16 v[152:155], a[164:167], v[228:231], v[152:155]
    v_mfma_f32_16x16x32_bf16 v[136:139], a[168:171], v[216:219], v[136:139]
    v_mfma_f32_16x16x32_bf16 v[156:159], a[168:171], v[228:231], v[156:159]
    v_mfma_f32_16x16x32_bf16 v[140:143], a[172:175], v[216:219], v[140:143]
    v_mfma_f32_16x16x32_bf16 v[160:163], a[172:175], v[228:231], v[160:163]
    s_add_u32 s33, s67, 15466496
    s_mov_b64 exec, 0xffff
    buffer_load_dwordx2 v[10:11], v9, s[24:27], s33 offen sc1
    s_mov_b64 exec, -1
    v_mfma_f32_16x16x32_bf16 v[144:147], a[176:179], v[216:219], v[144:147]
    v_mfma_f32_16x16x32_bf16 v[164:167], a[176:179], v[228:231], v[164:167]
    v_mfma_f32_16x16x32_bf16 v[128:131], a[180:183], v[232:235], v[128:131]
    v_mfma_f32_16x16x32_bf16 v[148:151], a[180:183], v[244:247], v[148:151]
    v_mfma_f32_16x16x32_bf16 v[132:135], a[184:187], v[232:235], v[132:135]
    v_mfma_f32_16x16x32_bf16 v[152:155], a[184:187], v[244:247], v[152:155]
    v_mfma_f32_16x16x32_bf16 v[136:139], a[188:191], v[232:235], v[136:139]
    v_mfma_f32_16x16x32_bf16 v[156:159], a[188:191], v[244:247], v[156:159]
    v_mfma_f32_16x16x32_bf16 v[140:143], a[192:195], v[232:235], v[140:143]
    v_mfma_f32_16x16x32_bf16 v[160:163], a[192:195], v[244:247], v[160:163]
    v_mfma_f32_16x16x32_bf16 v[144:147], a[196:199], v[232:235], v[144:147]
    v_mfma_f32_16x16x32_bf16 v[164:167], a[196:199], v[244:247], v[164:167]
    v_mfma_f32_16x16x32_bf16 v[128:131], a[200:203], v[236:239], v[128:131]
    v_mfma_f32_16x16x32_bf16 v[148:151], a[200:203], v[248:251], v[148:151]
    v_mfma_f32_16x16x32_bf16 v[132:135], a[204:207], v[236:239], v[132:135]
    v_mfma_f32_16x16x32_bf16 v[152:155], a[204:207], v[248:251], v[152:155]
    v_mfma_f32_16x16x32_bf16 v[136:139], a[208:211], v[236:239], v[136:139]
    v_mfma_f32_16x16x32_bf16 v[156:159], a[208:211], v[248:251], v[156:159]
    v_mfma_f32_16x16x32_bf16 v[140:143], a[212:215], v[236:239], v[140:143]
    v_mfma_f32_16x16x32_bf16 v[160:163], a[212:215], v[248:251], v[160:163]
    v_mfma_f32_16x16x32_bf16 v[144:147], a[216:219], v[236:239], v[144:147]
    v_mfma_f32_16x16x32_bf16 v[164:167], a[216:219], v[248:251], v[164:167]
    v_mfma_f32_16x16x32_bf16 v[128:131], a[220:223], v[240:243], v[128:131]
    v_mfma_f32_16x16x32_bf16 v[148:151], a[220:223], v[252:255], v[148:151]
    v_mfma_f32_16x16x32_bf16 v[132:135], a[224:227], v[240:243], v[132:135]
    v_mfma_f32_16x16x32_bf16 v[152:155], a[224:227], v[252:255], v[152:155]
    s_waitcnt vmcnt(4)
    v_mfma_f32_16x16x32_bf16 v[136:139], a[228:231], v[240:243], v[136:139]
    v_mfma_f32_16x16x32_bf16 v[156:159], a[228:231], v[252:255], v[156:159]
    s_waitcnt vmcnt(3)
    v_mfma_f32_16x16x32_bf16 v[140:143], a[232:235], v[240:243], v[140:143]
    v_mfma_f32_16x16x32_bf16 v[160:163], a[232:235], v[252:255], v[160:163]
    s_waitcnt vmcnt(2)
    v_mfma_f32_16x16x32_bf16 v[144:147], a[236:239], v[240:243], v[144:147]
    s_waitcnt vmcnt(0)
    s_mov_b64 exec, 0xffff
    s_branch Lpo_interleave_layers__ssm_conv_h3__swiglu_ffn__prompt_kernel_59
Lpr_interleave_layers__ssm_conv_h3__swiglu_ffn__prompt_kernel_58:
    s_sleep 2
    buffer_load_dwordx2 v[10:11], v9, s[24:27], s33 offen sc1
    s_waitcnt vmcnt(0)
    s_sub_u32 s58, s58, 1
    s_cbranch_scc1 Lk2_end
Lpo_interleave_layers__ssm_conv_h3__swiglu_ffn__prompt_kernel_59:
    v_cmp_ne_u64 vcc, v[2:3], v[10:11]
    s_cbranch_vccnz Lpr_interleave_layers__ssm_conv_h3__swiglu_ffn__prompt_kernel_58
    s_mov_b64 exec, -1
    s_add_u32 s32, s35, 29562880
    buffer_load_dwordx4 v[80:83], v7, s[24:27], s32 offen offset:0 sc1
    buffer_load_dwordx4 v[84:87], v7, s[24:27], s32 offen offset:1024 sc1
    buffer_load_dwordx4 v[88:91], v7, s[24:27], s32 offen offset:2048 sc1
    s_add_u32 s32, s35, 29612032
    buffer_load_dwordx4 v[92:95], v7, s[24:27], s32 offen offset:0 sc1
    buffer_load_dwordx4 v[96:99], v7, s[24:27], s32 offen offset:1024 sc1
    buffer_load_dwordx4 v[100:103], v7, s[24:27], s32 offen offset:2048 sc1
    v_mfma_f32_16x16x32_bf16 v[164:167], a[236:239], v[252:255], v[164:167]
    s_mul_i32 s3, s40, 10240
    v_add_u32 v72, s3, v7
    ds_write_b128 v72, v[128:131] offset:0
    ds_write_b128 v72, v[132:135] offset:1024
    ds_write_b128 v72, v[136:139] offset:2048
    ds_write_b128 v72, v[140:143] offset:3072
    ds_write_b128 v72, v[144:147] offset:4096
    ds_write_b128 v72, v[148:151] offset:5120
    s_add_u32 s32, s35, 29565952
    buffer_load_dwordx4 v[104:107], v7, s[24:27], s32 offen offset:0 sc1
    ds_write_b128 v72, v[152:155] offset:6144
    ds_write_b128 v72, v[156:159] offset:7168
    ds_write_b128 v72, v[160:163] offset:8192
    ds_write_b128 v72, v[164:167] offset:9216
    v_lshlrev_b32 v56, 16, v32
    v_and_b32 v57, 0xffff0000, v32
    v_lshlrev_b32 v58, 16, v33
    v_and_b32 v59, 0xffff0000, v33
    v_lshlrev_b32 v60, 16, v34
    v_and_b32 v61, 0xffff0000, v34
    v_lshlrev_b32 v62, 16, v35
    v_and_b32 v63, 0xffff0000, v35
    buffer_load_dwordx4 v[108:111], v7, s[24:27], s32 offen offset:1024 sc1
    v_lshlrev_b32 v64, 16, v36
    v_and_b32 v65, 0xffff0000, v36
    v_lshlrev_b32 v66, 16, v37
    v_and_b32 v67, 0xffff0000, v37
    s_waitcnt lgkmcnt(0)
    s_barrier
    ds_read_b128 v[128:131], v14 offset:0
    ds_read_b128 v[132:135], v14 offset:10240
    ds_read_b128 v[136:139], v14 offset:20480
    ds_read_b128 v[140:143], v14 offset:30720
    ds_read_b128 v[144:147], v14 offset:1024
    ds_read_b128 v[148:151], v14 offset:11264
    ds_read_b128 v[152:155], v14 offset:21504
    buffer_load_dwordx4 v[112:115], v7, s[24:27], s32 offen offset:2048 sc1
    ds_read_b128 v[156:159], v14 offset:31744
    ds_read_b128 v[160:163], v15 offset:0
    ds_read_b128 v[164:167], v15 offset:10240
    ds_read_b128 v[168:171], v15 offset:20480
    ds_read_b128 v[172:175], v15 offset:30720
    s_waitcnt lgkmcnt(8)
    v_pk_add_f32 v[128:129], v[128:129], v[132:133]
    v_pk_add_f32 v[130:131], v[130:131], v[134:135]
    v_pk_add_f32 v[136:137], v[136:137], v[140:141]
    v_pk_add_f32 v[138:139], v[138:139], v[142:143]
    s_waitcnt lgkmcnt(4)
    v_pk_add_f32 v[144:145], v[144:145], v[148:149]
    v_pk_add_f32 v[146:147], v[146:147], v[150:151]
    v_pk_add_f32 v[152:153], v[152:153], v[156:157]
    s_add_u32 s32, s35, 29615104
    buffer_load_dwordx4 v[116:119], v7, s[24:27], s32 offen offset:0 sc1
    v_pk_add_f32 v[154:155], v[154:155], v[158:159]
    s_waitcnt lgkmcnt(0)
    v_pk_add_f32 v[160:161], v[160:161], v[164:165]
    v_pk_add_f32 v[162:163], v[162:163], v[166:167]
    v_pk_add_f32 v[168:169], v[168:169], v[172:173]
    v_pk_add_f32 v[170:171], v[170:171], v[174:175]
    v_pk_add_f32 v[128:129], v[128:129], v[136:137]
    v_pk_add_f32 v[130:131], v[130:131], v[138:139]
    v_pk_add_f32 v[144:145], v[144:145], v[152:153]
    v_pk_add_f32 v[146:147], v[146:147], v[154:155]
    v_pk_add_f32 v[160:161], v[160:161], v[168:169]
    v_pk_add_f32 v[162:163], v[162:163], v[170:171]
    v_cvt_pk_bf16_f32 v132, v128, v129
    buffer_load_dwordx4 v[120:123], v7, s[24:27], s32 offen offset:1024 sc1
    v_cvt_pk_bf16_f32 v133, v130, v131
    v_cvt_pk_bf16_f32 v148, v144, v145
    v_cvt_pk_bf16_f32 v149, v146, v147
    v_cvt_pk_bf16_f32 v164, v160, v161
    v_cvt_pk_bf16_f32 v165, v162, v163
    v_lshlrev_b32 v128, 16, v132
    v_and_b32 v129, 0xffff0000, v132
    v_lshlrev_b32 v130, 16, v133
    v_and_b32 v131, 0xffff0000, v133
    v_lshlrev_b32 v144, 16, v148
    v_and_b32 v145, 0xffff0000, v148
    v_lshlrev_b32 v146, 16, v149
    buffer_load_dwordx4 v[124:127], v7, s[24:27], s32 offen offset:2048 sc1
    v_and_b32 v147, 0xffff0000, v149
    v_lshlrev_b32 v160, 16, v164
    v_and_b32 v161, 0xffff0000, v164
    v_lshlrev_b32 v162, 16, v165
    v_and_b32 v163, 0xffff0000, v165
    v_pk_add_f32 v[128:129], v[128:129], v[56:57]
    v_pk_add_f32 v[130:131], v[130:131], v[58:59]
    v_pk_add_f32 v[144:145], v[144:145], v[60:61]
    v_pk_add_f32 v[146:147], v[146:147], v[62:63]
    v_pk_add_f32 v[160:161], v[160:161], v[64:65]
    v_pk_add_f32 v[162:163], v[162:163], v[66:67]
    v_cvt_pk_bf16_f32 v32, v128, v129
    s_add_u32 s32, s35, 29556736
    buffer_load_dwordx4 v[208:211], v7, s[24:27], s32 offen offset:0 sc1
    v_cvt_pk_bf16_f32 v33, v130, v131
    v_cvt_pk_bf16_f32 v34, v144, v145
    v_cvt_pk_bf16_f32 v35, v146, v147
    v_cvt_pk_bf16_f32 v36, v160, v161
    v_cvt_pk_bf16_f32 v37, v162, v163
    s_mov_b32 s3, 0
    buffer_store_dwordx4 v[32:35], v16, s[16:19], s3 offen
    buffer_store_dwordx2 v[36:37], v17, s[16:19], s3 offen
    ds_read_b128 v[176:179], v4 offset:0
    ds_read_b128 v[180:183], v4 offset:1024
    ds_read_b128 v[184:187], v4 offset:2048
    ds_read_b128 v[188:191], v4 offset:3072
    ds_read_b128 v[192:195], v4 offset:4096
    ds_read_b128 v[196:199], v4 offset:5120
    s_waitcnt vmcnt(11)
    v_mfma_f32_16x16x32_bf16 v[128:131], a[120:123], v[80:83], 0
    buffer_load_dwordx4 v[212:215], v7, s[24:27], s32 offen offset:1024 sc1
    v_mfma_f32_16x16x32_bf16 v[148:151], a[120:123], v[92:95], 0
    v_mfma_f32_16x16x32_bf16 v[132:135], a[124:127], v[80:83], 0
    v_mfma_f32_16x16x32_bf16 v[152:155], a[124:127], v[92:95], 0
    buffer_load_dwordx4 v[216:219], v7, s[24:27], s32 offen offset:2048 sc1
    v_mfma_f32_16x16x32_bf16 v[136:139], a[128:131], v[80:83], 0
    v_mfma_f32_16x16x32_bf16 v[156:159], a[128:131], v[92:95], 0
    v_mfma_f32_16x16x32_bf16 v[140:143], a[132:135], v[80:83], 0
    s_add_u32 s32, s35, 29605888
    buffer_load_dwordx4 v[220:223], v7, s[24:27], s32 offen offset:0 sc1
    v_mfma_f32_16x16x32_bf16 v[160:163], a[132:135], v[92:95], 0
    v_mfma_f32_16x16x32_bf16 v[144:147], a[136:139], v[80:83], 0
    v_mfma_f32_16x16x32_bf16 v[164:167], a[136:139], v[92:95], 0
    buffer_load_dwordx4 v[224:227], v7, s[24:27], s32 offen offset:1024 sc1
    s_waitcnt vmcnt(14)
    v_mfma_f32_16x16x32_bf16 v[128:131], a[140:143], v[84:87], v[128:131]
    v_mfma_f32_16x16x32_bf16 v[148:151], a[140:143], v[96:99], v[148:151]
    v_mfma_f32_16x16x32_bf16 v[132:135], a[144:147], v[84:87], v[132:135]
    buffer_load_dwordx4 v[228:231], v7, s[24:27], s32 offen offset:2048 sc1
    v_mfma_f32_16x16x32_bf16 v[152:155], a[144:147], v[96:99], v[152:155]
    v_mfma_f32_16x16x32_bf16 v[136:139], a[148:151], v[84:87], v[136:139]
    v_mfma_f32_16x16x32_bf16 v[156:159], a[148:151], v[96:99], v[156:159]
    s_add_u32 s32, s35, 29559808
    buffer_load_dwordx4 v[232:235], v7, s[24:27], s32 offen offset:0 sc1
    v_mfma_f32_16x16x32_bf16 v[140:143], a[152:155], v[84:87], v[140:143]
    v_mfma_f32_16x16x32_bf16 v[160:163], a[152:155], v[96:99], v[160:163]
    v_mfma_f32_16x16x32_bf16 v[144:147], a[156:159], v[84:87], v[144:147]
    buffer_load_dwordx4 v[236:239], v7, s[24:27], s32 offen offset:1024 sc1
    v_mfma_f32_16x16x32_bf16 v[164:167], a[156:159], v[96:99], v[164:167]
    s_waitcnt vmcnt(16)
    v_mfma_f32_16x16x32_bf16 v[128:131], a[160:163], v[88:91], v[128:131]
    v_mfma_f32_16x16x32_bf16 v[148:151], a[160:163], v[100:103], v[148:151]
    buffer_load_dwordx4 v[240:243], v7, s[24:27], s32 offen offset:2048 sc1
    v_mfma_f32_16x16x32_bf16 v[132:135], a[164:167], v[88:91], v[132:135]
    s_barrier
    v_mfma_f32_16x16x32_bf16 v[152:155], a[164:167], v[100:103], v[152:155]
    v_mfma_f32_16x16x32_bf16 v[136:139], a[168:171], v[88:91], v[136:139]
    s_add_u32 s32, s35, 29608960
    buffer_load_dwordx4 v[244:247], v7, s[24:27], s32 offen offset:0 sc1
    v_mfma_f32_16x16x32_bf16 v[156:159], a[168:171], v[100:103], v[156:159]
    v_mfma_f32_16x16x32_bf16 v[140:143], a[172:175], v[88:91], v[140:143]
    v_mfma_f32_16x16x32_bf16 v[160:163], a[172:175], v[100:103], v[160:163]
    buffer_load_dwordx4 v[248:251], v7, s[24:27], s32 offen offset:1024 sc1
    v_mfma_f32_16x16x32_bf16 v[144:147], a[176:179], v[88:91], v[144:147]
    v_mfma_f32_16x16x32_bf16 v[164:167], a[176:179], v[100:103], v[164:167]
    s_waitcnt vmcnt(15)
    v_mfma_f32_16x16x32_bf16 v[128:131], a[180:183], v[104:107], v[128:131]
    buffer_load_dwordx4 v[252:255], v7, s[24:27], s32 offen offset:2048 sc1
    v_mfma_f32_16x16x32_bf16 v[148:151], a[180:183], v[116:119], v[148:151]
    v_mfma_f32_16x16x32_bf16 v[132:135], a[184:187], v[104:107], v[132:135]
    v_mfma_f32_16x16x32_bf16 v[152:155], a[184:187], v[116:119], v[152:155]
    v_mfma_f32_16x16x32_bf16 v[136:139], a[188:191], v[104:107], v[136:139]
    v_mfma_f32_16x16x32_bf16 v[156:159], a[188:191], v[116:119], v[156:159]
    v_mfma_f32_16x16x32_bf16 v[140:143], a[192:195], v[104:107], v[140:143]
    v_mfma_f32_16x16x32_bf16 v[160:163], a[192:195], v[116:119], v[160:163]
    v_mfma_f32_16x16x32_bf16 v[144:147], a[196:199], v[104:107], v[144:147]
    v_mfma_f32_16x16x32_bf16 v[164:167], a[196:199], v[116:119], v[164:167]
    s_waitcnt vmcnt(15)
    v_mfma_f32_16x16x32_bf16 v[128:131], a[200:203], v[108:111], v[128:131]
    v_mfma_f32_16x16x32_bf16 v[148:151], a[200:203], v[120:123], v[148:151]
    v_mfma_f32_16x16x32_bf16 v[132:135], a[204:207], v[108:111], v[132:135]
    v_mfma_f32_16x16x32_bf16 v[152:155], a[204:207], v[120:123], v[152:155]
    v_mfma_f32_16x16x32_bf16 v[136:139], a[208:211], v[108:111], v[136:139]
    v_mfma_f32_16x16x32_bf16 v[156:159], a[208:211], v[120:123], v[156:159]
    v_mfma_f32_16x16x32_bf16 v[140:143], a[212:215], v[108:111], v[140:143]
    v_mfma_f32_16x16x32_bf16 v[160:163], a[212:215], v[120:123], v[160:163]
    v_mfma_f32_16x16x32_bf16 v[144:147], a[216:219], v[108:111], v[144:147]
    v_mfma_f32_16x16x32_bf16 v[164:167], a[216:219], v[120:123], v[164:167]
    s_waitcnt vmcnt(14)
    v_mfma_f32_16x16x32_bf16 v[128:131], a[220:223], v[112:115], v[128:131]
    v_mfma_f32_16x16x32_bf16 v[148:151], a[220:223], v[124:127], v[148:151]
    v_mfma_f32_16x16x32_bf16 v[132:135], a[224:227], v[112:115], v[132:135]
    v_mfma_f32_16x16x32_bf16 v[152:155], a[224:227], v[124:127], v[152:155]
    v_mfma_f32_16x16x32_bf16 v[136:139], a[228:231], v[112:115], v[136:139]
    v_mfma_f32_16x16x32_bf16 v[156:159], a[228:231], v[124:127], v[156:159]
    v_mfma_f32_16x16x32_bf16 v[140:143], a[232:235], v[112:115], v[140:143]
    v_mfma_f32_16x16x32_bf16 v[160:163], a[232:235], v[124:127], v[160:163]
    v_mfma_f32_16x16x32_bf16 v[144:147], a[236:239], v[112:115], v[144:147]
    v_mfma_f32_16x16x32_bf16 v[164:167], a[236:239], v[124:127], v[164:167]
    s_waitcnt vmcnt(8)
    s_waitcnt lgkmcnt(5)
    v_mfma_f32_16x16x32_bf16 v[128:131], v[176:179], v[208:211], v[128:131]
    ds_read_b128 v[200:203], v4 offset:6144
    v_mfma_f32_16x16x32_bf16 v[148:151], v[176:179], v[220:223], v[148:151]
    s_waitcnt lgkmcnt(5)
    v_mfma_f32_16x16x32_bf16 v[132:135], v[180:183], v[208:211], v[132:135]
    ds_read_b128 v[204:207], v4 offset:7168
    v_mfma_f32_16x16x32_bf16 v[152:155], v[180:183], v[220:223], v[152:155]
    s_waitcnt lgkmcnt(5)
    v_mfma_f32_16x16x32_bf16 v[136:139], v[184:187], v[208:211], v[136:139]
    ds_read_b128 v[176:179], v4 offset:8192
    v_mfma_f32_16x16x32_bf16 v[156:159], v[184:187], v[220:223], v[156:159]
    s_waitcnt lgkmcnt(5)
    v_mfma_f32_16x16x32_bf16 v[140:143], v[188:191], v[208:211], v[140:143]
    ds_read_b128 v[180:183], v4 offset:9216
    v_mfma_f32_16x16x32_bf16 v[160:163], v[188:191], v[220:223], v[160:163]
    s_waitcnt lgkmcnt(5)
    v_mfma_f32_16x16x32_bf16 v[144:147], v[192:195], v[208:211], v[144:147]
    ds_read_b128 v[184:187], v4 offset:10240
    v_mfma_f32_16x16x32_bf16 v[164:167], v[192:195], v[220:223], v[164:167]
    s_waitcnt vmcnt(7)
    s_waitcnt lgkmcnt(5)
    v_mfma_f32_16x16x32_bf16 v[128:131], v[196:199], v[212:215], v[128:131]
    ds_read_b128 v[188:191], v4 offset:11264
    v_mfma_f32_16x16x32_bf16 v[148:151], v[196:199], v[224:227], v[148:151]
    s_waitcnt lgkmcnt(5)
    v_mfma_f32_16x16x32_bf16 v[132:135], v[200:203], v[212:215], v[132:135]
    ds_read_b128 v[192:195], v4 offset:12288
    v_mfma_f32_16x16x32_bf16 v[152:155], v[200:203], v[224:227], v[152:155]
    s_waitcnt lgkmcnt(5)
    v_mfma_f32_16x16x32_bf16 v[136:139], v[204:207], v[212:215], v[136:139]
    ds_read_b128 v[196:199], v4 offset:13312
    v_mfma_f32_16x16x32_bf16 v[156:159], v[204:207], v[224:227], v[156:159]
    s_waitcnt lgkmcnt(5)
    v_mfma_f32_16x16x32_bf16 v[140:143], v[176:179], v[212:215], v[140:143]
    ds_read_b128 v[200:203], v4 offset:14336
    v_mfma_f32_16x16x32_bf16 v[160:163], v[176:179], v[224:227], v[160:163]
    s_waitcnt lgkmcnt(5)
    v_mfma_f32_16x16x32_bf16 v[144:147], v[180:183], v[212:215], v[144:147]
    ds_read_b128 v[204:207], v4 offset:15360
    v_mfma_f32_16x16x32_bf16 v[164:167], v[180:183], v[224:227], v[164:167]
    s_waitcnt vmcnt(6)
    s_waitcnt lgkmcnt(5)
    v_mfma_f32_16x16x32_bf16 v[128:131], v[184:187], v[216:219], v[128:131]
    ds_read_b128 v[176:179], v4 offset:16384
    v_mfma_f32_16x16x32_bf16 v[148:151], v[184:187], v[228:231], v[148:151]
    s_waitcnt lgkmcnt(5)
    v_mfma_f32_16x16x32_bf16 v[132:135], v[188:191], v[216:219], v[132:135]
    ds_read_b128 v[180:183], v4 offset:17408
    v_mfma_f32_16x16x32_bf16 v[152:155], v[188:191], v[228:231], v[152:155]
    s_waitcnt lgkmcnt(5)
    v_mfma_f32_16x16x32_bf16 v[136:139], v[192:195], v[216:219], v[136:139]
    ds_read_b128 v[184:187], v4 offset:18432
    v_mfma_f32_16x16x32_bf16 v[156:159], v[192:195], v[228:231], v[156:159]
    s_waitcnt lgkmcnt(5)
    v_mfma_f32_16x16x32_bf16 v[140:143], v[196:199], v[216:219], v[140:143]
    ds_read_b128 v[188:191], v4 offset:19456
    v_mfma_f32_16x16x32_bf16 v[160:163], v[196:199], v[228:231], v[160:163]
    s_waitcnt lgkmcnt(5)
    v_mfma_f32_16x16x32_bf16 v[144:147], v[200:203], v[216:219], v[144:147]
    ds_read_b128 v[192:195], v4 offset:20480
    v_mfma_f32_16x16x32_bf16 v[164:167], v[200:203], v[228:231], v[164:167]
    s_waitcnt vmcnt(2)
    s_waitcnt lgkmcnt(5)
    v_mfma_f32_16x16x32_bf16 v[128:131], v[204:207], v[232:235], v[128:131]
    ds_read_b128 v[196:199], v4 offset:21504
    v_mfma_f32_16x16x32_bf16 v[148:151], v[204:207], v[244:247], v[148:151]
    s_waitcnt lgkmcnt(5)
    v_mfma_f32_16x16x32_bf16 v[132:135], v[176:179], v[232:235], v[132:135]
    ds_read_b128 v[200:203], v4 offset:22528
    v_mfma_f32_16x16x32_bf16 v[152:155], v[176:179], v[244:247], v[152:155]
    s_waitcnt lgkmcnt(5)
    v_mfma_f32_16x16x32_bf16 v[136:139], v[180:183], v[232:235], v[136:139]
    ds_read_b128 v[204:207], v4 offset:23552
    v_mfma_f32_16x16x32_bf16 v[156:159], v[180:183], v[244:247], v[156:159]
    s_waitcnt lgkmcnt(5)
    v_mfma_f32_16x16x32_bf16 v[140:143], v[184:187], v[232:235], v[140:143]
    ds_read_b128 v[176:179], v4 offset:24576
    v_mfma_f32_16x16x32_bf16 v[160:163], v[184:187], v[244:247], v[160:163]
    s_waitcnt lgkmcnt(5)
    v_mfma_f32_16x16x32_bf16 v[144:147], v[188:191], v[232:235], v[144:147]
    ds_read_b128 v[180:183], v4 offset:25600
    v_mfma_f32_16x16x32_bf16 v[164:167], v[188:191], v[244:247], v[164:167]
    s_waitcnt vmcnt(1)
    s_waitcnt lgkmcnt(5)
    v_mfma_f32_16x16x32_bf16 v[128:131], v[192:195], v[236:239], v[128:131]
    ds_read_b128 v[184:187], v4 offset:26624
    v_mfma_f32_16x16x32_bf16 v[148:151], v[192:195], v[248:251], v[148:151]
    s_waitcnt lgkmcnt(5)
    v_mfma_f32_16x16x32_bf16 v[132:135], v[196:199], v[236:239], v[132:135]
    v_mfma_f32_16x16x32_bf16 v[152:155], v[196:199], v[248:251], v[152:155]
    s_waitcnt lgkmcnt(4)
    v_mfma_f32_16x16x32_bf16 v[136:139], v[200:203], v[236:239], v[136:139]
    v_mfma_f32_16x16x32_bf16 v[156:159], v[200:203], v[248:251], v[156:159]
    s_waitcnt lgkmcnt(3)
    v_mfma_f32_16x16x32_bf16 v[140:143], v[204:207], v[236:239], v[140:143]
    v_mfma_f32_16x16x32_bf16 v[160:163], v[204:207], v[248:251], v[160:163]
    s_waitcnt lgkmcnt(2)
    v_mfma_f32_16x16x32_bf16 v[144:147], v[176:179], v[236:239], v[144:147]
    v_mfma_f32_16x16x32_bf16 v[164:167], v[176:179], v[248:251], v[164:167]
    s_waitcnt vmcnt(0)
    s_waitcnt lgkmcnt(1)
    v_mfma_f32_16x16x32_bf16 v[128:131], v[180:183], v[240:243], v[128:131]
    v_mfma_f32_16x16x32_bf16 v[148:151], v[180:183], v[252:255], v[148:151]
    s_waitcnt lgkmcnt(0)
    v_mfma_f32_16x16x32_bf16 v[132:135], v[184:187], v[240:243], v[132:135]
    v_mfma_f32_16x16x32_bf16 v[152:155], v[184:187], v[252:255], v[152:155]
    v_mfma_f32_16x16x32_bf16 v[136:139], a[108:111], v[240:243], v[136:139]
    v_mfma_f32_16x16x32_bf16 v[156:159], a[108:111], v[252:255], v[156:159]
    v_mfma_f32_16x16x32_bf16 v[140:143], a[112:115], v[240:243], v[140:143]
    v_mfma_f32_16x16x32_bf16 v[160:163], a[112:115], v[252:255], v[160:163]
    v_mfma_f32_16x16x32_bf16 v[144:147], a[116:119], v[240:243], v[144:147]
    v_mfma_f32_16x16x32_bf16 v[164:167], a[116:119], v[252:255], v[164:167]
    s_mul_i32 s3, s40, 10240
    v_add_u32 v72, s3, v7
    ds_write_b128 v72, v[128:131] offset:0
    ds_write_b128 v72, v[132:135] offset:1024
    ds_write_b128 v72, v[136:139] offset:2048
    ds_write_b128 v72, v[140:143] offset:3072
    s_nop 0
    ds_write_b128 v72, v[144:147] offset:4096
    ds_write_b128 v72, v[148:151] offset:5120
    ds_write_b128 v72, v[152:155] offset:6144
    ds_write_b128 v72, v[156:159] offset:7168
    ds_write_b128 v72, v[160:163] offset:8192
    ds_write_b128 v72, v[164:167] offset:9216
    v_lshlrev_b32 v56, 16, v38
    v_and_b32 v57, 0xffff0000, v38
    v_lshlrev_b32 v58, 16, v39
    v_and_b32 v59, 0xffff0000, v39
    v_lshlrev_b32 v60, 16, v40
    v_and_b32 v61, 0xffff0000, v40
    v_lshlrev_b32 v62, 16, v41
    v_and_b32 v63, 0xffff0000, v41
    v_lshlrev_b32 v64, 16, v42
    v_and_b32 v65, 0xffff0000, v42
    v_lshlrev_b32 v66, 16, v43
    v_and_b32 v67, 0xffff0000, v43
    s_waitcnt lgkmcnt(0)
    s_barrier
    ds_read_b128 v[128:131], v14 offset:0
    ds_read_b128 v[132:135], v14 offset:10240
    ds_read_b128 v[136:139], v14 offset:20480
    ds_read_b128 v[140:143], v14 offset:30720
    ds_read_b128 v[144:147], v14 offset:1024
    ds_read_b128 v[148:151], v14 offset:11264
    ds_read_b128 v[152:155], v14 offset:21504
    ds_read_b128 v[156:159], v14 offset:31744
    ds_read_b128 v[160:163], v15 offset:0
    ds_read_b128 v[164:167], v15 offset:10240
    ds_read_b128 v[168:171], v15 offset:20480
    ds_read_b128 v[172:175], v15 offset:30720
    s_waitcnt lgkmcnt(8)
    v_pk_add_f32 v[128:129], v[128:129], v[132:133]
    v_pk_add_f32 v[130:131], v[130:131], v[134:135]
    v_pk_add_f32 v[136:137], v[136:137], v[140:141]
    v_pk_add_f32 v[138:139], v[138:139], v[142:143]
    s_waitcnt lgkmcnt(4)
    v_pk_add_f32 v[144:145], v[144:145], v[148:149]
    v_pk_add_f32 v[146:147], v[146:147], v[150:151]
    v_pk_add_f32 v[152:153], v[152:153], v[156:157]
    v_pk_add_f32 v[154:155], v[154:155], v[158:159]
    s_waitcnt lgkmcnt(0)
    v_pk_add_f32 v[160:161], v[160:161], v[164:165]
    v_pk_add_f32 v[162:163], v[162:163], v[166:167]
    v_pk_add_f32 v[168:169], v[168:169], v[172:173]
    v_pk_add_f32 v[170:171], v[170:171], v[174:175]
    v_pk_add_f32 v[128:129], v[128:129], v[136:137]
    v_pk_add_f32 v[130:131], v[130:131], v[138:139]
    v_pk_add_f32 v[144:145], v[144:145], v[152:153]
    v_pk_add_f32 v[146:147], v[146:147], v[154:155]
    v_pk_add_f32 v[160:161], v[160:161], v[168:169]
    v_pk_add_f32 v[162:163], v[162:163], v[170:171]
    v_cvt_pk_bf16_f32 v132, v128, v129
    v_cvt_pk_bf16_f32 v133, v130, v131
    v_cvt_pk_bf16_f32 v148, v144, v145
    v_cvt_pk_bf16_f32 v149, v146, v147
    v_cvt_pk_bf16_f32 v164, v160, v161
    v_cvt_pk_bf16_f32 v165, v162, v163
    v_lshlrev_b32 v128, 16, v132
    v_and_b32 v129, 0xffff0000, v132
    v_lshlrev_b32 v130, 16, v133
    v_and_b32 v131, 0xffff0000, v133
    v_lshlrev_b32 v144, 16, v148
    v_and_b32 v145, 0xffff0000, v148
    v_lshlrev_b32 v146, 16, v149
    v_and_b32 v147, 0xffff0000, v149
    v_lshlrev_b32 v160, 16, v164
    v_and_b32 v161, 0xffff0000, v164
    v_lshlrev_b32 v162, 16, v165
    v_and_b32 v163, 0xffff0000, v165
    v_pk_add_f32 v[128:129], v[128:129], v[56:57]
    v_pk_add_f32 v[130:131], v[130:131], v[58:59]
    v_pk_add_f32 v[144:145], v[144:145], v[60:61]
    v_pk_add_f32 v[146:147], v[146:147], v[62:63]
    v_pk_add_f32 v[160:161], v[160:161], v[64:65]
    v_pk_add_f32 v[162:163], v[162:163], v[66:67]
    v_cvt_pk_bf16_f32 v38, v128, v129
    v_cvt_pk_bf16_f32 v39, v130, v131
    v_cvt_pk_bf16_f32 v40, v144, v145
    v_cvt_pk_bf16_f32 v41, v146, v147
    v_cvt_pk_bf16_f32 v42, v160, v161
    v_cvt_pk_bf16_f32 v43, v162, v163
    s_mov_b32 s3, 81920
    buffer_store_dwordx4 v[38:41], v16, s[16:19], s3 offen
    buffer_store_dwordx2 v[42:43], v17, s[16:19], s3 offen
Lk2_end:
    s_endpgm
.section .rodata,"a"
.p2align 6
.amdhsa_kernel interleave_layers__ssm_conv_h3__swiglu_ffn__prompt_kernel
  .amdhsa_next_free_vgpr 512
  .amdhsa_next_free_sgpr 102
  .amdhsa_accum_offset 256
  .amdhsa_group_segment_fixed_size 0
  .amdhsa_kernarg_size 104
  .amdhsa_user_sgpr_count 2
  .amdhsa_user_sgpr_kernarg_segment_ptr 1
  .amdhsa_system_sgpr_workgroup_id_x 1
  .amdhsa_float_denorm_mode_32 3
  .amdhsa_float_denorm_mode_16_64 3
.end_amdhsa_kernel
```
